```python
import torch

def _softmax(x, axis=-1):
    return torch.softmax(x, dim=axis)
def _gelu(x):
    return torch.nn.functional.gelu(x, approximate="tanh")
def _silu(x):
    return torch.nn.functional.silu(x)
def _sigmoid(x):
    return torch.sigmoid(x)
def _layernorm(x, axis=-1, eps=1e-5):
    m = x.mean(dim=axis, keepdim=True)
    v = x.var(dim=axis, keepdim=True, unbiased=False)
    return (x - m) / torch.sqrt(v + eps)
def _scatter_add(tgt, idx, src, axis=0):
    return tgt.clone().index_add_(axis, idx, src)
def _segment_sum(src, seg, n):
    out = torch.zeros((n,) + src.shape[1:], dtype=src.dtype)
    return out.index_add_(0, seg, src)
def _pad(x, pw):
    flat = tuple(v for pair in reversed(pw) for v in pair)
    return torch.nn.functional.pad(x, flat)

kernel_name = 'standalone__gqa_block_cached__near_ridge'

def setup_inputs():

    _w = (lambda a: (lambda t: t.to(torch.bfloat16) if t.is_floating_point() else t)(torch.as_tensor(a)))
    B, Sq, D = 8, 224, 512
    Hq, Hkv, Sk, Dh = 32, 32, 512, 128
    assert Hq % Hkv == 0, (Hq, Hkv)
    return {
        "x": _w((lambda *s: torch.randn(*s, dtype=torch.bfloat16) * 0.8)(B, Sq, D)),
        "k_cache": _w((lambda *s: torch.randn(*s, dtype=torch.bfloat16) * 0.8)(B, Hkv, Sk, Dh)),
        "v_cache": _w((lambda *s: torch.randn(*s, dtype=torch.bfloat16) * 0.05)(B, Hkv, Sk, Dh)),
        "wq": _w((lambda *s: torch.randn(*s, dtype=torch.bfloat16) * 0.8)(D, Hq * Dh) * (D ** -0.5)),
        "wo": _w((lambda *s: torch.randn(*s, dtype=torch.bfloat16) * 0.05)(Hq * Dh, D) * ((Hq * Dh) ** -0.5)),
    }

def reference(x, k_cache, v_cache, wq, wo):
    B, Sq, D = x.shape
    Hq, Dh = 32, 128
    Hkv = k_cache.shape[1]
    rep = Hq // Hkv
    q = (lambda x, *d: x.permute(*d))((x @ wq).reshape(B, Sq, Hq, Dh), 0, 2, 1, 3)
    k = (lambda x, n, axis: torch.repeat_interleave(x, n, dim=axis))(k_cache, rep, axis=1)
    v = (lambda x, n, axis: torch.repeat_interleave(x, n, dim=axis))(v_cache, rep, axis=1)
    scores = torch.einsum("bhqd,bhkd->bhqk", q, k) * (Dh ** -0.5)
    p = _softmax(scores, axis=-1)
    o = torch.einsum("bhqk,bhkd->bhqd", p, v)
    return (lambda x, *d: x.permute(*d))(o, 0, 2, 1, 3).reshape(B, Sq, Hq * Dh) @ wo
```

```asm
; @launch grid=(256,1,1) block=(256,1,1) lds=163840
.amdgcn_target "amdgcn-amd-amdhsa--gfx950"
.text
.globl standalone__gqa_block_cached__near_ridge_kernel
.p2align 8
.type standalone__gqa_block_cached__near_ridge_kernel,@function
standalone__gqa_block_cached__near_ridge_kernel:
    s_cmp_ge_u32 s2, 256
    s_cbranch_scc1 L_end
    s_load_dwordx2 s[24:25], s[0:1], 24
    s_load_dwordx2 s[20:21], s[0:1], 0
    s_getpc_b64 s[56:57]
L_pc:
    s_bfe_u32 s55, s2, 0x40003
    s_mul_i32 s55, s55, 2944
    v_min_u32 v6, 22, v0
    v_lshl_add_u32 v6, v6, 7, s55
    v_min_u32 v6, L_codeend-L_pc-4, v6
    global_load_dword a84, v6, s[56:57]
    v_lshrrev_b32 v1, 6, v0
    v_and_b32 v0, 63, v0
    v_readfirstlane_b32 s3, v1
    s_mov_b32 s53, 0
L_restart:
    v_lshrrev_b32 v1, 4, v0
    v_and_b32 v2, 15, v0
    v_lshrrev_b32 v3, 3, v0
    v_and_b32 v4, 7, v0
    s_and_b32 s9, s2, 7
    s_lshr_b32 s58, s2, 3
    s_bfe_u32 s4, s2, 0x10002
    s_and_b32 s55, s58, 3
    s_lshl2_add_u32 s4, s4, s55
    s_and_b32 s5, s2, 3
    s_lshr_b32 s55, s2, 5
    s_lshl3_add_u32 s5, s5, s55
    s_bfe_u32 s55, s2, 0x10002
    s_and_b32 s9, s2, 3
    s_lshl1_add_u32 s9, s9, s55
    v_lshlrev_b32 v5, 1, v1
    v_xor_b32 v5, v5, v2
    v_lshlrev_b32 v5, 4, v5
    v_lshl_add_u32 v60, v1, 13, v5
    v_add_u32 v61, 31744, v60
    v_xor_b32 v6, 0x80, v60
    v_add_u32 v62, 63488, v6
    v_add_u32 v63, 95232, v6
    s_lshl_b32 s11, s5, 8
    s_lshl_b32 s55, s3, 17
    s_add_u32 s11, s11, s55
    s_lshl_b32 s15, s3, 12
    s_mov_b32 s26, 0x400000
    s_mov_b32 s27, 0x20000
    s_mov_b32 s22, 0x1c0000
    s_mov_b32 s23, 0x20000
    s_and_b32 s8, s3, 1
    s_lshl_b32 s56, s8, 6
    v_xor_b32 v6, v4, v1
    v_lshlrev_b32 v6, 4, v6
    v_lshl_add_u32 v6, v3, 10, v6
    v_xor_b32 v76, s56, v6
    v_xor_b32 v7, 64, v76
    v_add_u32 v77, 7168, v7
    v_add_u32 v78, 14336, v76
    v_add_u32 v79, 21504, v7
    v_add_u32 v80, 0x8000, v76
    v_add_u32 v81, 0x8000, v77
    v_add_u32 v82, 0x8000, v78
    s_mul_i32 s10, s4, 229376
    s_mul_i32 s55, s3, 57344
    s_add_u32 s10, s10, s55
    s_mul_i32 s14, s3, 7168
    s_lshl_b32 s9, s9, 2
    s_lshr_b32 s62, 0x7654210, s9
    s_and_b32 s62, s62, 7
    s_lshl_b32 s84, s62, 19
    s_add_u32 s84, s84, s11
    s_lshl_b32 s85, s62, 7
    s_add_u32 s85, s85, s10
    s_lshr_b32 s62, 0x10765421, s9
    s_and_b32 s62, s62, 7
    s_lshl_b32 s86, s62, 19
    s_add_u32 s86, s86, s11
    s_lshl_b32 s87, s62, 7
    s_add_u32 s87, s87, s10
    s_waitcnt lgkmcnt(0)
    s_load_dwordx2 s[28:29], s[0:1], 8
    s_load_dwordx2 s[32:33], s[0:1], 16
    s_load_dwordx2 s[36:37], s[0:1], 32
    s_load_dwordx2 s[44:45], s[0:1], 40
    s_load_dwordx2 s[48:49], s[0:1], 48
    s_load_dwordx2 s[40:41], s[0:1], 56
    s_add_u32 m0, s15, 0x1c000
    s_nop 0
    buffer_load_dwordx4 v60, s[24:27], s84 offen offset:0 lds
    buffer_load_dwordx4 v61, s[24:27], s84 offen offset:1024 lds
    buffer_load_dwordx4 v62, s[24:27], s84 offen offset:2048 lds
    buffer_load_dwordx4 v63, s[24:27], s84 offen offset:3072 lds
    s_mov_b32 s30, 0x2000000
    s_mov_b32 s31, 0x20000
    s_mov_b32 s34, 0x2000000
    s_mov_b32 s35, 0x20000
    s_mov_b32 s38, 0x400000
    s_mov_b32 s39, 0x20000
    s_mov_b32 s46, 0x1c0000
    s_mov_b32 s47, 0x20000
    s_mov_b32 s50, 0x100
    s_mov_b32 s51, 0x20000
    s_mov_b32 s42, 0x4000000
    s_mov_b32 s43, 0x20000
    s_lshr_b32 s6, s5, 2
    s_and_b32 s7, s5, 3
    s_add_u32 m0, s14, 0x7000
    s_nop 0
    buffer_load_dwordx4 v76, s[20:23], s85 offen offset:0 lds
    s_lshr_b32 s62, 0x21076542, s9
    s_and_b32 s62, s62, 7
    s_lshl_b32 s88, s62, 19
    s_add_u32 s88, s88, s11
    s_lshl_b32 s89, s62, 7
    s_add_u32 s89, s89, s10
    s_mov_b32 s62, 3
    s_lshl_b32 s90, s62, 19
    s_add_u32 s90, s90, s11
    s_lshl_b32 s91, s62, 7
    s_add_u32 s91, s91, s10
    s_lshr_b32 s62, 0x42107654, s9
    s_and_b32 s62, s62, 7
    s_lshl_b32 s92, s62, 19
    buffer_load_dwordx4 v77, s[20:23], s85 offen offset:1024 lds
    s_add_u32 s92, s92, s11
    s_lshl_b32 s93, s62, 7
    s_add_u32 s93, s93, s10
    s_lshr_b32 s62, 0x54210765, s9
    s_and_b32 s62, s62, 7
    s_lshl_b32 s94, s62, 19
    s_add_u32 s94, s94, s11
    s_lshl_b32 s95, s62, 7
    s_add_u32 s95, s95, s10
    s_lshr_b32 s62, 0x65421076, s9
    s_and_b32 s62, s62, 7
    s_lshl_b32 s96, s62, 19
    s_add_u32 s96, s96, s11
    s_lshl_b32 s97, s62, 7
    buffer_load_dwordx4 v78, s[20:23], s85 offen offset:2048 lds
    s_add_u32 s97, s97, s10
    s_lshl_b32 s55, s4, 5
    s_add_u32 s55, s55, s5
    s_lshl_b32 s12, s55, 17
    s_add_u32 s12, s12, s15
    s_lshr_b32 s16, s4, 2
    s_lshl_b32 s16, s16, 5
    s_add_u32 s16, s16, s5
    s_and_b32 s17, s4, 3
    s_lshl2_add_u32 s16, s16, s17
    s_and_b32 s17, s4, 1
    s_lshl1_add_u32 s16, s16, s17
    s_lshl_b32 s16, s16, 17
    s_lshl_b32 s17, s3, 11
    buffer_load_dwordx4 v79, s[20:23], s85 offen offset:3072 lds
    s_add_u32 s16, s16, s17
    s_xor_b32 s17, s16, 0x20000
    s_lshl_b32 s13, s5, 17
    s_lshl_b32 s55, s3, 14
    s_add_u32 s13, s13, s55
    s_xor_b32 s55, s7, 2
    s_lshl_b32 s55, s55, 8
    s_add_u32 s13, s13, s55
    s_mov_b32 s52, 0x3e0293ee
    s_cmp_lg_u32 s53, 0
    s_cbranch_scc1 L_noinit
    s_mov_b32 s60, 0x53800000
    s_mov_b32 s63, 0
    v_mov_b32 v112, 0x7f800000
    v_mov_b32 v116, 0x7f800000
    v_mov_b32 v120, 0x7f800000
    v_mov_b32 v124, 0x7f800000
    s_mov_b32 s101, 0
L_noinit:
    s_add_u32 m0, s14, 0x8000
    s_nop 0
    buffer_load_dwordx4 v80, s[20:23], s85 offen offset:0 lds
    s_mov_b64 vcc, 1
    v_bfrev_b32 v6, 1
    v_cndmask_b32 v19, v6, 0, vcc
    v_lshlrev_b32 v7, 4, v0
    s_mov_b64 vcc, 0xffff
    v_cndmask_b32 v54, v6, v7, vcc
    v_and_b32 v7, 1, v3
    v_lshlrev_b32 v7, 13, v7
    v_lshl_add_u32 v7, v1, 8, v7
    v_lshl_add_u32 v7, v4, 4, v7
    s_mov_b32 vcc_lo, -1
    s_mov_b32 vcc_hi, 0
    v_cndmask_b32 v49, v6, v7, vcc
    v_mov_b32 v50, 1
    buffer_load_dwordx4 v81, s[20:23], s85 offen offset:1024 lds
    v_mov_b32 v48, 0
    s_add_u32 s58, s16, 0x1c000
    s_mov_b32 s100, 0
    v_lshrrev_b32 v7, 1, v2
    v_xor_b32 v7, v7, v1
    v_lshlrev_b32 v7, 4, v7
    v_lshl_add_u32 v7, v2, 7, v7
    s_lshr_b32 s55, s3, 1
    s_mul_i32 s55, s55, 14336
    s_lshl_b32 s56, s8, 13
    s_add_u32 s57, s55, s56
    s_add_u32 s55, s55, 6144
    v_add_u32 v64, s57, v7
    v_xor_b32 v65, 64, v64
    buffer_load_dwordx4 v82, s[20:23], s85 offen offset:2048 lds
    v_add_u32 v66, s55, v7
    v_xor_b32 v67, 64, v66
    v_and_b32 v6, 3, v0
    v_lshrrev_b32 v3, 2, v2
    v_and_b32 v4, 1, v1
    v_lshl_or_b32 v4, v4, 2, v3
    s_lshl_b32 s55, s8, 1
    v_xor_b32 v4, s55, v4
    v_lshlrev_b32 v4, 5, v4
    v_lshl_add_u32 v4, v6, 3, v4
    v_lshl_add_u32 v7, v1, 3, v3
    v_lshl_add_u32 v7, v7, 8, v4
    v_add_u32 v68, 0x18000, v7
    v_xor_b32 v69, 32, v68
    s_add_u32 m0, s15, 0x18000
    s_nop 0
    buffer_load_dwordx4 v60, s[24:27], s86 offen offset:0 lds
    v_xor_b32 v70, 64, v68
    v_xor_b32 v71, 96, v68
    v_xor_b32 v72, 128, v68
    v_xor_b32 v73, 160, v68
    v_xor_b32 v74, 192, v68
    v_xor_b32 v75, 224, v68
L_st7:
    s_lshr_b32 s62, 0x76542107, s9
    s_and_b32 s62, s62, 7
    s_lshl_b32 s84, s62, 19
    s_add_u32 s84, s84, s11
    s_lshl_b32 s85, s62, 7
    s_add_u32 s85, s85, s10
    s_lshl3_add_u32 s55, s4, s6
    buffer_load_dwordx4 v61, s[24:27], s86 offen offset:1024 lds
    s_lshl_b32 s62, s3, 8
    s_lshl2_add_u32 s62, s55, s62
    s_add_u32 s62, s62, s53
    s_and_b32 s55, s4, 3
    s_lshl_b32 s55, s55, 15
    s_lshl_b32 s57, s3, 13
    s_add_u32 s55, s55, s57
    s_lshl_b32 s57, s5, 17
    s_add_u32 s9, s55, s57
    s_and_b32 s57, s13, 0x300
    s_add_u32 s9, s9, s57
    s_waitcnt lgkmcnt(0)
    s_mov_b64 exec, 0
    s_cmp_eq_u32 s3, 0
    s_cbranch_scc1 L_pad0
    s_cmp_eq_u32 s3, 1
    s_cbranch_scc1 L_pad1
    s_cmp_eq_u32 s3, 2
    s_cbranch_scc1 L_pad2
    s_branch L_pad3
L_wret:
    s_mov_b64 exec, -1
    buffer_load_dwordx4 v62, s[24:27], s86 offen offset:2048 lds
    buffer_load_dwordx4 v63, s[24:27], s86 offen offset:3072 lds
    s_add_u32 m0, s14, 0x0
    s_nop 0
    buffer_load_dwordx4 v76, s[20:23], s87 offen offset:0 lds
    buffer_load_dwordx4 v77, s[20:23], s87 offen offset:1024 lds
    buffer_load_dwordx4 v78, s[20:23], s87 offen offset:2048 lds
    buffer_load_dwordx4 v79, s[20:23], s87 offen offset:3072 lds
    s_add_u32 m0, s14, 0x1000
    s_nop 0
    buffer_load_dwordx4 v80, s[20:23], s87 offen offset:0 lds
    buffer_load_dwordx4 v81, s[20:23], s87 offen offset:1024 lds
    buffer_load_dwordx4 v82, s[20:23], s87 offen offset:2048 lds
    buffer_store_dwordx4 v[50:53], v49, s[40:43], s58 offen sc1
    s_bfe_u32 s59, s16, 0x10015
    s_lshl_b32 s55, s59, 13
    s_add_u32 s58, s58, s55
    s_xor_b32 s98, s58, 0x2000
    s_branch L_pad0
.p2align 12
L_pad0:
    s_cbranch_execz L_pad4
    s_waitcnt vmcnt(12)
    s_barrier
    ds_read_b64_tr_b16 a[192:193], v68 offset:16384
    ds_read_b64_tr_b16 a[194:195], v68 offset:17408
    ds_read_b128 a[96:99], v64 offset:28672
    ds_read_b64_tr_b16 a[196:197], v68 offset:24576
    ds_read_b64_tr_b16 a[198:199], v68 offset:25600
    ds_read_b128 a[100:103], v65 offset:28672
    ds_read_b128 a[104:107], v64 offset:30720
    ds_read_b128 a[108:111], v65 offset:30720
    ds_read_b128 a[112:115], v64 offset:32768
    ds_read_b128 a[116:119], v65 offset:32768
    ds_read_b128 a[120:123], v66 offset:28672
    ds_read_b128 a[124:127], v67 offset:28672
    ds_read_b64_tr_b16 a[200:201], v69 offset:16384
    ds_read_b64_tr_b16 a[202:203], v69 offset:17408
    ds_read_b64_tr_b16 a[204:205], v69 offset:24576
    ds_read_b64_tr_b16 a[206:207], v69 offset:25600
    s_waitcnt lgkmcnt(13)
    v_mfma_f32_16x16x32_bf16 v[128:131], a[192:195], a[96:99], 0
    s_waitcnt lgkmcnt(10)
    s_add_u32 m0, s15, 0x20000
    ds_read_b64_tr_b16 a[208:209], v70 offset:16384
    v_mfma_f32_16x16x32_bf16 v[128:131], a[196:199], a[100:103], v[128:131]
    s_waitcnt lgkmcnt(10)
    buffer_load_dwordx4 v60, s[24:27], s88 offen offset:0 lds
    v_mfma_f32_16x16x32_bf16 v[160:163], a[192:195], a[104:107], 0
    s_waitcnt lgkmcnt(9)
    ds_read_b64_tr_b16 a[210:211], v70 offset:17408
    v_mfma_f32_16x16x32_bf16 v[160:163], a[196:199], a[108:111], v[160:163]
    s_waitcnt lgkmcnt(9)
    buffer_load_dwordx4 v61, s[24:27], s88 offen offset:1024 lds
    v_mfma_f32_16x16x32_bf16 v[192:195], a[192:195], a[112:115], 0
    s_waitcnt lgkmcnt(8)
    ds_read_b64_tr_b16 a[212:213], v70 offset:24576
    v_mfma_f32_16x16x32_bf16 v[192:195], a[196:199], a[116:119], v[192:195]
    s_waitcnt lgkmcnt(7)
    ds_read_b64_tr_b16 a[214:215], v70 offset:25600
    v_mfma_f32_16x16x32_bf16 v[224:227], a[192:195], a[120:123], 0
    buffer_load_dwordx4 v62, s[24:27], s88 offen offset:2048 lds
    v_mfma_f32_16x16x32_bf16 v[224:227], a[196:199], a[124:127], v[224:227]
    s_waitcnt lgkmcnt(4)
    ds_read_b64_tr_b16 a[216:217], v71 offset:16384
    v_mfma_f32_16x16x32_bf16 v[132:135], a[200:203], a[96:99], 0
    ds_read_b64_tr_b16 a[218:219], v71 offset:17408
    v_mfma_f32_16x16x32_bf16 v[132:135], a[204:207], a[100:103], v[132:135]
    ds_read_b64_tr_b16 a[220:221], v71 offset:24576
    v_mfma_f32_16x16x32_bf16 v[164:167], a[200:203], a[104:107], 0
    buffer_load_dwordx4 v63, s[24:27], s88 offen offset:3072 lds
    v_mfma_f32_16x16x32_bf16 v[164:167], a[204:207], a[108:111], v[164:167]
    ds_read_b64_tr_b16 a[222:223], v71 offset:25600
    v_mfma_f32_16x16x32_bf16 v[196:199], a[200:203], a[112:115], 0
    s_add_u32 m0, s14, 0xe000
    ds_read_b64_tr_b16 a[224:225], v72 offset:16384
    v_mfma_f32_16x16x32_bf16 v[196:199], a[204:207], a[116:119], v[196:199]
    buffer_load_dwordx4 v76, s[20:23], s89 offen offset:0 lds
    v_mfma_f32_16x16x32_bf16 v[228:231], a[200:203], a[120:123], 0
    ds_read_b64_tr_b16 a[226:227], v72 offset:17408
    v_mfma_f32_16x16x32_bf16 v[228:231], a[204:207], a[124:127], v[228:231]
    s_waitcnt lgkmcnt(5)
    ds_read_b64_tr_b16 a[228:229], v72 offset:24576
    v_mfma_f32_16x16x32_bf16 v[136:139], a[208:211], a[96:99], 0
    ds_read_b64_tr_b16 a[230:231], v72 offset:25600
    v_mfma_f32_16x16x32_bf16 v[136:139], a[212:215], a[100:103], v[136:139]
    buffer_load_dwordx4 v77, s[20:23], s89 offen offset:1024 lds
    v_mfma_f32_16x16x32_bf16 v[168:171], a[208:211], a[104:107], 0
    buffer_load_dwordx4 v78, s[20:23], s89 offen offset:2048 lds
    v_mfma_f32_16x16x32_bf16 v[168:171], a[212:215], a[108:111], v[168:171]
    ds_read_b64_tr_b16 a[232:233], v73 offset:16384
    v_mfma_f32_16x16x32_bf16 v[200:203], a[208:211], a[112:115], 0
    ds_read_b64_tr_b16 a[234:235], v73 offset:17408
    v_mfma_f32_16x16x32_bf16 v[200:203], a[212:215], a[116:119], v[200:203]
    s_waitcnt lgkmcnt(5)
    ds_read_b64_tr_b16 a[236:237], v73 offset:24576
    v_mfma_f32_16x16x32_bf16 v[140:143], a[216:219], a[96:99], 0
    buffer_load_dwordx4 v79, s[20:23], s89 offen offset:3072 lds
    v_mfma_f32_16x16x32_bf16 v[140:143], a[220:223], a[100:103], v[140:143]
    ds_read_b64_tr_b16 a[238:239], v73 offset:25600
    v_mfma_f32_16x16x32_bf16 v[172:175], a[216:219], a[104:107], 0
    ds_read_b64_tr_b16 a[240:241], v74 offset:16384
    v_mfma_f32_16x16x32_bf16 v[172:175], a[220:223], a[108:111], v[172:175]
    s_waitcnt lgkmcnt(5)
    ds_read_b64_tr_b16 a[242:243], v74 offset:17408
    v_mfma_f32_16x16x32_bf16 v[204:207], a[216:219], a[112:115], 0
    s_add_u32 m0, s14, 0xf000
    ds_read_b64_tr_b16 a[244:245], v74 offset:24576
    v_mfma_f32_16x16x32_bf16 v[204:207], a[220:223], a[116:119], v[204:207]
    buffer_load_dwordx4 v80, s[20:23], s89 offen offset:0 lds
    v_mfma_f32_16x16x32_bf16 v[144:147], a[224:227], a[96:99], 0
    ds_read_b64_tr_b16 a[246:247], v74 offset:25600
    v_mfma_f32_16x16x32_bf16 v[144:147], a[228:231], a[100:103], v[144:147]
    ds_read_b64_tr_b16 a[248:249], v75 offset:16384
    v_mfma_f32_16x16x32_bf16 v[176:179], a[224:227], a[104:107], 0
    ds_read_b64_tr_b16 a[250:251], v75 offset:17408
    v_mfma_f32_16x16x32_bf16 v[176:179], a[228:231], a[108:111], v[176:179]
    buffer_load_dwordx4 v81, s[20:23], s89 offen offset:1024 lds
    v_mfma_f32_16x16x32_bf16 v[208:211], a[224:227], a[112:115], 0
    ds_read_b64_tr_b16 a[252:253], v75 offset:24576
    v_mfma_f32_16x16x32_bf16 v[208:211], a[228:231], a[116:119], v[208:211]
    ds_read_b64_tr_b16 a[254:255], v75 offset:25600
    v_mfma_f32_16x16x32_bf16 v[232:235], a[224:227], a[120:123], 0
    buffer_load_dwordx4 v82, s[20:23], s89 offen offset:2048 lds
    v_mfma_f32_16x16x32_bf16 v[232:235], a[228:231], a[124:127], v[232:235]
    s_waitcnt lgkmcnt(5)
    v_mfma_f32_16x16x32_bf16 v[148:151], a[232:235], a[96:99], 0
    v_mfma_f32_16x16x32_bf16 v[148:151], a[236:239], a[100:103], v[148:151]
    v_mfma_f32_16x16x32_bf16 v[180:183], a[232:235], a[104:107], 0
    v_mfma_f32_16x16x32_bf16 v[180:183], a[236:239], a[108:111], v[180:183]
    s_waitcnt vmcnt(12) lgkmcnt(0)
    v_mfma_f32_16x16x32_bf16 v[212:215], a[232:235], a[112:115], 0
    s_barrier
    v_lshlrev_b32 v18, 4, v0
    ds_read_b64_tr_b16 a[192:193], v68 offset:0
    v_mfma_f32_16x16x32_bf16 v[212:215], a[236:239], a[116:119], v[212:215]
    v_xor_b32 v7, v2, v1
    ds_read_b64_tr_b16 a[194:195], v68 offset:1024
    v_mfma_f32_16x16x32_bf16 v[236:239], a[232:235], a[120:123], 0
    ds_read_b128 a[128:131], v64 offset:0
    v_mfma_f32_16x16x32_bf16 v[236:239], a[236:239], a[124:127], v[236:239]
    s_add_u32 m0, s15, 0x1c000
    v_lshlrev_b32 v7, 4, v7
    ds_read_b64_tr_b16 a[196:197], v68 offset:8192
    v_mfma_f32_16x16x32_bf16 v[152:155], a[240:243], a[96:99], 0
    buffer_load_dwordx4 v60, s[24:27], s90 offen offset:0 lds
    v_mfma_f32_16x16x32_bf16 v[152:155], a[244:247], a[100:103], v[152:155]
    ds_read_b64_tr_b16 a[198:199], v68 offset:9216
    v_mfma_f32_16x16x32_bf16 v[184:187], a[240:243], a[104:107], 0
    v_lshl_add_u32 v8, v1, 8, v7
    ds_read_b128 a[132:135], v65 offset:0
    v_mfma_f32_16x16x32_bf16 v[184:187], a[244:247], a[108:111], v[184:187]
    ds_read_b128 a[136:139], v64 offset:2048
    v_mfma_f32_16x16x32_bf16 v[216:219], a[240:243], a[112:115], 0
    v_xor_b32 v9, 64, v8
    ds_read_b128 a[140:143], v65 offset:2048
    v_mfma_f32_16x16x32_bf16 v[216:219], a[244:247], a[116:119], v[216:219]
    ds_read_b128 a[144:147], v64 offset:4096
    v_mfma_f32_16x16x32_bf16 v[156:159], a[248:251], a[96:99], 0
    buffer_load_dwordx4 v61, s[24:27], s90 offen offset:1024 lds
    v_mfma_f32_16x16x32_bf16 v[156:159], a[252:255], a[100:103], v[156:159]
    v_xor_b32 v10, 128, v8
    ds_read_b128 a[148:151], v65 offset:4096
    v_mfma_f32_16x16x32_bf16 v[188:191], a[248:251], a[104:107], 0
    v_xor_b32 v11, 192, v8
    ds_read_b128 a[152:155], v66 offset:0
    v_mfma_f32_16x16x32_bf16 v[188:191], a[252:255], a[108:111], v[188:191]
    ds_read_b128 a[156:159], v67 offset:0
    v_mfma_f32_16x16x32_bf16 v[220:223], a[248:251], a[112:115], 0
    v_lshl_add_u32 v12, v1, 8, v5
    ds_read_b64_tr_b16 a[200:201], v69 offset:0
    v_mfma_f32_16x16x32_bf16 v[220:223], a[252:255], a[116:119], v[220:223]
    s_waitcnt lgkmcnt(6)
    ds_read_b64_tr_b16 a[202:203], v69 offset:1024
    v_mfma_f32_16x16x32_bf16 v[128:131], a[192:195], a[128:131], v[128:131]
    buffer_load_dwordx4 v62, s[24:27], s90 offen offset:2048 lds
    v_mfma_f32_16x16x32_bf16 v[128:131], a[196:199], a[132:135], v[128:131]
    v_xor_b32 v13, 0x80, v12
    ds_read_b64_tr_b16 a[204:205], v69 offset:8192
    v_mfma_f32_16x16x32_bf16 v[160:163], a[192:195], a[136:139], v[160:163]
    s_waitcnt lgkmcnt(6)
    ds_read_b64_tr_b16 a[206:207], v69 offset:9216
    v_mfma_f32_16x16x32_bf16 v[160:163], a[196:199], a[140:143], v[160:163]
    buffer_load_dwordx4 v63, s[24:27], s90 offen offset:3072 lds
    v_mfma_f32_16x16x32_bf16 v[192:195], a[192:195], a[144:147], v[192:195]
    s_waitcnt lgkmcnt(5)
    v_lshl_add_u32 v14, v1, 10, v5
    ds_read_b64_tr_b16 a[208:209], v70 offset:0
    v_mfma_f32_16x16x32_bf16 v[192:195], a[196:199], a[148:151], v[192:195]
    ds_read_b64_tr_b16 a[210:211], v70 offset:1024
    v_mfma_f32_16x16x32_bf16 v[224:227], a[192:195], a[152:155], v[224:227]
    s_waitcnt lgkmcnt(4)
    v_xor_b32 v7, 0x80, v14
    ds_read_b64_tr_b16 a[212:213], v70 offset:8192
    v_mfma_f32_16x16x32_bf16 v[224:227], a[196:199], a[156:159], v[224:227]
    s_add_u32 m0, s14, 0x7000
    v_add_u32 v15, 3072, v7
    ds_read_b64_tr_b16 a[214:215], v70 offset:9216
    v_mfma_f32_16x16x32_bf16 v[132:135], a[200:203], a[128:131], v[132:135]
    s_waitcnt lgkmcnt(4)
    buffer_load_dwordx4 v76, s[20:23], s91 offen offset:0 lds
    v_mfma_f32_16x16x32_bf16 v[132:135], a[204:207], a[132:135], v[132:135]
    ds_read_b64_tr_b16 a[216:217], v71 offset:0
    v_mfma_f32_16x16x32_bf16 v[164:167], a[200:203], a[136:139], v[164:167]
    v_add_u32 v16, 6144, v14
    ds_read_b64_tr_b16 a[218:219], v71 offset:1024
    v_mfma_f32_16x16x32_bf16 v[164:167], a[204:207], a[140:143], v[164:167]
    ds_read_b64_tr_b16 a[220:221], v71 offset:8192
    v_mfma_f32_16x16x32_bf16 v[196:199], a[200:203], a[144:147], v[196:199]
    buffer_load_dwordx4 v77, s[20:23], s91 offen offset:1024 lds
    v_mfma_f32_16x16x32_bf16 v[196:199], a[204:207], a[148:151], v[196:199]
    v_add_u32 v17, 9216, v7
    ds_read_b64_tr_b16 a[222:223], v71 offset:9216
    v_mfma_f32_16x16x32_bf16 v[228:231], a[200:203], a[152:155], v[228:231]
    ds_read_b64_tr_b16 a[224:225], v72 offset:0
    v_mfma_f32_16x16x32_bf16 v[228:231], a[204:207], a[156:159], v[228:231]
    s_waitcnt lgkmcnt(5)
    v_lshl_add_u32 v7, v1, 2, v3
    ds_read_b64_tr_b16 a[226:227], v72 offset:1024
    v_mfma_f32_16x16x32_bf16 v[136:139], a[208:211], a[128:131], v[136:139]
    buffer_load_dwordx4 v78, s[20:23], s91 offen offset:2048 lds
    v_mfma_f32_16x16x32_bf16 v[136:139], a[212:215], a[132:135], v[136:139]
    ds_read_b64_tr_b16 a[228:229], v72 offset:8192
    v_mfma_f32_16x16x32_bf16 v[168:171], a[208:211], a[136:139], v[168:171]
    v_lshl_add_u32 v7, v7, 8, v4
    ds_read_b64_tr_b16 a[230:231], v72 offset:9216
    v_mfma_f32_16x16x32_bf16 v[168:171], a[212:215], a[140:143], v[168:171]
    buffer_load_dwordx4 v79, s[20:23], s91 offen offset:3072 lds
    v_mfma_f32_16x16x32_bf16 v[200:203], a[208:211], a[144:147], v[200:203]
    v_add_u32 v7, 0x8000, v7
    ds_read_b64_tr_b16 a[232:233], v73 offset:0
    v_mfma_f32_16x16x32_bf16 v[200:203], a[212:215], a[148:151], v[200:203]
    s_waitcnt lgkmcnt(5)
    ds_read_b64_tr_b16 a[234:235], v73 offset:1024
    v_mfma_f32_16x16x32_bf16 v[140:143], a[216:219], a[128:131], v[140:143]
    v_add_u32 v30, s56, v7
    ds_read_b64_tr_b16 a[236:237], v73 offset:8192
    v_mfma_f32_16x16x32_bf16 v[140:143], a[220:223], a[132:135], v[140:143]
    s_add_u32 m0, s14, 0x8000
    ds_read_b64_tr_b16 a[238:239], v73 offset:9216
    v_mfma_f32_16x16x32_bf16 v[172:175], a[216:219], a[136:139], v[172:175]
    buffer_load_dwordx4 v80, s[20:23], s91 offen offset:0 lds
    v_mfma_f32_16x16x32_bf16 v[172:175], a[220:223], a[140:143], v[172:175]
    v_xor_b32 v31, 32, v30
    ds_read_b64_tr_b16 a[240:241], v74 offset:0
    v_mfma_f32_16x16x32_bf16 v[204:207], a[216:219], a[144:147], v[204:207]
    ds_read_b64_tr_b16 a[242:243], v74 offset:1024
    v_mfma_f32_16x16x32_bf16 v[204:207], a[220:223], a[148:151], v[204:207]
    s_waitcnt lgkmcnt(6)
    v_xor_b32 v32, 64, v30
    ds_read_b64_tr_b16 a[244:245], v74 offset:8192
    v_mfma_f32_16x16x32_bf16 v[144:147], a[224:227], a[128:131], v[144:147]
    ds_read_b64_tr_b16 a[246:247], v74 offset:9216
    v_mfma_f32_16x16x32_bf16 v[144:147], a[228:231], a[132:135], v[144:147]
    v_xor_b32 v33, 96, v30
    ds_read_b64_tr_b16 a[248:249], v75 offset:0
    v_mfma_f32_16x16x32_bf16 v[176:179], a[224:227], a[136:139], v[176:179]
    buffer_load_dwordx4 v81, s[20:23], s91 offen offset:1024 lds
    v_mfma_f32_16x16x32_bf16 v[176:179], a[228:231], a[140:143], v[176:179]
    v_xor_b32 v34, 128, v30
    ds_read_b64_tr_b16 a[250:251], v75 offset:1024
    v_mfma_f32_16x16x32_bf16 v[208:211], a[224:227], a[144:147], v[208:211]
    ds_read_b64_tr_b16 a[252:253], v75 offset:8192
    v_mfma_f32_16x16x32_bf16 v[208:211], a[228:231], a[148:151], v[208:211]
    v_xor_b32 v35, 160, v30
    ds_read_b64_tr_b16 a[254:255], v75 offset:9216
    v_mfma_f32_16x16x32_bf16 v[232:235], a[224:227], a[152:155], v[232:235]
    buffer_load_dwordx4 v82, s[20:23], s91 offen offset:2048 lds
    v_mfma_f32_16x16x32_bf16 v[232:235], a[228:231], a[156:159], v[232:235]
    s_waitcnt lgkmcnt(5)
    v_mfma_f32_16x16x32_bf16 v[148:151], a[232:235], a[128:131], v[148:151]
    v_mfma_f32_16x16x32_bf16 v[148:151], a[236:239], a[132:135], v[148:151]
    v_mfma_f32_16x16x32_bf16 v[180:183], a[232:235], a[136:139], v[180:183]
    v_mfma_f32_16x16x32_bf16 v[180:183], a[236:239], a[140:143], v[180:183]
    s_waitcnt vmcnt(11) lgkmcnt(0)
    v_mfma_f32_16x16x32_bf16 v[212:215], a[232:235], a[144:147], v[212:215]
    s_barrier
    ds_read_b64_tr_b16 a[192:193], v68 offset:32768
    v_mfma_f32_16x16x32_bf16 v[212:215], a[236:239], a[148:151], v[212:215]
    s_mov_b32 s55, 0
    v_xor_b32 v36, 192, v30
    ds_read_b64_tr_b16 a[194:195], v68 offset:33792
    v_mfma_f32_16x16x32_bf16 v[236:239], a[232:235], a[152:155], v[236:239]
    s_buffer_load_dword s55, s[40:43], s58 offset:0 glc
    ds_read_b128 a[96:99], v64 offset:57344
    v_mfma_f32_16x16x32_bf16 v[236:239], a[236:239], a[156:159], v[236:239]
    s_add_u32 m0, s15, 0x18000
    v_xor_b32 v37, 224, v30
    ds_read_b64_tr_b16 a[196:197], v68 offset:40960
    v_mfma_f32_16x16x32_bf16 v[152:155], a[240:243], a[128:131], v[152:155]
    buffer_load_dwordx4 v60, s[24:27], s92 offen offset:0 lds
    v_mfma_f32_16x16x32_bf16 v[152:155], a[244:247], a[132:135], v[152:155]
    ds_read_b64_tr_b16 a[198:199], v68 offset:41984
    v_mfma_f32_16x16x32_bf16 v[184:187], a[240:243], a[136:139], v[184:187]
    v_xor_b32 v38, 0x2000, v30
    ds_read_b128 a[100:103], v65 offset:57344
    v_mfma_f32_16x16x32_bf16 v[184:187], a[244:247], a[140:143], v[184:187]
    v_xor_b32 v39, 0x2000, v31
    ds_read_b128 a[104:107], v64 offset:59392
    v_mfma_f32_16x16x32_bf16 v[216:219], a[240:243], a[144:147], v[216:219]
    ds_read_b128 a[108:111], v65 offset:59392
    v_mfma_f32_16x16x32_bf16 v[216:219], a[244:247], a[148:151], v[216:219]
    v_xor_b32 v40, 0x2000, v32
    ds_read_b128 a[112:115], v64 offset:61440
    v_mfma_f32_16x16x32_bf16 v[156:159], a[248:251], a[128:131], v[156:159]
    buffer_load_dwordx4 v61, s[24:27], s92 offen offset:1024 lds
    v_mfma_f32_16x16x32_bf16 v[156:159], a[252:255], a[132:135], v[156:159]
    ds_read_b128 a[116:119], v65 offset:61440
    v_mfma_f32_16x16x32_bf16 v[188:191], a[248:251], a[136:139], v[188:191]
    s_add_u32 s100, s100, s55
    v_xor_b32 v41, 0x2000, v33
    ds_read_b128 a[120:123], v66 offset:57344
    v_mfma_f32_16x16x32_bf16 v[188:191], a[252:255], a[140:143], v[188:191]
    ds_read_b128 a[124:127], v67 offset:57344
    v_mfma_f32_16x16x32_bf16 v[220:223], a[248:251], a[144:147], v[220:223]
    s_add_u32 s100, s100, s55
    v_xor_b32 v42, 0x2000, v34
    ds_read_b64_tr_b16 a[200:201], v69 offset:32768
    v_mfma_f32_16x16x32_bf16 v[220:223], a[252:255], a[148:151], v[220:223]
    s_waitcnt lgkmcnt(4)
    ds_read_b64_tr_b16 a[202:203], v69 offset:33792
    v_mfma_f32_16x16x32_bf16 v[128:131], a[192:195], a[96:99], v[128:131]
    s_add_u32 s100, s100, s55
    v_xor_b32 v43, 0x2000, v35
    ds_read_b64_tr_b16 a[204:205], v69 offset:40960
    v_mfma_f32_16x16x32_bf16 v[128:131], a[196:199], a[100:103], v[128:131]
    buffer_load_dwordx4 v62, s[24:27], s92 offen offset:2048 lds
    v_mfma_f32_16x16x32_bf16 v[160:163], a[192:195], a[104:107], v[160:163]
    s_add_u32 s100, s100, s55
    v_xor_b32 v44, 0x2000, v36
    ds_read_b64_tr_b16 a[206:207], v69 offset:41984
    v_mfma_f32_16x16x32_bf16 v[160:163], a[196:199], a[108:111], v[160:163]
    buffer_load_dwordx4 v63, s[24:27], s92 offen offset:3072 lds
    v_mfma_f32_16x16x32_bf16 v[192:195], a[192:195], a[112:115], v[192:195]
    s_waitcnt lgkmcnt(5)
    s_add_u32 s100, s100, s55
    ds_read_b64_tr_b16 a[208:209], v70 offset:32768
    v_mfma_f32_16x16x32_bf16 v[192:195], a[196:199], a[116:119], v[192:195]
    s_waitcnt lgkmcnt(3)
    v_xor_b32 v45, 0x2000, v37
    ds_read_b64_tr_b16 a[210:211], v70 offset:33792
    v_mfma_f32_16x16x32_bf16 v[224:227], a[192:195], a[120:123], v[224:227]
    s_add_u32 s100, s100, s55
    ds_read_b64_tr_b16 a[212:213], v70 offset:40960
    v_mfma_f32_16x16x32_bf16 v[224:227], a[196:199], a[124:127], v[224:227]
    s_add_u32 m0, s14, 0x0
    v_and_b32 v7, 1, v1
    ds_read_b64_tr_b16 a[214:215], v70 offset:41984
    v_mfma_f32_16x16x32_bf16 v[132:135], a[200:203], a[96:99], v[132:135]
    s_waitcnt lgkmcnt(4)
    s_add_u32 s100, s100, s55
    ds_read_b64_tr_b16 a[216:217], v71 offset:32768
    v_mfma_f32_16x16x32_bf16 v[132:135], a[204:207], a[100:103], v[132:135]
    buffer_load_dwordx4 v76, s[20:23], s93 offen offset:0 lds
    v_mfma_f32_16x16x32_bf16 v[164:167], a[200:203], a[104:107], v[164:167]
    s_mov_b32 s99, 0
    v_lshlrev_b32 v7, 1, v7
    ds_read_b64_tr_b16 a[218:219], v71 offset:33792
    v_mfma_f32_16x16x32_bf16 v[164:167], a[204:207], a[108:111], v[164:167]
    s_buffer_load_dword s99, s[40:43], s98 offset:0 glc
    ds_read_b64_tr_b16 a[220:221], v71 offset:40960
    v_mfma_f32_16x16x32_bf16 v[196:199], a[200:203], a[112:115], v[196:199]
    buffer_load_dwordx4 v77, s[20:23], s93 offen offset:1024 lds
    v_mfma_f32_16x16x32_bf16 v[196:199], a[204:207], a[116:119], v[196:199]
    v_lshrrev_b32 v3, 1, v1
    ds_read_b64_tr_b16 a[222:223], v71 offset:41984
    v_mfma_f32_16x16x32_bf16 v[228:231], a[200:203], a[120:123], v[228:231]
    v_or_b32 v7, v7, v3
    ds_read_b64_tr_b16 a[224:225], v72 offset:32768
    v_mfma_f32_16x16x32_bf16 v[228:231], a[204:207], a[124:127], v[228:231]
    s_waitcnt lgkmcnt(5)
    ds_read_b64_tr_b16 a[226:227], v72 offset:33792
    v_mfma_f32_16x16x32_bf16 v[136:139], a[208:211], a[96:99], v[136:139]
    buffer_load_dwordx4 v78, s[20:23], s93 offen offset:2048 lds
    v_mfma_f32_16x16x32_bf16 v[136:139], a[212:215], a[100:103], v[136:139]
    v_lshl_or_b32 v7, s8, 2, v7
    ds_read_b64_tr_b16 a[228:229], v72 offset:40960
    v_mfma_f32_16x16x32_bf16 v[168:171], a[208:211], a[104:107], v[168:171]
    ds_read_b64_tr_b16 a[230:231], v72 offset:41984
    v_mfma_f32_16x16x32_bf16 v[168:171], a[212:215], a[108:111], v[168:171]
    buffer_load_dwordx4 v79, s[20:23], s93 offen offset:3072 lds
    v_mfma_f32_16x16x32_bf16 v[200:203], a[208:211], a[112:115], v[200:203]
    s_waitcnt lgkmcnt(4)
    v_xor_b32 v7, v7, v2
    ds_read_b64_tr_b16 a[232:233], v73 offset:32768
    v_mfma_f32_16x16x32_bf16 v[200:203], a[212:215], a[116:119], v[200:203]
    s_sub_u32 s100, s100, s99
    ds_read_b64_tr_b16 a[234:235], v73 offset:33792
    v_mfma_f32_16x16x32_bf16 v[140:143], a[216:219], a[96:99], v[140:143]
    s_add_u32 m0, s14, 0x1000
    v_lshlrev_b32 v7, 4, v7
    ds_read_b64_tr_b16 a[236:237], v73 offset:40960
    v_mfma_f32_16x16x32_bf16 v[140:143], a[220:223], a[100:103], v[140:143]
    s_sub_u32 s100, s100, s99
    ds_read_b64_tr_b16 a[238:239], v73 offset:41984
    v_mfma_f32_16x16x32_bf16 v[172:175], a[216:219], a[104:107], v[172:175]
    buffer_load_dwordx4 v80, s[20:23], s93 offen offset:0 lds
    v_mfma_f32_16x16x32_bf16 v[172:175], a[220:223], a[108:111], v[172:175]
    s_sub_u32 s100, s100, s99
    v_lshl_add_u32 v7, v2, 8, v7
    ds_read_b64_tr_b16 a[240:241], v74 offset:32768
    v_mfma_f32_16x16x32_bf16 v[204:207], a[216:219], a[112:115], v[204:207]
    s_waitcnt lgkmcnt(5)
    v_add_u32 v252, 0x18000, v7
    ds_read_b64_tr_b16 a[242:243], v74 offset:33792
    v_mfma_f32_16x16x32_bf16 v[204:207], a[220:223], a[116:119], v[204:207]
    s_sub_u32 s100, s100, s99
    ds_read_b64_tr_b16 a[244:245], v74 offset:40960
    v_mfma_f32_16x16x32_bf16 v[144:147], a[224:227], a[96:99], v[144:147]
    v_xor_b32 v253, 64, v252
    ds_read_b64_tr_b16 a[246:247], v74 offset:41984
    v_mfma_f32_16x16x32_bf16 v[144:147], a[228:231], a[100:103], v[144:147]
    s_sub_u32 s100, s100, s99
    ds_read_b64_tr_b16 a[248:249], v75 offset:32768
    v_mfma_f32_16x16x32_bf16 v[176:179], a[224:227], a[104:107], v[176:179]
    buffer_load_dwordx4 v81, s[20:23], s93 offen offset:1024 lds
    v_mfma_f32_16x16x32_bf16 v[176:179], a[228:231], a[108:111], v[176:179]
    s_sub_u32 s100, s100, s99
    v_xor_b32 v254, 128, v252
    ds_read_b64_tr_b16 a[250:251], v75 offset:33792
    v_mfma_f32_16x16x32_bf16 v[208:211], a[224:227], a[112:115], v[208:211]
    ds_read_b64_tr_b16 a[252:253], v75 offset:40960
    v_mfma_f32_16x16x32_bf16 v[208:211], a[228:231], a[116:119], v[208:211]
    s_sub_u32 s100, s100, s99
    v_xor_b32 v255, 192, v252
    ds_read_b64_tr_b16 a[254:255], v75 offset:41984
    v_mfma_f32_16x16x32_bf16 v[232:235], a[224:227], a[120:123], v[232:235]
    buffer_load_dwordx4 v82, s[20:23], s93 offen offset:2048 lds
    v_mfma_f32_16x16x32_bf16 v[232:235], a[228:231], a[124:127], v[232:235]
    s_waitcnt lgkmcnt(5)
    v_mfma_f32_16x16x32_bf16 v[148:151], a[232:235], a[96:99], v[148:151]
    v_mfma_f32_16x16x32_bf16 v[148:151], a[236:239], a[100:103], v[148:151]
    v_mfma_f32_16x16x32_bf16 v[180:183], a[232:235], a[104:107], v[180:183]
    v_mfma_f32_16x16x32_bf16 v[180:183], a[236:239], a[108:111], v[180:183]
    s_waitcnt vmcnt(11) lgkmcnt(0)
    v_mfma_f32_16x16x32_bf16 v[212:215], a[232:235], a[112:115], v[212:215]
    s_barrier
    ds_read_b64_tr_b16 a[192:193], v68 offset:16384
    v_mfma_f32_16x16x32_bf16 v[212:215], a[236:239], a[116:119], v[212:215]
    s_mov_b32 s55, 0
    v_add_u32 v22, s56, v252
    ds_read_b64_tr_b16 a[194:195], v68 offset:17408
    v_mfma_f32_16x16x32_bf16 v[236:239], a[232:235], a[120:123], v[236:239]
    s_buffer_load_dword s55, s[40:43], s98 offset:0 glc
    v_add_u32 v23, s56, v253
    ds_read_b128 a[128:131], v64 offset:28672
    v_mfma_f32_16x16x32_bf16 v[236:239], a[236:239], a[124:127], v[236:239]
    s_add_u32 m0, s15, 0x20000
    ds_read_b64_tr_b16 a[196:197], v68 offset:24576
    v_mfma_f32_16x16x32_bf16 v[152:155], a[240:243], a[96:99], v[152:155]
    buffer_load_dwordx4 v60, s[24:27], s94 offen offset:0 lds
    v_mfma_f32_16x16x32_bf16 v[152:155], a[244:247], a[100:103], v[152:155]
    v_add_u32 v24, s56, v254
    ds_read_b64_tr_b16 a[198:199], v68 offset:25600
    v_mfma_f32_16x16x32_bf16 v[184:187], a[240:243], a[104:107], v[184:187]
    ds_read_b128 a[132:135], v65 offset:28672
    v_mfma_f32_16x16x32_bf16 v[184:187], a[244:247], a[108:111], v[184:187]
    v_add_u32 v25, s56, v255
    ds_read_b128 a[136:139], v64 offset:30720
    v_mfma_f32_16x16x32_bf16 v[216:219], a[240:243], a[112:115], v[216:219]
    ds_read_b128 a[140:143], v65 offset:30720
    v_mfma_f32_16x16x32_bf16 v[216:219], a[244:247], a[116:119], v[216:219]
    v_xor_b32 v26, 0x2000, v22
    ds_read_b128 a[144:147], v64 offset:32768
    v_mfma_f32_16x16x32_bf16 v[156:159], a[248:251], a[96:99], v[156:159]
    buffer_load_dwordx4 v61, s[24:27], s94 offen offset:1024 lds
    v_mfma_f32_16x16x32_bf16 v[156:159], a[252:255], a[100:103], v[156:159]
    ds_read_b128 a[148:151], v65 offset:32768
    v_mfma_f32_16x16x32_bf16 v[188:191], a[248:251], a[104:107], v[188:191]
    s_sub_u32 s100, s100, s55
    v_xor_b32 v27, 0x2000, v23
    ds_read_b128 a[152:155], v66 offset:28672
    v_mfma_f32_16x16x32_bf16 v[188:191], a[252:255], a[108:111], v[188:191]
    v_xor_b32 v28, 0x2000, v24
    ds_read_b128 a[156:159], v67 offset:28672
    v_mfma_f32_16x16x32_bf16 v[220:223], a[248:251], a[112:115], v[220:223]
    s_sub_u32 s100, s100, s55
    ds_read_b64_tr_b16 a[200:201], v69 offset:16384
    v_mfma_f32_16x16x32_bf16 v[220:223], a[252:255], a[116:119], v[220:223]
    s_waitcnt lgkmcnt(4)
    v_xor_b32 v29, 0x2000, v25
    ds_read_b64_tr_b16 a[202:203], v69 offset:17408
    v_mfma_f32_16x16x32_bf16 v[128:131], a[192:195], a[128:131], v[128:131]
    s_sub_u32 s100, s100, s55
    ds_read_b64_tr_b16 a[204:205], v69 offset:24576
    v_mfma_f32_16x16x32_bf16 v[128:131], a[196:199], a[132:135], v[128:131]
    buffer_load_dwordx4 v62, s[24:27], s94 offen offset:2048 lds
    v_mfma_f32_16x16x32_bf16 v[160:163], a[192:195], a[136:139], v[160:163]
    s_sub_u32 s100, s100, s55
    v_mov_b32 v7, 0x3f803f80
    ds_read_b64_tr_b16 a[206:207], v69 offset:25600
    v_mfma_f32_16x16x32_bf16 v[160:163], a[196:199], a[140:143], v[160:163]
    buffer_load_dwordx4 v63, s[24:27], s94 offen offset:3072 lds
    v_mfma_f32_16x16x32_bf16 v[192:195], a[192:195], a[144:147], v[192:195]
    s_waitcnt lgkmcnt(5)
    s_sub_u32 s100, s100, s55
    ds_read_b64_tr_b16 a[208:209], v70 offset:16384
    v_mfma_f32_16x16x32_bf16 v[192:195], a[196:199], a[148:151], v[192:195]
    s_waitcnt lgkmcnt(3)
    v_accvgpr_write_b32 a80, v7
    ds_read_b64_tr_b16 a[210:211], v70 offset:17408
    v_mfma_f32_16x16x32_bf16 v[224:227], a[192:195], a[152:155], v[224:227]
    s_sub_u32 s100, s100, s55
    ds_read_b64_tr_b16 a[212:213], v70 offset:24576
    v_mfma_f32_16x16x32_bf16 v[224:227], a[196:199], a[156:159], v[224:227]
    s_add_u32 m0, s14, 0xe000
    v_accvgpr_write_b32 a81, v7
    ds_read_b64_tr_b16 a[214:215], v70 offset:25600
    v_mfma_f32_16x16x32_bf16 v[132:135], a[200:203], a[128:131], v[132:135]
    s_waitcnt lgkmcnt(4)
    s_sub_u32 s100, s100, s55
    v_accvgpr_write_b32 a82, v7
    ds_read_b64_tr_b16 a[216:217], v71 offset:16384
    v_mfma_f32_16x16x32_bf16 v[132:135], a[204:207], a[132:135], v[132:135]
    buffer_load_dwordx4 v76, s[20:23], s95 offen offset:0 lds
    v_mfma_f32_16x16x32_bf16 v[164:167], a[200:203], a[136:139], v[164:167]
    s_mov_b32 s99, 0
    ds_read_b64_tr_b16 a[218:219], v71 offset:17408
    v_mfma_f32_16x16x32_bf16 v[164:167], a[204:207], a[140:143], v[164:167]
    s_buffer_load_dword s99, s[40:43], s58 offset:0 glc
    v_accvgpr_write_b32 a83, v7
    ds_read_b64_tr_b16 a[220:221], v71 offset:24576
    v_mfma_f32_16x16x32_bf16 v[196:199], a[200:203], a[144:147], v[196:199]
    buffer_load_dwordx4 v77, s[20:23], s95 offen offset:1024 lds
    v_mfma_f32_16x16x32_bf16 v[196:199], a[204:207], a[148:151], v[196:199]
    ds_read_b64_tr_b16 a[222:223], v71 offset:25600
    v_mfma_f32_16x16x32_bf16 v[228:231], a[200:203], a[152:155], v[228:231]
    v_accvgpr_write_b32 a92, 0
    ds_read_b64_tr_b16 a[224:225], v72 offset:16384
    v_mfma_f32_16x16x32_bf16 v[228:231], a[204:207], a[156:159], v[228:231]
    s_waitcnt lgkmcnt(5)
    ds_read_b64_tr_b16 a[226:227], v72 offset:17408
    v_mfma_f32_16x16x32_bf16 v[136:139], a[208:211], a[128:131], v[136:139]
    buffer_load_dwordx4 v78, s[20:23], s95 offen offset:2048 lds
    v_mfma_f32_16x16x32_bf16 v[136:139], a[212:215], a[132:135], v[136:139]
    v_accvgpr_write_b32 a93, 0
    ds_read_b64_tr_b16 a[228:229], v72 offset:24576
    v_mfma_f32_16x16x32_bf16 v[168:171], a[208:211], a[136:139], v[168:171]
    ds_read_b64_tr_b16 a[230:231], v72 offset:25600
    v_mfma_f32_16x16x32_bf16 v[168:171], a[212:215], a[140:143], v[168:171]
    buffer_load_dwordx4 v79, s[20:23], s95 offen offset:3072 lds
    v_mfma_f32_16x16x32_bf16 v[200:203], a[208:211], a[144:147], v[200:203]
    s_waitcnt lgkmcnt(4)
    v_accvgpr_write_b32 a94, 0
    ds_read_b64_tr_b16 a[232:233], v73 offset:16384
    v_mfma_f32_16x16x32_bf16 v[200:203], a[212:215], a[148:151], v[200:203]
    s_add_u32 s100, s100, s99
    v_accvgpr_write_b32 a95, 0
    ds_read_b64_tr_b16 a[234:235], v73 offset:17408
    v_mfma_f32_16x16x32_bf16 v[140:143], a[216:219], a[128:131], v[140:143]
    s_add_u32 m0, s14, 0xf000
    ds_read_b64_tr_b16 a[236:237], v73 offset:24576
    v_mfma_f32_16x16x32_bf16 v[140:143], a[220:223], a[132:135], v[140:143]
    s_add_u32 s100, s100, s99
    v_add_u32 v7, 0x8000, v18
    ds_read_b64_tr_b16 a[238:239], v73 offset:25600
    v_mfma_f32_16x16x32_bf16 v[172:175], a[216:219], a[136:139], v[172:175]
    buffer_load_dwordx4 v80, s[20:23], s95 offen offset:0 lds
    v_mfma_f32_16x16x32_bf16 v[172:175], a[220:223], a[140:143], v[172:175]
    s_add_u32 s100, s100, s99
    ds_read_b64_tr_b16 a[240:241], v74 offset:16384
    v_mfma_f32_16x16x32_bf16 v[204:207], a[216:219], a[144:147], v[204:207]
    s_waitcnt lgkmcnt(5)
    v_add_u32 v21, s15, v7
    ds_read_b64_tr_b16 a[242:243], v74 offset:17408
    v_mfma_f32_16x16x32_bf16 v[204:207], a[220:223], a[148:151], v[204:207]
    s_add_u32 s100, s100, s99
    ds_read_b64_tr_b16 a[244:245], v74 offset:24576
    v_mfma_f32_16x16x32_bf16 v[144:147], a[224:227], a[128:131], v[144:147]
    v_add_u32 v1, 0x18000, v18
    ds_read_b64_tr_b16 a[246:247], v74 offset:25600
    v_mfma_f32_16x16x32_bf16 v[144:147], a[228:231], a[132:135], v[144:147]
    s_add_u32 s100, s100, s99
    ds_read_b64_tr_b16 a[248:249], v75 offset:16384
    v_mfma_f32_16x16x32_bf16 v[176:179], a[224:227], a[136:139], v[176:179]
    buffer_load_dwordx4 v81, s[20:23], s95 offen offset:1024 lds
    v_mfma_f32_16x16x32_bf16 v[176:179], a[228:231], a[140:143], v[176:179]
    s_add_u32 s100, s100, s99
    v_lshlrev_b32 v46, 2, s3
    ds_read_b64_tr_b16 a[250:251], v75 offset:17408
    v_mfma_f32_16x16x32_bf16 v[208:211], a[224:227], a[144:147], v[208:211]
L_pad1:
    s_cbranch_execz L_pad5
    v_add_u32 v51, v46, v1
    ds_read_b64_tr_b16 a[252:253], v75 offset:24576
    v_mfma_f32_16x16x32_bf16 v[208:211], a[228:231], a[148:151], v[208:211]
    s_add_u32 s100, s100, s99
    ds_read_b64_tr_b16 a[254:255], v75 offset:25600
    v_mfma_f32_16x16x32_bf16 v[232:235], a[224:227], a[152:155], v[232:235]
    buffer_load_dwordx4 v82, s[20:23], s95 offen offset:2048 lds
    v_mfma_f32_16x16x32_bf16 v[232:235], a[228:231], a[156:159], v[232:235]
    s_waitcnt lgkmcnt(5)
    v_mfma_f32_16x16x32_bf16 v[148:151], a[232:235], a[128:131], v[148:151]
    v_mfma_f32_16x16x32_bf16 v[148:151], a[236:239], a[132:135], v[148:151]
    v_mfma_f32_16x16x32_bf16 v[180:183], a[232:235], a[136:139], v[180:183]
    v_mfma_f32_16x16x32_bf16 v[180:183], a[236:239], a[140:143], v[180:183]
    s_waitcnt vmcnt(11) lgkmcnt(0)
    v_mfma_f32_16x16x32_bf16 v[212:215], a[232:235], a[144:147], v[212:215]
    s_barrier
    v_xor_b32 v52, 4, v51
    ds_read_b64_tr_b16 a[192:193], v68 offset:0
    v_mfma_f32_16x16x32_bf16 v[212:215], a[236:239], a[148:151], v[212:215]
    s_mov_b32 s55, 0
    ds_read_b64_tr_b16 a[194:195], v68 offset:1024
    v_mfma_f32_16x16x32_bf16 v[236:239], a[232:235], a[152:155], v[236:239]
    s_buffer_load_dword s55, s[40:43], s58 offset:256 glc
    v_xor_b32 v53, 0x1000, v21
    ds_read_b128 a[96:99], v64 offset:0
    v_mfma_f32_16x16x32_bf16 v[236:239], a[236:239], a[156:159], v[236:239]
    s_add_u32 m0, s15, 0x1c000
    ds_read_b64_tr_b16 a[196:197], v68 offset:8192
    v_mfma_f32_16x16x32_bf16 v[152:155], a[240:243], a[128:131], v[152:155]
    buffer_load_dwordx4 v60, s[24:27], s96 offen offset:0 lds
    v_mfma_f32_16x16x32_bf16 v[152:155], a[244:247], a[132:135], v[152:155]
    v_and_b32 v55, 7, v0
    ds_read_b64_tr_b16 a[198:199], v68 offset:9216
    v_mfma_f32_16x16x32_bf16 v[184:187], a[240:243], a[136:139], v[184:187]
    ds_read_b128 a[100:103], v65 offset:0
    v_mfma_f32_16x16x32_bf16 v[184:187], a[244:247], a[140:143], v[184:187]
    v_xor_b32 v55, s6, v55
    ds_read_b128 a[104:107], v64 offset:2048
    v_mfma_f32_16x16x32_bf16 v[216:219], a[240:243], a[144:147], v[216:219]
    v_lshlrev_b32 v55, 2, v55
    ds_read_b128 a[108:111], v65 offset:2048
    v_mfma_f32_16x16x32_bf16 v[216:219], a[244:247], a[148:151], v[216:219]
    ds_read_b128 a[112:115], v64 offset:4096
    v_mfma_f32_16x16x32_bf16 v[156:159], a[248:251], a[128:131], v[156:159]
    buffer_load_dwordx4 v61, s[24:27], s96 offen offset:1024 lds
    v_mfma_f32_16x16x32_bf16 v[156:159], a[252:255], a[132:135], v[156:159]
    v_lshlrev_b32 v7, 3, s7
    ds_read_b128 a[116:119], v65 offset:4096
    v_mfma_f32_16x16x32_bf16 v[188:191], a[248:251], a[136:139], v[188:191]
    s_add_u32 s100, s100, s55
    ds_read_b128 a[120:123], v66 offset:0
    v_mfma_f32_16x16x32_bf16 v[188:191], a[252:255], a[140:143], v[188:191]
    v_bfm_b32 v7, 8, v7
    ds_read_b128 a[124:127], v67 offset:0
    v_mfma_f32_16x16x32_bf16 v[220:223], a[248:251], a[144:147], v[220:223]
    s_add_u32 s100, s100, s55
    ds_read_b64_tr_b16 a[200:201], v69 offset:0
    v_mfma_f32_16x16x32_bf16 v[220:223], a[252:255], a[148:151], v[220:223]
    s_waitcnt lgkmcnt(4)
    v_not_b32 v49, v7
    ds_read_b64_tr_b16 a[202:203], v69 offset:1024
    v_mfma_f32_16x16x32_bf16 v[128:131], a[192:195], a[96:99], v[128:131]
    s_add_u32 s100, s100, s55
    ds_read_b64_tr_b16 a[204:205], v69 offset:8192
    v_mfma_f32_16x16x32_bf16 v[128:131], a[196:199], a[100:103], v[128:131]
    buffer_load_dwordx4 v62, s[24:27], s96 offen offset:2048 lds
    v_mfma_f32_16x16x32_bf16 v[160:163], a[192:195], a[104:107], v[160:163]
    s_add_u32 s100, s100, s55
    v_lshrrev_b32 v7, 1, v2
    ds_read_b64_tr_b16 a[206:207], v69 offset:9216
    v_mfma_f32_16x16x32_bf16 v[160:163], a[196:199], a[108:111], v[160:163]
    buffer_load_dwordx4 v63, s[24:27], s96 offen offset:3072 lds
    v_mfma_f32_16x16x32_bf16 v[192:195], a[192:195], a[112:115], v[192:195]
    s_waitcnt lgkmcnt(5)
    s_add_u32 s100, s100, s55
    v_lshlrev_b32 v7, 3, v7
    ds_read_b64_tr_b16 a[208:209], v70 offset:0
    v_mfma_f32_16x16x32_bf16 v[192:195], a[196:199], a[116:119], v[192:195]
    s_waitcnt lgkmcnt(3)
    ds_read_b64_tr_b16 a[210:211], v70 offset:1024
    v_mfma_f32_16x16x32_bf16 v[224:227], a[192:195], a[120:123], v[224:227]
    s_add_u32 s100, s100, s55
    v_and_or_b32 v2, v2, 1, v7
    ds_read_b64_tr_b16 a[212:213], v70 offset:8192
    v_mfma_f32_16x16x32_bf16 v[224:227], a[196:199], a[124:127], v[224:227]
    s_add_u32 m0, s14, 0x7000
    ds_read_b64_tr_b16 a[214:215], v70 offset:9216
    v_mfma_f32_16x16x32_bf16 v[132:135], a[200:203], a[96:99], v[132:135]
    s_waitcnt lgkmcnt(4)
    s_add_u32 s100, s100, s55
    v_lshrrev_b32 v7, 4, v0
    ds_read_b64_tr_b16 a[216:217], v71 offset:0
    v_mfma_f32_16x16x32_bf16 v[132:135], a[204:207], a[100:103], v[132:135]
    buffer_load_dwordx4 v76, s[20:23], s97 offen offset:0 lds
    v_mfma_f32_16x16x32_bf16 v[164:167], a[200:203], a[104:107], v[164:167]
    s_mov_b32 s99, 0
    ds_read_b64_tr_b16 a[218:219], v71 offset:1024
    v_mfma_f32_16x16x32_bf16 v[164:167], a[204:207], a[108:111], v[164:167]
    s_buffer_load_dword s99, s[40:43], s98 offset:256 glc
    v_lshlrev_b32 v3, 7, v2
    ds_read_b64_tr_b16 a[220:221], v71 offset:8192
    v_mfma_f32_16x16x32_bf16 v[196:199], a[200:203], a[112:115], v[196:199]
    buffer_load_dwordx4 v77, s[20:23], s97 offen offset:1024 lds
    v_mfma_f32_16x16x32_bf16 v[196:199], a[204:207], a[116:119], v[196:199]
    ds_read_b64_tr_b16 a[222:223], v71 offset:9216
    v_mfma_f32_16x16x32_bf16 v[228:231], a[200:203], a[120:123], v[228:231]
    v_lshl_add_u32 v3, v7, 28, v3
    ds_read_b64_tr_b16 a[224:225], v72 offset:0
    v_mfma_f32_16x16x32_bf16 v[228:231], a[204:207], a[124:127], v[228:231]
    s_waitcnt lgkmcnt(5)
    ds_read_b64_tr_b16 a[226:227], v72 offset:1024
    v_mfma_f32_16x16x32_bf16 v[136:139], a[208:211], a[96:99], v[136:139]
    buffer_load_dwordx4 v78, s[20:23], s97 offen offset:2048 lds
    v_mfma_f32_16x16x32_bf16 v[136:139], a[212:215], a[100:103], v[136:139]
    ds_read_b64_tr_b16 a[228:229], v72 offset:8192
    v_mfma_f32_16x16x32_bf16 v[168:171], a[208:211], a[104:107], v[168:171]
    ds_read_b64_tr_b16 a[230:231], v72 offset:9216
    v_mfma_f32_16x16x32_bf16 v[168:171], a[212:215], a[108:111], v[168:171]
    buffer_load_dwordx4 v79, s[20:23], s97 offen offset:3072 lds
    v_mfma_f32_16x16x32_bf16 v[200:203], a[208:211], a[112:115], v[200:203]
    s_waitcnt lgkmcnt(4)
    ds_read_b64_tr_b16 a[232:233], v73 offset:0
    v_mfma_f32_16x16x32_bf16 v[200:203], a[212:215], a[116:119], v[200:203]
    s_sub_u32 s100, s100, s99
    ds_read_b64_tr_b16 a[234:235], v73 offset:1024
    v_mfma_f32_16x16x32_bf16 v[140:143], a[216:219], a[96:99], v[140:143]
    s_add_u32 m0, s14, 0x8000
    ds_read_b64_tr_b16 a[236:237], v73 offset:8192
    v_mfma_f32_16x16x32_bf16 v[140:143], a[220:223], a[100:103], v[140:143]
    s_sub_u32 s100, s100, s99
    ds_read_b64_tr_b16 a[238:239], v73 offset:9216
    v_mfma_f32_16x16x32_bf16 v[172:175], a[216:219], a[104:107], v[172:175]
    buffer_load_dwordx4 v80, s[20:23], s97 offen offset:0 lds
    v_mfma_f32_16x16x32_bf16 v[172:175], a[220:223], a[108:111], v[172:175]
    s_sub_u32 s100, s100, s99
    ds_read_b64_tr_b16 a[240:241], v74 offset:0
    v_mfma_f32_16x16x32_bf16 v[204:207], a[216:219], a[112:115], v[204:207]
    s_waitcnt lgkmcnt(5)
    ds_read_b64_tr_b16 a[242:243], v74 offset:1024
    v_mfma_f32_16x16x32_bf16 v[204:207], a[220:223], a[116:119], v[204:207]
    s_sub_u32 s100, s100, s99
    ds_read_b64_tr_b16 a[244:245], v74 offset:8192
    v_mfma_f32_16x16x32_bf16 v[144:147], a[224:227], a[96:99], v[144:147]
    ds_read_b64_tr_b16 a[246:247], v74 offset:9216
    v_mfma_f32_16x16x32_bf16 v[144:147], a[228:231], a[100:103], v[144:147]
    s_sub_u32 s100, s100, s99
    ds_read_b64_tr_b16 a[248:249], v75 offset:0
    v_mfma_f32_16x16x32_bf16 v[176:179], a[224:227], a[104:107], v[176:179]
    buffer_load_dwordx4 v81, s[20:23], s97 offen offset:1024 lds
    v_mfma_f32_16x16x32_bf16 v[176:179], a[228:231], a[108:111], v[176:179]
    s_sub_u32 s100, s100, s99
    ds_read_b64_tr_b16 a[250:251], v75 offset:1024
    v_mfma_f32_16x16x32_bf16 v[208:211], a[224:227], a[112:115], v[208:211]
    ds_read_b64_tr_b16 a[252:253], v75 offset:8192
    v_mfma_f32_16x16x32_bf16 v[208:211], a[228:231], a[116:119], v[208:211]
    s_sub_u32 s100, s100, s99
    ds_read_b64_tr_b16 a[254:255], v75 offset:9216
    v_mfma_f32_16x16x32_bf16 v[232:235], a[224:227], a[120:123], v[232:235]
    buffer_load_dwordx4 v82, s[20:23], s97 offen offset:2048 lds
    v_mfma_f32_16x16x32_bf16 v[232:235], a[228:231], a[124:127], v[232:235]
    s_waitcnt lgkmcnt(5)
    v_mfma_f32_16x16x32_bf16 v[148:151], a[232:235], a[96:99], v[148:151]
    v_mfma_f32_16x16x32_bf16 v[148:151], a[236:239], a[100:103], v[148:151]
    v_mfma_f32_16x16x32_bf16 v[180:183], a[232:235], a[104:107], v[180:183]
    s_add_u32 m0, s15, 0x18000
    v_mfma_f32_16x16x32_bf16 v[180:183], a[236:239], a[108:111], v[180:183]
    s_waitcnt vmcnt(11) lgkmcnt(0)
    v_mfma_f32_16x16x32_bf16 v[212:215], a[232:235], a[112:115], v[212:215]
    s_barrier
    ds_read_b64_tr_b16 a[192:193], v68 offset:32768
    v_mfma_f32_16x16x32_bf16 v[212:215], a[236:239], a[116:119], v[212:215]
    s_mov_b32 s55, 0
    ds_read_b64_tr_b16 a[194:195], v68 offset:33792
    v_mfma_f32_16x16x32_bf16 v[236:239], a[232:235], a[120:123], v[236:239]
    s_buffer_load_dword s55, s[40:43], s98 offset:256 glc
    ds_read_b128 a[128:131], v64 offset:57344
    v_mfma_f32_16x16x32_bf16 v[236:239], a[236:239], a[124:127], v[236:239]
    buffer_load_dwordx4 v60, s[24:27], s84 offen offset:0 lds
    v_mfma_f32_16x16x32_bf16 v[152:155], a[240:243], a[96:99], v[152:155]
    ds_read_b64_tr_b16 a[196:197], v68 offset:40960
    v_mfma_f32_16x16x32_bf16 v[152:155], a[244:247], a[100:103], v[152:155]
    ds_read_b64_tr_b16 a[198:199], v68 offset:41984
    v_mfma_f32_16x16x32_bf16 v[184:187], a[240:243], a[104:107], v[184:187]
    ds_read_b128 a[132:135], v65 offset:57344
    v_mfma_f32_16x16x32_bf16 v[184:187], a[244:247], a[108:111], v[184:187]
    ds_read_b128 a[136:139], v64 offset:59392
    v_mfma_f32_16x16x32_bf16 v[216:219], a[240:243], a[112:115], v[216:219]
    buffer_load_dwordx4 v61, s[24:27], s84 offen offset:1024 lds
    v_mfma_f32_16x16x32_bf16 v[216:219], a[244:247], a[116:119], v[216:219]
    ds_read_b128 a[140:143], v65 offset:59392
    v_mfma_f32_16x16x32_bf16 v[156:159], a[248:251], a[96:99], v[156:159]
    ds_read_b128 a[144:147], v64 offset:61440
    v_mfma_f32_16x16x32_bf16 v[156:159], a[252:255], a[100:103], v[156:159]
    ds_read_b128 a[148:151], v65 offset:61440
    v_mfma_f32_16x16x32_bf16 v[188:191], a[248:251], a[104:107], v[188:191]
    s_sub_u32 s100, s100, s55
    ds_read_b128 a[152:155], v66 offset:57344
    v_mfma_f32_16x16x32_bf16 v[188:191], a[252:255], a[108:111], v[188:191]
    buffer_load_dwordx4 v62, s[24:27], s84 offen offset:2048 lds
    v_mfma_f32_16x16x32_bf16 v[220:223], a[248:251], a[112:115], v[220:223]
    s_sub_u32 s100, s100, s55
    ds_read_b128 a[156:159], v67 offset:57344
    v_mfma_f32_16x16x32_bf16 v[220:223], a[252:255], a[116:119], v[220:223]
    s_waitcnt lgkmcnt(4)
    ds_read_b64_tr_b16 a[200:201], v69 offset:32768
    v_mfma_f32_16x16x32_bf16 v[128:131], a[192:195], a[128:131], v[128:131]
    s_sub_u32 s100, s100, s55
    ds_read_b64_tr_b16 a[202:203], v69 offset:33792
    v_mfma_f32_16x16x32_bf16 v[128:131], a[196:199], a[132:135], v[128:131]
    buffer_load_dwordx4 v63, s[24:27], s84 offen offset:3072 lds
    v_mfma_f32_16x16x32_bf16 v[160:163], a[192:195], a[136:139], v[160:163]
    s_sub_u32 s100, s100, s55
    ds_read_b64_tr_b16 a[204:205], v69 offset:40960
    v_mfma_f32_16x16x32_bf16 v[160:163], a[196:199], a[140:143], v[160:163]
    s_waitcnt lgkmcnt(5)
    s_add_u32 m0, s14, 0x0
    ds_read_b64_tr_b16 a[206:207], v69 offset:41984
    v_mfma_f32_16x16x32_bf16 v[192:195], a[192:195], a[144:147], v[192:195]
    s_sub_u32 s100, s100, s55
    ds_read_b64_tr_b16 a[208:209], v70 offset:32768
    v_mfma_f32_16x16x32_bf16 v[192:195], a[196:199], a[148:151], v[192:195]
    s_waitcnt lgkmcnt(6)
    buffer_load_dwordx4 v76, s[20:23], s85 offen offset:0 lds
    v_mfma_f32_16x16x32_bf16 v[224:227], a[192:195], a[152:155], v[224:227]
    s_waitcnt lgkmcnt(5)
    s_sub_u32 s100, s100, s55
    ds_read_b64_tr_b16 a[210:211], v70 offset:33792
    v_mfma_f32_16x16x32_bf16 v[224:227], a[196:199], a[156:159], v[224:227]
    s_waitcnt lgkmcnt(4)
    buffer_load_dwordx4 v77, s[20:23], s85 offen offset:1024 lds
    v_mfma_f32_16x16x32_bf16 v[132:135], a[200:203], a[128:131], v[132:135]
    s_waitcnt lgkmcnt(2)
    s_sub_u32 s100, s100, s55
    ds_read_b64_tr_b16 a[212:213], v70 offset:40960
    v_mfma_f32_16x16x32_bf16 v[132:135], a[204:207], a[132:135], v[132:135]
    ds_read_b64_tr_b16 a[214:215], v70 offset:41984
    v_mfma_f32_16x16x32_bf16 v[164:167], a[200:203], a[136:139], v[164:167]
    s_mov_b32 s99, 0
    ds_read_b64_tr_b16 a[216:217], v71 offset:32768
    v_mfma_f32_16x16x32_bf16 v[164:167], a[204:207], a[140:143], v[164:167]
    s_buffer_load_dword s99, s[40:43], s58 offset:256 glc
    ds_read_b64_tr_b16 a[218:219], v71 offset:33792
    v_mfma_f32_16x16x32_bf16 v[196:199], a[200:203], a[144:147], v[196:199]
    buffer_load_dwordx4 v78, s[20:23], s85 offen offset:2048 lds
    v_mfma_f32_16x16x32_bf16 v[196:199], a[204:207], a[148:151], v[196:199]
    buffer_load_dwordx4 v79, s[20:23], s85 offen offset:3072 lds
    v_mfma_f32_16x16x32_bf16 v[228:231], a[200:203], a[152:155], v[228:231]
    s_waitcnt lgkmcnt(4)
    ds_read_b64_tr_b16 a[220:221], v71 offset:40960
    v_mfma_f32_16x16x32_bf16 v[228:231], a[204:207], a[156:159], v[228:231]
    s_add_u32 m0, s14, 0x1000
    ds_read_b64_tr_b16 a[222:223], v71 offset:41984
    v_mfma_f32_16x16x32_bf16 v[136:139], a[208:211], a[128:131], v[136:139]
    s_waitcnt lgkmcnt(4)
    buffer_load_dwordx4 v80, s[20:23], s85 offen offset:0 lds
    v_mfma_f32_16x16x32_bf16 v[136:139], a[212:215], a[132:135], v[136:139]
    ds_read_b64_tr_b16 a[224:225], v72 offset:32768
    v_mfma_f32_16x16x32_bf16 v[168:171], a[208:211], a[136:139], v[168:171]
    ds_read_b64_tr_b16 a[226:227], v72 offset:33792
    v_mfma_f32_16x16x32_bf16 v[168:171], a[212:215], a[140:143], v[168:171]
    s_waitcnt lgkmcnt(4)
    ds_read_b64_tr_b16 a[228:229], v72 offset:40960
    v_mfma_f32_16x16x32_bf16 v[200:203], a[208:211], a[144:147], v[200:203]
    buffer_load_dwordx4 v81, s[20:23], s85 offen offset:1024 lds
    v_mfma_f32_16x16x32_bf16 v[200:203], a[212:215], a[148:151], v[200:203]
    s_add_u32 s100, s100, s99
    ds_read_b64_tr_b16 a[230:231], v72 offset:41984
    v_mfma_f32_16x16x32_bf16 v[140:143], a[216:219], a[128:131], v[140:143]
    s_waitcnt lgkmcnt(4)
    buffer_load_dwordx4 v82, s[20:23], s85 offen offset:2048 lds
    v_mfma_f32_16x16x32_bf16 v[140:143], a[220:223], a[132:135], v[140:143]
    s_add_u32 s100, s100, s99
    ds_read_b64_tr_b16 a[232:233], v73 offset:32768
    v_mfma_f32_16x16x32_bf16 v[172:175], a[216:219], a[136:139], v[172:175]
    s_add_u32 m0, s15, 0x24000
    ds_read_b64_tr_b16 a[234:235], v73 offset:33792
    v_mfma_f32_16x16x32_bf16 v[172:175], a[220:223], a[140:143], v[172:175]
    s_add_u32 s100, s100, s99
    ds_read_b64_tr_b16 a[236:237], v73 offset:40960
    v_mfma_f32_16x16x32_bf16 v[204:207], a[216:219], a[144:147], v[204:207]
    s_add_u32 s54, s12, 0x0
    ds_read_b64_tr_b16 a[238:239], v73 offset:41984
    v_mfma_f32_16x16x32_bf16 v[204:207], a[220:223], a[148:151], v[204:207]
    s_waitcnt lgkmcnt(5)
    s_add_u32 s100, s100, s99
    ds_read_b64_tr_b16 a[240:241], v74 offset:32768
    v_mfma_f32_16x16x32_bf16 v[144:147], a[224:227], a[128:131], v[144:147]
    s_waitcnt lgkmcnt(5)
    buffer_load_dwordx4 v8, s[28:31], s54 offen offset:0 nt lds
    v_mfma_f32_16x16x32_bf16 v[144:147], a[228:231], a[132:135], v[144:147]
    s_add_u32 s100, s100, s99
    ds_read_b64_tr_b16 a[242:243], v74 offset:33792
    v_mfma_f32_16x16x32_bf16 v[176:179], a[224:227], a[136:139], v[176:179]
    buffer_load_dwordx4 v9, s[28:31], s54 offen offset:1024 nt lds
    v_mfma_f32_16x16x32_bf16 v[176:179], a[228:231], a[140:143], v[176:179]
    s_add_u32 s100, s100, s99
    ds_read_b64_tr_b16 a[244:245], v74 offset:40960
    v_mfma_f32_16x16x32_bf16 v[208:211], a[224:227], a[144:147], v[208:211]
    ds_read_b64_tr_b16 a[246:247], v74 offset:41984
    v_mfma_f32_16x16x32_bf16 v[208:211], a[228:231], a[148:151], v[208:211]
    s_add_u32 s100, s100, s99
    ds_read_b64_tr_b16 a[248:249], v75 offset:32768
    v_mfma_f32_16x16x32_bf16 v[232:235], a[224:227], a[152:155], v[232:235]
    s_waitcnt lgkmcnt(5)
    ds_read_b64_tr_b16 a[250:251], v75 offset:33792
    v_mfma_f32_16x16x32_bf16 v[232:235], a[228:231], a[156:159], v[232:235]
    buffer_load_dwordx4 v10, s[28:31], s54 offen offset:2048 nt lds
    v_mfma_f32_16x16x32_bf16 v[148:151], a[232:235], a[128:131], v[148:151]
    ds_read_b64_tr_b16 a[252:253], v75 offset:40960
    v_mfma_f32_16x16x32_bf16 v[148:151], a[236:239], a[132:135], v[148:151]
    ds_read_b64_tr_b16 a[254:255], v75 offset:41984
    v_mfma_f32_16x16x32_bf16 v[180:183], a[232:235], a[136:139], v[180:183]
    buffer_load_dwordx4 v11, s[28:31], s54 offen offset:3072 nt lds
    v_mfma_f32_16x16x32_bf16 v[180:183], a[236:239], a[140:143], v[180:183]
    s_waitcnt vmcnt(15) lgkmcnt(0)
    v_mfma_f32_16x16x32_bf16 v[212:215], a[232:235], a[144:147], v[212:215]
    s_barrier
    ds_read_b64_tr_b16 a[192:193], v68 offset:16384
    v_mfma_f32_16x16x32_bf16 v[212:215], a[236:239], a[148:151], v[212:215]
    ds_read_b64_tr_b16 a[194:195], v68 offset:17408
    v_mfma_f32_16x16x32_bf16 v[236:239], a[232:235], a[152:155], v[236:239]
    ds_read_b128 a[96:99], v64 offset:28672
    v_mfma_f32_16x16x32_bf16 v[236:239], a[236:239], a[156:159], v[236:239]
    ds_read_b64_tr_b16 a[196:197], v68 offset:24576
    v_mfma_f32_16x16x32_bf16 v[152:155], a[240:243], a[128:131], v[152:155]
    ds_read_b64_tr_b16 a[198:199], v68 offset:25600
    v_mfma_f32_16x16x32_bf16 v[152:155], a[244:247], a[132:135], v[152:155]
    s_add_u32 m0, s15, 0x14000
    ds_read_b128 a[100:103], v65 offset:28672
    v_mfma_f32_16x16x32_bf16 v[184:187], a[240:243], a[136:139], v[184:187]
    s_add_u32 s54, s12, 0x0
    ds_read_b128 a[104:107], v64 offset:30720
    v_mfma_f32_16x16x32_bf16 v[184:187], a[244:247], a[140:143], v[184:187]
    buffer_load_dwordx4 v12, s[32:35], s54 offen offset:0 nt lds
    v_mfma_f32_16x16x32_bf16 v[216:219], a[240:243], a[144:147], v[216:219]
    ds_read_b128 a[108:111], v65 offset:30720
    v_mfma_f32_16x16x32_bf16 v[216:219], a[244:247], a[148:151], v[216:219]
    ds_read_b128 a[112:115], v64 offset:32768
    v_mfma_f32_16x16x32_bf16 v[156:159], a[248:251], a[128:131], v[156:159]
    ds_read_b128 a[116:119], v65 offset:32768
    v_mfma_f32_16x16x32_bf16 v[156:159], a[252:255], a[132:135], v[156:159]
    ds_read_b128 a[120:123], v66 offset:28672
    v_mfma_f32_16x16x32_bf16 v[188:191], a[248:251], a[136:139], v[188:191]
    ds_read_b128 a[124:127], v67 offset:28672
    v_mfma_f32_16x16x32_bf16 v[188:191], a[252:255], a[140:143], v[188:191]
    ds_read_b64_tr_b16 a[200:201], v69 offset:16384
    v_mfma_f32_16x16x32_bf16 v[220:223], a[248:251], a[144:147], v[220:223]
    ds_read_b64_tr_b16 a[202:203], v69 offset:17408
    v_mfma_f32_16x16x32_bf16 v[220:223], a[252:255], a[148:151], v[220:223]
    s_waitcnt lgkmcnt(7)
    ds_read_b64_tr_b16 a[204:205], v69 offset:24576
    v_mfma_f32_16x16x32_bf16 v[128:131], a[192:195], a[96:99], v[128:131]
    buffer_load_dwordx4 v13, s[32:35], s54 offen offset:1024 nt lds
    v_mfma_f32_16x16x32_bf16 v[128:131], a[196:199], a[100:103], v[128:131]
    ds_read_b64_tr_b16 a[206:207], v69 offset:25600
    v_mfma_f32_16x16x32_bf16 v[160:163], a[192:195], a[104:107], v[160:163]
    s_waitcnt lgkmcnt(6)
    ds_read_b64_tr_b16 a[208:209], v72 offset:16384
    v_mfma_f32_16x16x32_bf16 v[160:163], a[196:199], a[108:111], v[160:163]
    ds_read_b64_tr_b16 a[210:211], v72 offset:17408
    v_mfma_f32_16x16x32_bf16 v[192:195], a[192:195], a[112:115], v[192:195]
    buffer_load_dwordx4 v12, s[32:35], s54 offen offset:2048 nt lds
    v_mfma_f32_16x16x32_bf16 v[192:195], a[196:199], a[116:119], v[192:195]
    s_waitcnt lgkmcnt(5)
    ds_read_b64_tr_b16 a[212:213], v72 offset:24576
    v_mfma_f32_16x16x32_bf16 v[224:227], a[192:195], a[120:123], v[224:227]
    ds_read_b64_tr_b16 a[214:215], v72 offset:25600
    v_mfma_f32_16x16x32_bf16 v[224:227], a[196:199], a[124:127], v[224:227]
    s_waitcnt lgkmcnt(5)
    ds_read_b64_tr_b16 a[216:217], v73 offset:16384
    v_mfma_f32_16x16x32_bf16 v[132:135], a[200:203], a[96:99], v[132:135]
    s_waitcnt lgkmcnt(5)
    ds_read_b64_tr_b16 a[218:219], v73 offset:17408
    v_mfma_f32_16x16x32_bf16 v[132:135], a[204:207], a[100:103], v[132:135]
    ds_read_b64_tr_b16 a[220:221], v73 offset:24576
    v_mfma_f32_16x16x32_bf16 v[164:167], a[200:203], a[104:107], v[164:167]
    ds_read_b64_tr_b16 a[222:223], v73 offset:25600
    v_mfma_f32_16x16x32_bf16 v[164:167], a[204:207], a[108:111], v[164:167]
    buffer_load_dwordx4 v13, s[32:35], s54 offen offset:3072 nt lds
    v_mfma_f32_16x16x32_bf16 v[196:199], a[200:203], a[112:115], v[196:199]
    v_mfma_f32_16x16x32_bf16 v[196:199], a[204:207], a[116:119], v[196:199]
    v_mfma_f32_16x16x32_bf16 v[228:231], a[200:203], a[120:123], v[228:231]
    v_mfma_f32_16x16x32_bf16 v[228:231], a[204:207], a[124:127], v[228:231]
    s_waitcnt vmcnt(8) lgkmcnt(0)
    v_mfma_f32_16x16x32_bf16 v[144:147], a[208:211], a[96:99], v[144:147]
    s_barrier
    ds_read_b64_tr_b16 a[224:225], v68 offset:0
    v_mfma_f32_16x16x32_bf16 v[144:147], a[212:215], a[100:103], v[144:147]
    ds_read_b64_tr_b16 a[226:227], v68 offset:1024
    v_mfma_f32_16x16x32_bf16 v[176:179], a[208:211], a[104:107], v[176:179]
    ds_read_b128 a[128:131], v64 offset:0
    v_mfma_f32_16x16x32_bf16 v[176:179], a[212:215], a[108:111], v[176:179]
    ds_read_b64_tr_b16 a[228:229], v68 offset:8192
    v_mfma_f32_16x16x32_bf16 v[208:211], a[208:211], a[112:115], v[208:211]
    ds_read_b64_tr_b16 a[230:231], v68 offset:9216
    v_mfma_f32_16x16x32_bf16 v[208:211], a[212:215], a[116:119], v[208:211]
    ds_read_b128 a[132:135], v65 offset:0
    v_mfma_f32_16x16x32_bf16 v[232:235], a[208:211], a[120:123], v[232:235]
    ds_read_b128 a[136:139], v64 offset:2048
    v_mfma_f32_16x16x32_bf16 v[232:235], a[212:215], a[124:127], v[232:235]
    s_add_u32 m0, s15, 0x20000
    ds_read_b128 a[140:143], v65 offset:2048
    v_mfma_f32_16x16x32_bf16 v[148:151], a[216:219], a[96:99], v[148:151]
    s_add_u32 s54, s12, 0x4000
    ds_read_b128 a[144:147], v64 offset:4096
    v_mfma_f32_16x16x32_bf16 v[148:151], a[220:223], a[100:103], v[148:151]
    buffer_load_dwordx4 v8, s[28:31], s54 offen offset:0 nt lds
    v_mfma_f32_16x16x32_bf16 v[180:183], a[216:219], a[104:107], v[180:183]
    ds_read_b128 a[148:151], v65 offset:4096
    v_mfma_f32_16x16x32_bf16 v[180:183], a[220:223], a[108:111], v[180:183]
    ds_read_b128 a[152:155], v66 offset:0
    v_mfma_f32_16x16x32_bf16 v[212:215], a[216:219], a[112:115], v[212:215]
    ds_read_b128 a[156:159], v67 offset:0
    v_mfma_f32_16x16x32_bf16 v[212:215], a[220:223], a[116:119], v[212:215]
    ds_read_b64_tr_b16 a[232:233], v69 offset:0
    v_mfma_f32_16x16x32_bf16 v[236:239], a[216:219], a[120:123], v[236:239]
    ds_read_b64_tr_b16 a[234:235], v69 offset:1024
    v_mfma_f32_16x16x32_bf16 v[236:239], a[220:223], a[124:127], v[236:239]
    s_waitcnt lgkmcnt(6)
    ds_read_b64_tr_b16 a[236:237], v69 offset:8192
    v_mfma_f32_16x16x32_bf16 v[128:131], a[224:227], a[128:131], v[128:131]
    ds_read_b64_tr_b16 a[238:239], v69 offset:9216
    v_mfma_f32_16x16x32_bf16 v[128:131], a[228:231], a[132:135], v[128:131]
    buffer_load_dwordx4 v9, s[28:31], s54 offen offset:1024 nt lds
    v_mfma_f32_16x16x32_bf16 v[160:163], a[224:227], a[136:139], v[160:163]
    ds_read_b64_tr_b16 a[240:241], v72 offset:0
    v_mfma_f32_16x16x32_bf16 v[160:163], a[228:231], a[140:143], v[160:163]
    s_waitcnt lgkmcnt(6)
    ds_read_b64_tr_b16 a[242:243], v72 offset:1024
    v_mfma_f32_16x16x32_bf16 v[192:195], a[224:227], a[144:147], v[192:195]
    ds_read_b64_tr_b16 a[244:245], v72 offset:8192
    v_mfma_f32_16x16x32_bf16 v[192:195], a[228:231], a[148:151], v[192:195]
    s_waitcnt lgkmcnt(6)
    ds_read_b64_tr_b16 a[246:247], v72 offset:9216
    v_mfma_f32_16x16x32_bf16 v[224:227], a[224:227], a[152:155], v[224:227]
    buffer_load_dwordx4 v10, s[28:31], s54 offen offset:2048 nt lds
    v_mfma_f32_16x16x32_bf16 v[224:227], a[228:231], a[156:159], v[224:227]
    s_waitcnt lgkmcnt(5)
    ds_read_b64_tr_b16 a[248:249], v73 offset:0
    v_mfma_f32_16x16x32_bf16 v[132:135], a[232:235], a[128:131], v[132:135]
    s_waitcnt lgkmcnt(5)
    ds_read_b64_tr_b16 a[250:251], v73 offset:1024
    v_mfma_f32_16x16x32_bf16 v[132:135], a[236:239], a[132:135], v[132:135]
    ds_read_b64_tr_b16 a[252:253], v73 offset:8192
    v_mfma_f32_16x16x32_bf16 v[164:167], a[232:235], a[136:139], v[164:167]
    ds_read_b64_tr_b16 a[254:255], v73 offset:9216
    v_mfma_f32_16x16x32_bf16 v[164:167], a[236:239], a[140:143], v[164:167]
    ds_read_b64_tr_b16 a[192:193], v70 offset:16384
    v_mfma_f32_16x16x32_bf16 v[196:199], a[232:235], a[144:147], v[196:199]
    ds_read_b64_tr_b16 a[194:195], v70 offset:17408
    v_mfma_f32_16x16x32_bf16 v[196:199], a[236:239], a[148:151], v[196:199]
    ds_read_b64_tr_b16 a[196:197], v70 offset:24576
    v_mfma_f32_16x16x32_bf16 v[228:231], a[232:235], a[152:155], v[228:231]
    ds_read_b64_tr_b16 a[198:199], v70 offset:25600
    v_pk_mul_f32 v[128:129], v[128:129], s[52:53] op_sel_hi:[1,0]
    v_pk_mul_f32 v[130:131], v[130:131], s[52:53] op_sel_hi:[1,0]
    v_pk_mul_f32 v[132:133], v[132:133], s[52:53] op_sel_hi:[1,0]
    v_pk_mul_f32 v[134:135], v[134:135], s[52:53] op_sel_hi:[1,0]
    v_mfma_f32_16x16x32_bf16 v[228:231], a[236:239], a[156:159], v[228:231]
    s_waitcnt lgkmcnt(7)
    ds_read_b64_tr_b16 a[200:201], v70 offset:0
    v_cvt_pk_bf16_f32 v128, v128, v129
    v_cvt_pk_bf16_f32 v129, v130, v131
    v_mfma_f32_16x16x32_bf16 v[144:147], a[240:243], a[128:131], v[144:147]
    buffer_load_dwordx4 v11, s[28:31], s54 offen offset:3072 nt lds
    v_cvt_pk_bf16_f32 v130, v132, v133
    v_mfma_f32_16x16x32_bf16 v[144:147], a[244:247], a[132:135], v[144:147]
    ds_read_b64_tr_b16 a[202:203], v70 offset:1024
    v_cvt_pk_bf16_f32 v131, v134, v135
    v_mfma_f32_16x16x32_bf16 v[176:179], a[240:243], a[136:139], v[176:179]
    ds_read_b64_tr_b16 a[204:205], v70 offset:8192
    v_pk_mul_f32 v[224:225], v[224:225], s[52:53] op_sel_hi:[1,0]
    v_pk_mul_f32 v[226:227], v[226:227], s[52:53] op_sel_hi:[1,0]
    v_pk_mul_f32 v[228:229], v[228:229], s[52:53] op_sel_hi:[1,0]
    v_pk_mul_f32 v[230:231], v[230:231], s[52:53] op_sel_hi:[1,0]
    v_mfma_f32_16x16x32_bf16 v[176:179], a[244:247], a[140:143], v[176:179]
    ds_read_b64_tr_b16 a[206:207], v70 offset:9216
    v_permlane16_swap_b32 v128, v130
    v_mfma_f32_16x16x32_bf16 v[208:211], a[240:243], a[144:147], v[208:211]
    ds_read_b64_tr_b16 a[208:209], v71 offset:16384
    v_permlane16_swap_b32 v129, v131
    v_mfma_f32_16x16x32_bf16 v[208:211], a[244:247], a[148:151], v[208:211]
    ds_read_b64_tr_b16 a[210:211], v71 offset:17408
    v_accvgpr_write_b32 a0, v128
    v_accvgpr_write_b32 a1, v129
    v_mfma_f32_16x16x32_bf16 v[232:235], a[240:243], a[152:155], v[232:235]
    s_waitcnt lgkmcnt(6)
    ds_read_b64_tr_b16 a[212:213], v71 offset:24576
    v_accvgpr_write_b32 a2, v130
    v_accvgpr_write_b32 a3, v131
    v_cvt_pk_bf16_f32 v224, v224, v225
    v_mfma_f32_16x16x32_bf16 v[232:235], a[244:247], a[156:159], v[232:235]
    s_add_u32 m0, s15, 0x10000
    ds_read_b64_tr_b16 a[214:215], v71 offset:25600
    v_cvt_pk_bf16_f32 v225, v226, v227
    v_cvt_pk_bf16_f32 v226, v228, v229
    v_mfma_f32_16x16x32_bf16 v[148:151], a[248:251], a[128:131], v[148:151]
    s_add_u32 s54, s12, 0x4000
    ds_read_b64_tr_b16 a[216:217], v71 offset:0
    v_cvt_pk_bf16_f32 v227, v230, v231
    v_pk_mul_f32 v[160:161], v[160:161], s[52:53] op_sel_hi:[1,0]
    v_pk_mul_f32 v[162:163], v[162:163], s[52:53] op_sel_hi:[1,0]
    v_pk_mul_f32 v[164:165], v[164:165], s[52:53] op_sel_hi:[1,0]
    v_pk_mul_f32 v[166:167], v[166:167], s[52:53] op_sel_hi:[1,0]
    v_mfma_f32_16x16x32_bf16 v[148:151], a[252:255], a[132:135], v[148:151]
    buffer_load_dwordx4 v12, s[32:35], s54 offen offset:0 nt lds
    v_permlane16_swap_b32 v224, v226
    v_mfma_f32_16x16x32_bf16 v[180:183], a[248:251], a[136:139], v[180:183]
    ds_read_b64_tr_b16 a[218:219], v71 offset:1024
    v_permlane16_swap_b32 v225, v227
    v_mfma_f32_16x16x32_bf16 v[180:183], a[252:255], a[140:143], v[180:183]
    ds_read_b64_tr_b16 a[220:221], v71 offset:8192
    v_accvgpr_write_b32 a48, v224
    v_accvgpr_write_b32 a49, v225
    v_mfma_f32_16x16x32_bf16 v[212:215], a[248:251], a[144:147], v[212:215]
    ds_read_b64_tr_b16 a[222:223], v71 offset:9216
    v_accvgpr_write_b32 a50, v226
    v_accvgpr_write_b32 a51, v227
    v_mfma_f32_16x16x32_bf16 v[212:215], a[252:255], a[148:151], v[212:215]
    ds_read_b64_tr_b16 a[224:225], v74 offset:16384
    v_cvt_pk_bf16_f32 v160, v160, v161
    v_cvt_pk_bf16_f32 v161, v162, v163
    v_mfma_f32_16x16x32_bf16 v[236:239], a[248:251], a[152:155], v[236:239]
    ds_read_b64_tr_b16 a[226:227], v74 offset:17408
    v_cvt_pk_bf16_f32 v162, v164, v165
    v_cvt_pk_bf16_f32 v163, v166, v167
    v_pk_mul_f32 v[192:193], v[192:193], s[52:53] op_sel_hi:[1,0]
    v_pk_mul_f32 v[194:195], v[194:195], s[52:53] op_sel_hi:[1,0]
    v_pk_mul_f32 v[196:197], v[196:197], s[52:53] op_sel_hi:[1,0]
    v_pk_mul_f32 v[198:199], v[198:199], s[52:53] op_sel_hi:[1,0]
    v_mfma_f32_16x16x32_bf16 v[236:239], a[252:255], a[156:159], v[236:239]
    ds_read_b64_tr_b16 a[228:229], v74 offset:24576
    v_permlane16_swap_b32 v160, v162
    v_mfma_f32_16x16x32_bf16 v[136:139], a[192:195], a[96:99], v[136:139]
    ds_read_b64_tr_b16 a[230:231], v74 offset:25600
    v_permlane16_swap_b32 v161, v163
    v_mfma_f32_16x16x32_bf16 v[136:139], a[196:199], a[100:103], v[136:139]
    s_waitcnt lgkmcnt(7)
    ds_read_b64_tr_b16 a[232:233], v74 offset:0
    v_accvgpr_write_b32 a16, v160
    v_accvgpr_write_b32 a17, v161
    v_mfma_f32_16x16x32_bf16 v[136:139], a[200:203], a[128:131], v[136:139]
    ds_read_b64_tr_b16 a[234:235], v74 offset:1024
    v_accvgpr_write_b32 a18, v162
    v_accvgpr_write_b32 a19, v163
    v_mfma_f32_16x16x32_bf16 v[136:139], a[204:207], a[132:135], v[136:139]
    buffer_load_dwordx4 v13, s[32:35], s54 offen offset:1024 nt lds
    v_cvt_pk_bf16_f32 v192, v192, v193
    v_mfma_f32_16x16x32_bf16 v[168:171], a[192:195], a[104:107], v[168:171]
    ds_read_b64_tr_b16 a[236:237], v74 offset:8192
    v_cvt_pk_bf16_f32 v193, v194, v195
    v_cvt_pk_bf16_f32 v194, v196, v197
    v_mfma_f32_16x16x32_bf16 v[168:171], a[196:199], a[108:111], v[168:171]
    ds_read_b64_tr_b16 a[238:239], v74 offset:9216
    v_cvt_pk_bf16_f32 v195, v198, v199
    v_pk_mul_f32 v[232:233], v[232:233], s[52:53] op_sel_hi:[1,0]
    v_pk_mul_f32 v[234:235], v[234:235], s[52:53] op_sel_hi:[1,0]
    v_pk_mul_f32 v[236:237], v[236:237], s[52:53] op_sel_hi:[1,0]
    v_pk_mul_f32 v[238:239], v[238:239], s[52:53] op_sel_hi:[1,0]
    v_mfma_f32_16x16x32_bf16 v[168:171], a[200:203], a[136:139], v[168:171]
L_pad2:
    s_cbranch_execz L_pad6
    ds_read_b64_tr_b16 a[240:241], v75 offset:16384
    v_permlane16_swap_b32 v192, v194
    v_mfma_f32_16x16x32_bf16 v[168:171], a[204:207], a[140:143], v[168:171]
    ds_read_b64_tr_b16 a[242:243], v75 offset:17408
    v_permlane16_swap_b32 v193, v195
    v_mfma_f32_16x16x32_bf16 v[200:203], a[192:195], a[112:115], v[200:203]
    ds_read_b64_tr_b16 a[244:245], v75 offset:24576
    v_accvgpr_write_b32 a32, v192
    v_accvgpr_write_b32 a33, v193
    v_mfma_f32_16x16x32_bf16 v[200:203], a[196:199], a[116:119], v[200:203]
    ds_read_b64_tr_b16 a[246:247], v75 offset:25600
    v_accvgpr_write_b32 a34, v194
    v_accvgpr_write_b32 a35, v195
    v_mfma_f32_16x16x32_bf16 v[200:203], a[200:203], a[144:147], v[200:203]
    ds_read_b64_tr_b16 a[248:249], v75 offset:0
    v_cvt_pk_bf16_f32 v232, v232, v233
    v_cvt_pk_bf16_f32 v233, v234, v235
    v_mfma_f32_16x16x32_bf16 v[200:203], a[204:207], a[148:151], v[200:203]
    ds_read_b64_tr_b16 a[250:251], v75 offset:1024
    v_cvt_pk_bf16_f32 v234, v236, v237
    v_cvt_pk_bf16_f32 v235, v238, v239
    v_pk_mul_f32 v[144:145], v[144:145], s[52:53] op_sel_hi:[1,0]
    v_pk_mul_f32 v[146:147], v[146:147], s[52:53] op_sel_hi:[1,0]
    v_pk_mul_f32 v[148:149], v[148:149], s[52:53] op_sel_hi:[1,0]
    v_pk_mul_f32 v[150:151], v[150:151], s[52:53] op_sel_hi:[1,0]
    v_mfma_f32_16x16x32_bf16 v[140:143], a[208:211], a[96:99], v[140:143]
    buffer_load_dwordx4 v12, s[32:35], s54 offen offset:2048 nt lds
    v_permlane16_swap_b32 v232, v234
    v_mfma_f32_16x16x32_bf16 v[140:143], a[212:215], a[100:103], v[140:143]
    s_waitcnt lgkmcnt(6)
    ds_read_b64_tr_b16 a[252:253], v75 offset:8192
    v_permlane16_swap_b32 v233, v235
    v_mfma_f32_16x16x32_bf16 v[140:143], a[216:219], a[128:131], v[140:143]
    ds_read_b64_tr_b16 a[254:255], v75 offset:9216
    v_accvgpr_write_b32 a56, v232
    v_accvgpr_write_b32 a57, v233
    v_mfma_f32_16x16x32_bf16 v[140:143], a[220:223], a[132:135], v[140:143]
    v_accvgpr_write_b32 a58, v234
    v_accvgpr_write_b32 a59, v235
    v_cvt_pk_bf16_f32 v144, v144, v145
    v_mfma_f32_16x16x32_bf16 v[172:175], a[208:211], a[104:107], v[172:175]
    v_cvt_pk_bf16_f32 v145, v146, v147
    v_cvt_pk_bf16_f32 v146, v148, v149
    v_cvt_pk_bf16_f32 v147, v150, v151
    v_pk_mul_f32 v[176:177], v[176:177], s[52:53] op_sel_hi:[1,0]
    v_pk_mul_f32 v[178:179], v[178:179], s[52:53] op_sel_hi:[1,0]
    v_pk_mul_f32 v[180:181], v[180:181], s[52:53] op_sel_hi:[1,0]
    v_pk_mul_f32 v[182:183], v[182:183], s[52:53] op_sel_hi:[1,0]
    v_mfma_f32_16x16x32_bf16 v[172:175], a[212:215], a[108:111], v[172:175]
    v_permlane16_swap_b32 v144, v146
    v_permlane16_swap_b32 v145, v147
    v_mfma_f32_16x16x32_bf16 v[172:175], a[216:219], a[136:139], v[172:175]
    v_accvgpr_write_b32 a8, v144
    v_accvgpr_write_b32 a9, v145
    v_accvgpr_write_b32 a10, v146
    v_mfma_f32_16x16x32_bf16 v[172:175], a[220:223], a[140:143], v[172:175]
    v_accvgpr_write_b32 a11, v147
    v_cvt_pk_bf16_f32 v176, v176, v177
    v_cvt_pk_bf16_f32 v177, v178, v179
    v_mfma_f32_16x16x32_bf16 v[204:207], a[208:211], a[112:115], v[204:207]
    v_cvt_pk_bf16_f32 v178, v180, v181
    v_cvt_pk_bf16_f32 v179, v182, v183
    v_pk_mul_f32 v[208:209], v[208:209], s[52:53] op_sel_hi:[1,0]
    v_pk_mul_f32 v[210:211], v[210:211], s[52:53] op_sel_hi:[1,0]
    v_pk_mul_f32 v[212:213], v[212:213], s[52:53] op_sel_hi:[1,0]
    v_pk_mul_f32 v[214:215], v[214:215], s[52:53] op_sel_hi:[1,0]
    v_mfma_f32_16x16x32_bf16 v[204:207], a[212:215], a[116:119], v[204:207]
    ds_write_b128 v21, v[224:227] offset:0
    v_permlane16_swap_b32 v176, v178
    v_mfma_f32_16x16x32_bf16 v[204:207], a[216:219], a[144:147], v[204:207]
    buffer_load_dwordx4 v13, s[32:35], s54 offen offset:3072 nt lds
    v_permlane16_swap_b32 v177, v179
    v_mfma_f32_16x16x32_bf16 v[204:207], a[220:223], a[148:151], v[204:207]
    v_accvgpr_write_b32 a24, v176
    v_accvgpr_write_b32 a25, v177
    v_accvgpr_write_b32 a26, v178
    v_mfma_f32_16x16x32_bf16 v[152:155], a[224:227], a[96:99], v[152:155]
    ds_write_b128 v21, v[232:235] offset:1024
    v_accvgpr_write_b32 a27, v179
    v_cvt_pk_bf16_f32 v208, v208, v209
    v_mfma_f32_16x16x32_bf16 v[152:155], a[228:231], a[100:103], v[152:155]
    v_cvt_pk_bf16_f32 v209, v210, v211
    v_cvt_pk_bf16_f32 v210, v212, v213
    v_cvt_pk_bf16_f32 v211, v214, v215
    v_pk_mul_f32 v[136:137], v[136:137], s[52:53] op_sel_hi:[1,0]
    v_pk_mul_f32 v[138:139], v[138:139], s[52:53] op_sel_hi:[1,0]
    v_pk_mul_f32 v[140:141], v[140:141], s[52:53] op_sel_hi:[1,0]
    v_pk_mul_f32 v[142:143], v[142:143], s[52:53] op_sel_hi:[1,0]
    v_mfma_f32_16x16x32_bf16 v[152:155], a[232:235], a[128:131], v[152:155]
    v_permlane16_swap_b32 v208, v210
    v_permlane16_swap_b32 v209, v211
    v_mfma_f32_16x16x32_bf16 v[152:155], a[236:239], a[132:135], v[152:155]
    v_accvgpr_write_b32 a40, v208
    v_accvgpr_write_b32 a41, v209
    v_accvgpr_write_b32 a42, v210
    v_mfma_f32_16x16x32_bf16 v[184:187], a[224:227], a[104:107], v[184:187]
    v_accvgpr_write_b32 a43, v211
    v_cvt_pk_bf16_f32 v136, v136, v137
    v_cvt_pk_bf16_f32 v137, v138, v139
    v_mfma_f32_16x16x32_bf16 v[184:187], a[228:231], a[108:111], v[184:187]
    s_waitcnt vmcnt(12) lgkmcnt(0)
    v_cvt_pk_bf16_f32 v138, v140, v141
    v_cvt_pk_bf16_f32 v139, v142, v143
    v_pk_mul_f32 v[168:169], v[168:169], s[52:53] op_sel_hi:[1,0]
    v_pk_mul_f32 v[170:171], v[170:171], s[52:53] op_sel_hi:[1,0]
    v_pk_mul_f32 v[172:173], v[172:173], s[52:53] op_sel_hi:[1,0]
    v_pk_mul_f32 v[174:175], v[174:175], s[52:53] op_sel_hi:[1,0]
    v_mfma_f32_16x16x32_bf16 v[184:187], a[232:235], a[136:139], v[184:187]
    s_barrier
    ds_read_b128 a[192:195], v22 offset:49152
    v_permlane16_swap_b32 v136, v138
    v_mfma_f32_16x16x32_bf16 v[184:187], a[236:239], a[140:143], v[184:187]
    buffer_atomic_and v49, v19, s[48:51], s62 offen
    v_permlane16_swap_b32 v137, v139
    v_mfma_f32_16x16x32_bf16 v[216:219], a[224:227], a[112:115], v[216:219]
    ds_read_b128 a[196:199], v24 offset:49152
    v_accvgpr_write_b32 a4, v136
    v_accvgpr_write_b32 a5, v137
    v_mfma_f32_16x16x32_bf16 v[216:219], a[228:231], a[116:119], v[216:219]
    ds_read_b128 a[52:55], v53 offset:0
    v_accvgpr_write_b32 a6, v138
    v_accvgpr_write_b32 a7, v139
    v_mfma_f32_16x16x32_bf16 v[216:219], a[232:235], a[144:147], v[216:219]
    ds_read_b128 a[60:63], v53 offset:1024
    v_cvt_pk_bf16_f32 v168, v168, v169
    v_cvt_pk_bf16_f32 v169, v170, v171
    v_mfma_f32_16x16x32_bf16 v[216:219], a[236:239], a[148:151], v[216:219]
    ds_read_b128 a[200:203], v23 offset:49152
    v_cvt_pk_bf16_f32 v170, v172, v173
    v_cvt_pk_bf16_f32 v171, v174, v175
    v_pk_mul_f32 v[200:201], v[200:201], s[52:53] op_sel_hi:[1,0]
    v_pk_mul_f32 v[202:203], v[202:203], s[52:53] op_sel_hi:[1,0]
    v_pk_mul_f32 v[204:205], v[204:205], s[52:53] op_sel_hi:[1,0]
    v_pk_mul_f32 v[206:207], v[206:207], s[52:53] op_sel_hi:[1,0]
    v_mfma_f32_16x16x32_bf16 v[156:159], a[240:243], a[96:99], v[156:159]
    ds_read_b128 a[204:207], v252 offset:49152
    v_permlane16_swap_b32 v168, v170
    v_mfma_f32_16x16x32_bf16 v[156:159], a[244:247], a[100:103], v[156:159]
    s_add_u32 m0, s15, 0x1c000
    ds_read_b128 a[208:211], v253 offset:49152
    v_permlane16_swap_b32 v169, v171
    v_mfma_f32_16x16x32_bf16 v[156:159], a[248:251], a[128:131], v[156:159]
    s_add_u32 s54, s12, 0x8000
    ds_read_b128 a[212:215], v254 offset:49152
    v_accvgpr_write_b32 a20, v168
    v_accvgpr_write_b32 a21, v169
    v_mfma_f32_16x16x32_bf16 v[156:159], a[252:255], a[132:135], v[156:159]
    buffer_load_dwordx4 v8, s[28:31], s54 offen offset:0 nt lds
    v_accvgpr_write_b32 a22, v170
    v_mfma_f32_16x16x32_bf16 v[188:191], a[240:243], a[104:107], v[188:191]
    ds_read_b128 a[216:219], v255 offset:49152
    v_accvgpr_write_b32 a23, v171
    v_cvt_pk_bf16_f32 v200, v200, v201
    v_mfma_f32_16x16x32_bf16 v[188:191], a[244:247], a[108:111], v[188:191]
    ds_read_b128 a[220:223], v25 offset:49152
    v_cvt_pk_bf16_f32 v201, v202, v203
    v_cvt_pk_bf16_f32 v202, v204, v205
    v_mfma_f32_16x16x32_bf16 v[188:191], a[248:251], a[136:139], v[188:191]
    ds_read_b128 a[224:227], v22 offset:53248
    v_cvt_pk_bf16_f32 v203, v206, v207
    v_pk_mul_f32 v[152:153], v[152:153], s[52:53] op_sel_hi:[1,0]
    v_pk_mul_f32 v[154:155], v[154:155], s[52:53] op_sel_hi:[1,0]
    v_pk_mul_f32 v[156:157], v[156:157], s[52:53] op_sel_hi:[1,0]
    v_pk_mul_f32 v[158:159], v[158:159], s[52:53] op_sel_hi:[1,0]
    v_mfma_f32_16x16x32_bf16 v[188:191], a[252:255], a[140:143], v[188:191]
    ds_read_b128 a[228:231], v24 offset:53248
    v_permlane16_swap_b32 v200, v202
    v_mfma_f32_16x16x32_bf16 v[220:223], a[240:243], a[112:115], v[220:223]
    ds_read_b128 a[232:235], v23 offset:53248
    v_permlane16_swap_b32 v201, v203
    v_mfma_f32_16x16x32_bf16 v[220:223], a[244:247], a[116:119], v[220:223]
    ds_read_b128 a[236:239], v25 offset:53248
    v_accvgpr_write_b32 a36, v200
    v_accvgpr_write_b32 a37, v201
    v_mfma_f32_16x16x32_bf16 v[220:223], a[248:251], a[144:147], v[220:223]
    ds_read_b128 a[240:243], v26 offset:49152
    v_accvgpr_write_b32 a38, v202
    v_accvgpr_write_b32 a39, v203
    v_mfma_f32_16x16x32_bf16 v[220:223], a[252:255], a[148:151], v[220:223]
    s_waitcnt lgkmcnt(7)
    ds_read_b128 a[244:247], v27 offset:49152
    v_cvt_pk_bf16_f32 v152, v152, v153
    v_cvt_pk_bf16_f32 v153, v154, v155
    v_mfma_f32_16x16x32_bf16 v[56:59], a[192:195], a[0:3], 0
    ds_read_b128 a[248:251], v28 offset:49152
    v_cvt_pk_bf16_f32 v154, v156, v157
    v_cvt_pk_bf16_f32 v155, v158, v159
    v_pk_mul_f32 v[184:185], v[184:185], s[52:53] op_sel_hi:[1,0]
    v_pk_mul_f32 v[186:187], v[186:187], s[52:53] op_sel_hi:[1,0]
    v_pk_mul_f32 v[188:189], v[188:189], s[52:53] op_sel_hi:[1,0]
    v_pk_mul_f32 v[190:191], v[190:191], s[52:53] op_sel_hi:[1,0]
    v_mfma_f32_16x16x32_bf16 v[64:67], a[192:195], a[16:19], 0
    ds_read_b128 a[252:255], v29 offset:49152
    v_permlane16_swap_b32 v152, v154
    v_mfma_f32_16x16x32_bf16 v[72:75], a[192:195], a[32:35], 0
    v_permlane16_swap_b32 v153, v155
    v_accvgpr_write_b32 a12, v152
    v_mfma_f32_16x16x32_bf16 v[80:83], a[192:195], a[48:51], 0
    ds_read_b128 a[192:195], v26 offset:53248
    v_accvgpr_write_b32 a13, v153
    v_accvgpr_write_b32 a14, v154
    v_mfma_f32_16x16x32_bf16 v[56:59], a[196:199], a[8:11], v[56:59]
    v_accvgpr_write_b32 a15, v155
    v_cvt_pk_bf16_f32 v184, v184, v185
    v_cvt_pk_bf16_f32 v185, v186, v187
    v_mfma_f32_16x16x32_bf16 v[64:67], a[196:199], a[24:27], v[64:67]
    v_cvt_pk_bf16_f32 v186, v188, v189
    v_cvt_pk_bf16_f32 v187, v190, v191
    v_pk_mul_f32 v[216:217], v[216:217], s[52:53] op_sel_hi:[1,0]
    v_pk_mul_f32 v[218:219], v[218:219], s[52:53] op_sel_hi:[1,0]
    v_pk_mul_f32 v[220:221], v[220:221], s[52:53] op_sel_hi:[1,0]
    v_pk_mul_f32 v[222:223], v[222:223], s[52:53] op_sel_hi:[1,0]
    v_mfma_f32_16x16x32_bf16 v[72:75], a[196:199], a[40:43], v[72:75]
    v_permlane16_swap_b32 v184, v186
    v_mfma_f32_16x16x32_bf16 v[80:83], a[196:199], a[56:59], v[80:83]
    buffer_load_dwordx4 v9, s[28:31], s54 offen offset:1024 nt lds
    v_mfma_f32_16x16x32_bf16 v[56:59], a[200:203], a[4:7], v[56:59]
    ds_read_b128 a[196:199], v27 offset:53248
    v_permlane16_swap_b32 v185, v187
    v_mfma_f32_16x16x32_bf16 v[64:67], a[200:203], a[20:23], v[64:67]
    v_accvgpr_write_b32 a28, v184
    v_accvgpr_write_b32 a29, v185
    v_mfma_f32_16x16x32_bf16 v[72:75], a[200:203], a[36:39], v[72:75]
    v_accvgpr_write_b32 a30, v186
    v_accvgpr_write_b32 a31, v187
    v_mfma_f32_16x16x32_bf16 v[80:83], a[200:203], a[52:55], v[80:83]
    ds_read_b128 a[200:203], v28 offset:53248
    v_cvt_pk_bf16_f32 v216, v216, v217
    v_mfma_f32_16x16x32_bf16 v[240:243], a[204:207], a[48:51], 0
    ds_read_b128 a[204:207], v29 offset:53248
    v_cvt_pk_bf16_f32 v217, v218, v219
    v_mfma_f32_16x16x32_bf16 v[240:243], a[208:211], a[52:55], v[240:243]
    v_cvt_pk_bf16_f32 v218, v220, v221
    v_cvt_pk_bf16_f32 v219, v222, v223
    v_mfma_f32_16x16x32_bf16 v[240:243], a[212:215], a[56:59], v[240:243]
    s_waitcnt lgkmcnt(3)
    v_permlane16_swap_b32 v216, v218
    v_mfma_f32_16x16x32_bf16 v[240:243], a[216:219], a[60:63], v[240:243]
    v_permlane16_swap_b32 v217, v219
    v_accvgpr_write_b32 a44, v216
    v_mfma_f32_16x16x32_bf16 v[56:59], a[220:223], a[12:15], v[56:59]
    v_accvgpr_write_b32 a45, v217
    v_accvgpr_write_b32 a46, v218
    v_accvgpr_write_b32 a47, v219
    v_mfma_f32_16x16x32_bf16 v[64:67], a[220:223], a[28:31], v[64:67]
    s_nop 0
    v_mfma_f32_16x16x32_bf16 v[72:75], a[220:223], a[44:47], v[72:75]
    v_max3_f32 v250, v240, v241, v242
    v_max_f32 v250, v250, v243
    v_mov_b32 v251, v250
    s_nop 1
    v_permlane16_swap_b32 v250, v251
    v_max_f32 v250, v250, v251
    v_mov_b32 v251, v250
    v_mfma_f32_16x16x32_bf16 v[80:83], a[220:223], a[60:63], v[80:83]
    s_nop 0
    v_permlane32_swap_b32 v250, v251
    v_max_f32 v250, v250, v251
    v_min_f32 v124, -v250, v124
    v_mov_b32 v125, v124
    v_mov_b32 v126, v124
    v_mov_b32 v127, v124
    v_max3_f32 v244, v56, v57, v58
    v_max3_f32 v246, v64, v65, v66
    v_max3_f32 v248, v72, v73, v74
    v_max_f32 v244, v244, v59
    v_max_f32 v246, v246, v67
    v_max_f32 v248, v248, v75
    v_mov_b32 v245, v244
    v_mov_b32 v247, v246
    v_mov_b32 v249, v248
    v_permlane16_swap_b32 v244, v245
    v_permlane16_swap_b32 v246, v247
    v_permlane16_swap_b32 v248, v249
    v_max_f32 v244, v244, v245
    v_max_f32 v246, v246, v247
    v_max_f32 v248, v248, v249
    v_mov_b32 v245, v244
    v_mov_b32 v247, v246
    v_mov_b32 v249, v248
    v_permlane32_swap_b32 v244, v245
    v_permlane32_swap_b32 v246, v247
    v_permlane32_swap_b32 v248, v249
    v_max_f32 v244, v244, v245
    v_max_f32 v246, v246, v247
    v_max_f32 v248, v248, v249
    v_min_f32 v112, -v244, v112
    v_min_f32 v116, -v246, v116
    v_min_f32 v120, -v248, v120
    v_mov_b32 v113, v112
    v_mov_b32 v114, v112
    v_mov_b32 v115, v112
    s_nop 1
    v_mfma_f32_16x16x32_bf16 v[60:63], a[224:227], a[0:3], v[112:115]
    v_mov_b32 v117, v116
    v_mov_b32 v118, v116
    v_mov_b32 v119, v116
    s_nop 1
    v_mfma_f32_16x16x32_bf16 v[68:71], a[224:227], a[16:19], v[116:119]
    v_mov_b32 v121, v120
    v_mov_b32 v122, v120
    v_mov_b32 v123, v120
    s_nop 1
    v_mfma_f32_16x16x32_bf16 v[76:79], a[224:227], a[32:35], v[120:123]
    s_lshl_b32 s55, s59, 1
    v_add_f32 v56, v56, v112
    v_add_f32 v57, v57, v112
    v_add_f32 v58, v58, v112
    v_mfma_f32_16x16x32_bf16 v[84:87], a[224:227], a[48:51], v[124:127]
    s_sub_u32 s55, 1, s55
    v_add_f32 v59, v59, v112
    v_exp_f32 v56, v56
    v_mfma_f32_16x16x32_bf16 v[60:63], a[228:231], a[8:11], v[60:63]
    s_mul_i32 s55, s55, s100
    v_exp_f32 v57, v57
    v_mfma_f32_16x16x32_bf16 v[68:71], a[228:231], a[24:27], v[68:71]
    v_mov_b32 v47, s55
    v_exp_f32 v58, v58
    v_mfma_f32_16x16x32_bf16 v[76:79], a[228:231], a[40:43], v[76:79]
    buffer_load_dwordx4 v10, s[28:31], s54 offen offset:2048 nt lds
    v_mfma_f32_16x16x32_bf16 v[84:87], a[228:231], a[56:59], v[84:87]
    ds_write_b32 v46, v47
    v_exp_f32 v59, v59
    v_mfma_f32_16x16x32_bf16 v[60:63], a[232:235], a[4:7], v[60:63]
    v_cvt_pk_bf16_f32 v56, v56, v57
    v_cvt_pk_bf16_f32 v57, v58, v59
    v_add_f32 v64, v64, v116
    v_mfma_f32_16x16x32_bf16 v[68:71], a[232:235], a[20:23], v[68:71]
    v_add_f32 v65, v65, v116
    v_add_f32 v66, v66, v116
    v_add_f32 v67, v67, v116
    v_mfma_f32_16x16x32_bf16 v[76:79], a[232:235], a[36:39], v[76:79]
    v_exp_f32 v64, v64
    v_exp_f32 v65, v65
    v_mfma_f32_16x16x32_bf16 v[84:87], a[232:235], a[52:55], v[84:87]
    v_exp_f32 v66, v66
    v_mfma_f32_16x16x32_bf16 v[60:63], a[236:239], a[12:15], v[60:63]
    v_exp_f32 v67, v67
    v_cvt_pk_bf16_f32 v64, v64, v65
    v_mfma_f32_16x16x32_bf16 v[68:71], a[236:239], a[28:31], v[68:71]
    v_cvt_pk_bf16_f32 v65, v66, v67
    v_add_f32 v72, v72, v120
    v_add_f32 v73, v73, v120
    v_mfma_f32_16x16x32_bf16 v[76:79], a[236:239], a[44:47], v[76:79]
    v_add_f32 v74, v74, v120
    v_add_f32 v75, v75, v120
    v_exp_f32 v72, v72
    v_mfma_f32_16x16x32_bf16 v[84:87], a[236:239], a[60:63], v[84:87]
    v_exp_f32 v73, v73
    v_mfma_f32_16x16x32_bf16 v[88:91], a[240:243], a[0:3], v[112:115]
    v_exp_f32 v74, v74
    v_exp_f32 v75, v75
    v_mfma_f32_16x16x32_bf16 v[88:91], a[244:247], a[4:7], v[88:91]
    v_cvt_pk_bf16_f32 v72, v72, v73
    v_cvt_pk_bf16_f32 v73, v74, v75
    v_add_f32 v80, v80, v124
    v_mfma_f32_16x16x32_bf16 v[88:91], a[248:251], a[8:11], v[88:91]
    v_add_f32 v81, v81, v124
    v_add_f32 v82, v82, v124
    v_add_f32 v83, v83, v124
    v_mfma_f32_16x16x32_bf16 v[88:91], a[252:255], a[12:15], v[88:91]
    buffer_load_dwordx4 v11, s[28:31], s54 offen offset:3072 nt lds
    v_mfma_f32_16x16x32_bf16 v[96:99], a[240:243], a[16:19], v[116:119]
    v_exp_f32 v80, v80
    v_exp_f32 v81, v81
    v_mfma_f32_16x16x32_bf16 v[96:99], a[244:247], a[20:23], v[96:99]
    v_exp_f32 v82, v82
    v_mfma_f32_16x16x32_bf16 v[96:99], a[248:251], a[24:27], v[96:99]
    v_exp_f32 v83, v83
    v_cvt_pk_bf16_f32 v80, v80, v81
    v_mfma_f32_16x16x32_bf16 v[96:99], a[252:255], a[28:31], v[96:99]
    v_cvt_pk_bf16_f32 v81, v82, v83
    v_exp_f32 v60, v60
    v_mfma_f32_16x16x32_bf16 v[104:107], a[240:243], a[32:35], v[120:123]
    v_exp_f32 v61, v61
    v_exp_f32 v62, v62
    v_mfma_f32_16x16x32_bf16 v[104:107], a[244:247], a[36:39], v[104:107]
    v_exp_f32 v63, v63
    v_cvt_pk_bf16_f32 v58, v60, v61
    v_mfma_f32_16x16x32_bf16 v[104:107], a[248:251], a[40:43], v[104:107]
    s_waitcnt vmcnt(9) lgkmcnt(0)
    v_cvt_pk_bf16_f32 v59, v62, v63
    v_exp_f32 v68, v68
    v_mfma_f32_16x16x32_bf16 v[104:107], a[252:255], a[44:47], v[104:107]
    s_barrier
    ds_read_b64_tr_b16 a[208:209], v30 offset:49152
    v_exp_f32 v69, v69
    v_mfma_f32_16x16x32_bf16 v[92:95], a[192:195], a[0:3], v[112:115]
    ds_read_b64_tr_b16 a[210:211], v30 offset:53248
    v_exp_f32 v70, v70
    v_mfma_f32_16x16x32_bf16 v[92:95], a[196:199], a[4:7], v[92:95]
    ds_read_b64_tr_b16 a[212:213], v31 offset:49152
    v_exp_f32 v71, v71
    v_mfma_f32_16x16x32_bf16 v[92:95], a[200:203], a[8:11], v[92:95]
    ds_read_b64_tr_b16 a[214:215], v31 offset:53248
    v_cvt_pk_bf16_f32 v66, v68, v69
    v_cvt_pk_bf16_f32 v67, v70, v71
    v_mfma_f32_16x16x32_bf16 v[92:95], a[204:207], a[12:15], v[92:95]
    ds_read_b64_tr_b16 a[216:217], v32 offset:49152
    v_exp_f32 v76, v76
    v_mfma_f32_16x16x32_bf16 v[100:103], a[192:195], a[16:19], v[116:119]
    ds_read_b64_tr_b16 a[218:219], v32 offset:53248
    v_exp_f32 v77, v77
    v_mfma_f32_16x16x32_bf16 v[100:103], a[196:199], a[20:23], v[100:103]
    s_add_u32 m0, s15, 0xc000
    ds_read_b64_tr_b16 a[220:221], v33 offset:49152
    v_exp_f32 v78, v78
    v_mfma_f32_16x16x32_bf16 v[100:103], a[200:203], a[24:27], v[100:103]
    s_add_u32 s54, s12, 0x8000
    ds_read_b64_tr_b16 a[222:223], v33 offset:53248
    v_exp_f32 v79, v79
    v_mfma_f32_16x16x32_bf16 v[100:103], a[204:207], a[28:31], v[100:103]
    buffer_load_dwordx4 v12, s[32:35], s54 offen offset:0 nt lds
    v_cvt_pk_bf16_f32 v74, v76, v77
    v_mfma_f32_16x16x32_bf16 v[108:111], a[192:195], a[32:35], v[120:123]
    ds_read_b64_tr_b16 a[224:225], v34 offset:49152
    v_cvt_pk_bf16_f32 v75, v78, v79
    v_mfma_f32_16x16x32_bf16 v[108:111], a[196:199], a[36:39], v[108:111]
    ds_read_b64_tr_b16 a[226:227], v34 offset:53248
    v_exp_f32 v84, v84
    v_mfma_f32_16x16x32_bf16 v[108:111], a[200:203], a[40:43], v[108:111]
    ds_read_b64_tr_b16 a[228:229], v35 offset:49152
    v_exp_f32 v85, v85
    v_mfma_f32_16x16x32_bf16 v[108:111], a[204:207], a[44:47], v[108:111]
    s_waitcnt lgkmcnt(6)
    ds_read_b64_tr_b16 a[230:231], v35 offset:53248
    v_exp_f32 v86, v86
    v_mfma_f32_16x16x32_bf16 v[128:131], a[208:211], v[56:59], 0
    ds_read_b64_tr_b16 a[232:233], v36 offset:49152
    v_exp_f32 v87, v87
    v_mfma_f32_16x16x32_bf16 v[160:163], a[208:211], v[64:67], 0
    ds_read_b64_tr_b16 a[234:235], v36 offset:53248
    v_cvt_pk_bf16_f32 v82, v84, v85
    v_cvt_pk_bf16_f32 v83, v86, v87
    v_mfma_f32_16x16x32_bf16 v[192:195], a[208:211], v[72:75], 0
    v_exp_f32 v88, v88
    v_mfma_f32_16x16x32_bf16 v[224:227], a[208:211], v[80:83], 0
    ds_read_b64_tr_b16 a[236:237], v37 offset:49152
    v_mfma_f32_16x16x32_bf16 a[64:67], a[80:83], v[56:59], 0
    v_exp_f32 v89, v89
    v_mfma_f32_16x16x32_bf16 a[68:71], a[80:83], v[64:67], 0
    v_cvt_pk_bf16_f32 v88, v88, v89
    ds_read_b64_tr_b16 a[238:239], v37 offset:53248
    v_mfma_f32_16x16x32_bf16 a[72:75], a[80:83], v[72:75], 0
    v_exp_f32 v90, v90
    v_mfma_f32_16x16x32_bf16 a[76:79], a[80:83], v[80:83], 0
    ds_read_b128 a[240:243], v22 offset:32768
    v_mfma_f32_16x16x32_bf16 v[132:135], a[212:215], v[56:59], 0
    v_exp_f32 v91, v91
    v_mfma_f32_16x16x32_bf16 v[164:167], a[212:215], v[64:67], 0
    v_cvt_pk_bf16_f32 v89, v90, v91
    ds_read_b128 a[244:247], v23 offset:32768
    v_mfma_f32_16x16x32_bf16 v[196:199], a[212:215], v[72:75], 0
    buffer_load_dwordx4 v13, s[32:35], s54 offen offset:1024 nt lds
    v_mfma_f32_16x16x32_bf16 v[228:231], a[212:215], v[80:83], 0
    s_waitcnt lgkmcnt(3)
    v_exp_f32 v96, v96
    v_mfma_f32_16x16x32_bf16 v[136:139], a[216:219], v[56:59], 0
    ds_read_b128 a[248:251], v24 offset:32768
    v_mfma_f32_16x16x32_bf16 v[168:171], a[216:219], v[64:67], 0
    v_exp_f32 v97, v97
    v_mfma_f32_16x16x32_bf16 v[200:203], a[216:219], v[72:75], 0
    v_cvt_pk_bf16_f32 v96, v96, v97
    ds_read_b128 a[252:255], v25 offset:32768
    v_mfma_f32_16x16x32_bf16 v[232:235], a[216:219], v[80:83], 0
    v_exp_f32 v98, v98
    v_mfma_f32_16x16x32_bf16 v[140:143], a[220:223], v[56:59], 0
    ds_read_b128 a[192:195], v22 offset:36864
    v_mfma_f32_16x16x32_bf16 v[172:175], a[220:223], v[64:67], 0
    v_exp_f32 v99, v99
    v_mfma_f32_16x16x32_bf16 v[204:207], a[220:223], v[72:75], 0
    v_cvt_pk_bf16_f32 v97, v98, v99
    ds_read_b128 a[196:199], v23 offset:36864
    v_mfma_f32_16x16x32_bf16 v[236:239], a[220:223], v[80:83], 0
    v_exp_f32 v104, v104
    v_mfma_f32_16x16x32_bf16 v[144:147], a[224:227], v[56:59], 0
    ds_read_b128 a[200:203], v24 offset:36864
    v_mfma_f32_16x16x32_bf16 v[176:179], a[224:227], v[64:67], 0
    v_exp_f32 v105, v105
    v_mfma_f32_16x16x32_bf16 v[208:211], a[224:227], v[72:75], 0
    v_cvt_pk_bf16_f32 v104, v104, v105
    ds_read_b128 a[204:207], v25 offset:36864
    v_mfma_f32_16x16x32_bf16 v[240:243], a[224:227], v[80:83], 0
    v_exp_f32 v106, v106
    v_mfma_f32_16x16x32_bf16 v[148:151], a[228:231], v[56:59], 0
    buffer_load_dwordx4 v12, s[32:35], s54 offen offset:2048 nt lds
    v_mfma_f32_16x16x32_bf16 v[180:183], a[228:231], v[64:67], 0
    v_exp_f32 v107, v107
    v_mfma_f32_16x16x32_bf16 v[212:215], a[228:231], v[72:75], 0
    v_cvt_pk_bf16_f32 v105, v106, v107
    ds_read_b64_tr_b16 a[208:209], v38 offset:49152
    v_mfma_f32_16x16x32_bf16 v[244:247], a[228:231], v[80:83], 0
    v_exp_f32 v92, v92
    v_mfma_f32_16x16x32_bf16 v[152:155], a[232:235], v[56:59], 0
    ds_read_b64_tr_b16 a[210:211], v38 offset:53248
    v_mfma_f32_16x16x32_bf16 v[184:187], a[232:235], v[64:67], 0
    v_exp_f32 v93, v93
    v_mfma_f32_16x16x32_bf16 v[216:219], a[232:235], v[72:75], 0
    v_cvt_pk_bf16_f32 v90, v92, v93
    ds_read_b64_tr_b16 a[212:213], v39 offset:49152
    v_mfma_f32_16x16x32_bf16 v[248:251], a[232:235], v[80:83], 0
    s_waitcnt lgkmcnt(3)
    ds_read_b128 v[4:7], v48
    v_mfma_f32_16x16x32_bf16 v[156:159], a[236:239], v[56:59], 0
    v_exp_f32 v94, v94
    v_mfma_f32_16x16x32_bf16 v[188:191], a[236:239], v[64:67], 0
    ds_read_b64_tr_b16 a[214:215], v39 offset:53248
    v_mfma_f32_16x16x32_bf16 v[220:223], a[236:239], v[72:75], 0
    v_exp_f32 v95, v95
    v_mfma_f32_16x16x32_bf16 v[252:255], a[236:239], v[80:83], 0
    v_cvt_pk_bf16_f32 v91, v94, v95
    ds_read_b64_tr_b16 a[216:217], v40 offset:49152
    v_mfma_f32_16x16x32_bf16 v[56:59], a[240:243], a[0:3], v[112:115]
    v_exp_f32 v100, v100
    v_mfma_f32_16x16x32_bf16 v[56:59], a[244:247], a[4:7], v[56:59]
    ds_read_b64_tr_b16 a[218:219], v40 offset:53248
    v_mfma_f32_16x16x32_bf16 v[56:59], a[248:251], a[8:11], v[56:59]
    v_exp_f32 v101, v101
    v_mfma_f32_16x16x32_bf16 v[56:59], a[252:255], a[12:15], v[56:59]
    buffer_load_dwordx4 v13, s[32:35], s54 offen offset:3072 nt lds
    v_mfma_f32_16x16x32_bf16 v[64:67], a[240:243], a[16:19], v[116:119]
    v_exp_f32 v102, v102
    v_mfma_f32_16x16x32_bf16 v[64:67], a[244:247], a[20:23], v[64:67]
    s_waitcnt lgkmcnt(2)
    v_add3_u32 v4, v4, v5, v6
    v_add3_u32 v4, v4, v7, s101
    v_mfma_f32_16x16x32_bf16 v[64:67], a[248:251], a[24:27], v[64:67]
    v_cvt_pk_bf16_f32 v98, v100, v101
    ds_read_b64_tr_b16 a[220:221], v41 offset:49152
    v_mfma_f32_16x16x32_bf16 v[64:67], a[252:255], a[28:31], v[64:67]
    v_readfirstlane_b32 s55, v4
    ds_read_b64_tr_b16 a[222:223], v41 offset:53248
    v_mfma_f32_16x16x32_bf16 v[72:75], a[240:243], a[32:35], v[120:123]
    v_exp_f32 v103, v103
    v_mfma_f32_16x16x32_bf16 v[72:75], a[244:247], a[36:39], v[72:75]
    s_lshr_b32 s55, s55, 31
    v_cvt_pk_bf16_f32 v99, v102, v103
    ds_read_b64_tr_b16 a[224:225], v42 offset:49152
    v_mfma_f32_16x16x32_bf16 v[72:75], a[248:251], a[40:43], v[72:75]
    v_exp_f32 v108, v108
    v_mfma_f32_16x16x32_bf16 v[72:75], a[252:255], a[44:47], v[72:75]
    s_lshl_b32 s99, s55, 13
    ds_read_b64_tr_b16 a[226:227], v42 offset:53248
    v_mfma_f32_16x16x32_bf16 v[80:83], a[240:243], a[48:51], v[124:127]
    v_exp_f32 v109, v109
    v_mfma_f32_16x16x32_bf16 v[80:83], a[244:247], a[52:55], v[80:83]
    s_lshl1_add_u32 s55, s55, 1
    v_cvt_pk_bf16_f32 v106, v108, v109
    ds_read_b64_tr_b16 a[228:229], v43 offset:49152
    v_mfma_f32_16x16x32_bf16 v[80:83], a[248:251], a[56:59], v[80:83]
    s_add_u32 m0, s15, 0x18000
    v_exp_f32 v110, v110
    v_mfma_f32_16x16x32_bf16 v[80:83], a[252:255], a[60:63], v[80:83]
    s_lshl_b32 s58, s7, 3
    ds_read_b64_tr_b16 a[230:231], v43 offset:53248
    v_mfma_f32_16x16x32_bf16 v[60:63], a[192:195], a[0:3], v[112:115]
    s_add_u32 s54, s12, 0xc000
    v_exp_f32 v111, v111
    v_mfma_f32_16x16x32_bf16 v[60:63], a[196:199], a[4:7], v[60:63]
    s_lshl_b32 s55, s55, s58
    v_cvt_pk_bf16_f32 v107, v110, v111
    ds_read_b64_tr_b16 a[232:233], v44 offset:49152
    v_mfma_f32_16x16x32_bf16 v[60:63], a[200:203], a[8:11], v[60:63]
    buffer_load_dwordx4 v8, s[28:31], s54 offen offset:0 nt lds
    v_mfma_f32_16x16x32_bf16 v[60:63], a[204:207], a[12:15], v[60:63]
    s_add_u32 s92, s16, s99
    v_exp_f32 v56, v56
    v_mfma_f32_16x16x32_bf16 v[68:71], a[192:195], a[16:19], v[116:119]
    ds_read_b64_tr_b16 a[234:235], v44 offset:53248
    v_mfma_f32_16x16x32_bf16 v[68:71], a[196:199], a[20:23], v[68:71]
    s_add_u32 s93, s92, 16384
    v_mov_b32 v47, s55
    ds_read_b64_tr_b16 a[236:237], v45 offset:49152
    v_mfma_f32_16x16x32_bf16 v[68:71], a[200:203], a[24:27], v[68:71]
    v_exp_f32 v57, v57
    v_mfma_f32_16x16x32_bf16 v[68:71], a[204:207], a[28:31], v[68:71]
    s_add_u32 s94, s92, 32768
    v_cvt_pk_bf16_f32 v56, v56, v57
    ds_read_b64_tr_b16 a[238:239], v45 offset:53248
    v_mfma_f32_16x16x32_bf16 v[76:79], a[192:195], a[32:35], v[120:123]
    v_exp_f32 v58, v58
    v_mfma_f32_16x16x32_bf16 v[76:79], a[196:199], a[36:39], v[76:79]
    s_add_u32 s95, s92, 49152
    ds_read_b128 a[240:243], v26 offset:32768
    v_mfma_f32_16x16x32_bf16 v[76:79], a[200:203], a[40:43], v[76:79]
    v_exp_f32 v59, v59
    v_mfma_f32_16x16x32_bf16 v[76:79], a[204:207], a[44:47], v[76:79]
    s_add_u32 s96, s92, 65536
    v_cvt_pk_bf16_f32 v57, v58, v59
    ds_read_b128 a[244:247], v27 offset:32768
    v_mfma_f32_16x16x32_bf16 v[84:87], a[192:195], a[48:51], v[124:127]
    v_exp_f32 v64, v64
    v_mfma_f32_16x16x32_bf16 v[84:87], a[196:199], a[52:55], v[84:87]
    s_add_u32 s97, s92, 81920
    ds_read_b128 a[248:251], v28 offset:32768
    v_mfma_f32_16x16x32_bf16 v[84:87], a[200:203], a[56:59], v[84:87]
L_pad3:
    s_cbranch_execz L_pad7
    v_exp_f32 v65, v65
    v_mfma_f32_16x16x32_bf16 v[84:87], a[204:207], a[60:63], v[84:87]
    s_add_u32 s98, s92, 98304
    v_cvt_pk_bf16_f32 v64, v64, v65
    ds_read_b128 a[252:255], v29 offset:32768
    v_mfma_f32_16x16x32_bf16 v[128:131], a[208:211], v[88:91], v[128:131]
    buffer_load_dwordx4 v9, s[28:31], s54 offen offset:1024 nt lds
    v_mfma_f32_16x16x32_bf16 v[160:163], a[208:211], v[96:99], v[160:163]
    s_add_u32 s14, s17, s99
    v_exp_f32 v66, v66
    v_mfma_f32_16x16x32_bf16 v[192:195], a[208:211], v[104:107], v[192:195]
    ds_read_b128 a[192:195], v26 offset:36864
    v_mfma_f32_16x16x32_bf16 a[64:67], a[80:83], v[88:91], a[64:67]
    s_add_u32 s61, s14, 0x1c000
    v_exp_f32 v67, v67
    v_mfma_f32_16x16x32_bf16 a[68:71], a[80:83], v[96:99], a[68:71]
    v_cvt_pk_bf16_f32 v65, v66, v67
    ds_read_b128 a[196:199], v27 offset:36864
    v_mfma_f32_16x16x32_bf16 a[72:75], a[80:83], v[104:107], a[72:75]
    s_add_u32 s59, s61, s53
    v_exp_f32 v72, v72
    v_mfma_f32_16x16x32_bf16 v[132:135], a[212:215], v[88:91], v[132:135]
    ds_read_b128 a[200:203], v28 offset:36864
    v_mfma_f32_16x16x32_bf16 v[164:167], a[212:215], v[96:99], v[164:167]
    s_lshl_b32 s56, s8, 1
    v_exp_f32 v73, v73
    v_mfma_f32_16x16x32_bf16 v[196:199], a[212:215], v[104:107], v[196:199]
    s_waitcnt lgkmcnt(3)
    v_cvt_pk_bf16_f32 v72, v72, v73
    ds_read_b128 a[204:207], v29 offset:36864
    v_mfma_f32_16x16x32_bf16 v[136:139], a[216:219], v[88:91], v[136:139]
    s_xor_b32 s56, s56, s6
    v_exp_f32 v74, v74
    v_mfma_f32_16x16x32_bf16 v[168:171], a[216:219], v[96:99], v[168:171]
    v_exp_f32 v75, v75
    v_mfma_f32_16x16x32_bf16 v[200:203], a[216:219], v[104:107], v[200:203]
    s_lshl_b32 s56, s56, 5
    v_exp_f32 v80, v80
    v_mfma_f32_16x16x32_bf16 v[140:143], a[220:223], v[88:91], v[140:143]
    v_exp_f32 v81, v81
    v_mfma_f32_16x16x32_bf16 v[172:175], a[220:223], v[96:99], v[172:175]
    s_or_b32 s56, s56, 0x8000
    v_exp_f32 v82, v82
    v_mfma_f32_16x16x32_bf16 v[204:207], a[220:223], v[104:107], v[204:207]
    v_exp_f32 v83, v83
    v_mfma_f32_16x16x32_bf16 v[144:147], a[224:227], v[88:91], v[144:147]
    buffer_load_dwordx4 v10, s[28:31], s54 offen offset:2048 nt lds
    v_mfma_f32_16x16x32_bf16 v[176:179], a[224:227], v[96:99], v[176:179]
    v_exp_f32 v60, v60
    v_mfma_f32_16x16x32_bf16 v[208:211], a[224:227], v[104:107], v[208:211]
    v_exp_f32 v61, v61
    v_mfma_f32_16x16x32_bf16 v[148:151], a[228:231], v[88:91], v[148:151]
    v_exp_f32 v62, v62
    v_mfma_f32_16x16x32_bf16 v[180:183], a[228:231], v[96:99], v[180:183]
    v_exp_f32 v63, v63
    v_mfma_f32_16x16x32_bf16 v[212:215], a[228:231], v[104:107], v[212:215]
    v_exp_f32 v68, v68
    v_mfma_f32_16x16x32_bf16 v[152:155], a[232:235], v[88:91], v[152:155]
    v_exp_f32 v69, v69
    v_mfma_f32_16x16x32_bf16 v[184:187], a[232:235], v[96:99], v[184:187]
    v_exp_f32 v70, v70
    v_mfma_f32_16x16x32_bf16 v[216:219], a[232:235], v[104:107], v[216:219]
    v_exp_f32 v71, v71
    v_mfma_f32_16x16x32_bf16 v[156:159], a[236:239], v[88:91], v[156:159]
    v_exp_f32 v76, v76
    v_mfma_f32_16x16x32_bf16 v[188:191], a[236:239], v[96:99], v[188:191]
    v_exp_f32 v77, v77
    v_mfma_f32_16x16x32_bf16 v[220:223], a[236:239], v[104:107], v[220:223]
    v_exp_f32 v78, v78
    v_mfma_f32_16x16x32_bf16 v[88:91], a[240:243], a[0:3], v[112:115]
    v_exp_f32 v79, v79
    v_mfma_f32_16x16x32_bf16 v[88:91], a[244:247], a[4:7], v[88:91]
    v_exp_f32 v84, v84
    v_mfma_f32_16x16x32_bf16 v[88:91], a[248:251], a[8:11], v[88:91]
    v_exp_f32 v85, v85
    v_mfma_f32_16x16x32_bf16 v[88:91], a[252:255], a[12:15], v[88:91]
    buffer_load_dwordx4 v11, s[28:31], s54 offen offset:3072 nt lds
    v_mfma_f32_16x16x32_bf16 v[96:99], a[240:243], a[16:19], v[116:119]
    v_exp_f32 v86, v86
    v_mfma_f32_16x16x32_bf16 v[96:99], a[244:247], a[20:23], v[96:99]
    v_exp_f32 v87, v87
    v_mfma_f32_16x16x32_bf16 v[96:99], a[248:251], a[24:27], v[96:99]
    v_cvt_pk_bf16_f32 v73, v74, v75
    v_cvt_pk_bf16_f32 v80, v80, v81
    v_mfma_f32_16x16x32_bf16 v[96:99], a[252:255], a[28:31], v[96:99]
    v_cvt_pk_bf16_f32 v81, v82, v83
    v_cvt_pk_bf16_f32 v58, v60, v61
    v_mfma_f32_16x16x32_bf16 v[104:107], a[240:243], a[32:35], v[120:123]
    v_exp_f32 v88, v88
    v_mfma_f32_16x16x32_bf16 v[104:107], a[244:247], a[36:39], v[104:107]
    v_exp_f32 v89, v89
    v_mfma_f32_16x16x32_bf16 v[104:107], a[248:251], a[40:43], v[104:107]
    s_waitcnt vmcnt(8) lgkmcnt(0)
    v_exp_f32 v90, v90
    v_mfma_f32_16x16x32_bf16 v[104:107], a[252:255], a[44:47], v[104:107]
    s_barrier
    v_cvt_pk_bf16_f32 v59, v62, v63
    ds_read_b64_tr_b16 a[208:209], v30 offset:32768
    v_mfma_f32_16x16x32_bf16 v[92:95], a[192:195], a[0:3], v[112:115]
    v_cvt_pk_bf16_f32 v66, v68, v69
    ds_read_b64_tr_b16 a[210:211], v30 offset:36864
    v_mfma_f32_16x16x32_bf16 v[92:95], a[196:199], a[4:7], v[92:95]
    buffer_store_dwordx4 a[92:95], v18, s[40:43], s59 offen sc1
    v_mfma_f32_16x16x32_bf16 v[92:95], a[200:203], a[8:11], v[92:95]
    buffer_store_dwordx4 a[92:95], v54, s[40:43], s59 offen offset:1024 sc1
    v_mfma_f32_16x16x32_bf16 v[92:95], a[204:207], a[12:15], v[92:95]
    v_cvt_pk_bf16_f32 v67, v70, v71
    ds_read_b64_tr_b16 a[212:213], v31 offset:32768
    v_mfma_f32_16x16x32_bf16 v[100:103], a[192:195], a[16:19], v[116:119]
    v_cvt_pk_bf16_f32 v74, v76, v77
    ds_read_b64_tr_b16 a[214:215], v31 offset:36864
    v_mfma_f32_16x16x32_bf16 v[100:103], a[196:199], a[20:23], v[100:103]
    s_add_u32 m0, s15, 0x8000
    v_cvt_pk_bf16_f32 v75, v78, v79
    ds_read_b64_tr_b16 a[216:217], v32 offset:32768
    v_mfma_f32_16x16x32_bf16 v[100:103], a[200:203], a[24:27], v[100:103]
    s_add_u32 s54, s12, 0xc000
    v_cvt_pk_bf16_f32 v82, v84, v85
    ds_read_b64_tr_b16 a[218:219], v32 offset:36864
    v_mfma_f32_16x16x32_bf16 v[100:103], a[204:207], a[28:31], v[100:103]
    buffer_load_dwordx4 v12, s[32:35], s54 offen offset:0 nt lds
    v_mfma_f32_16x16x32_bf16 v[108:111], a[192:195], a[32:35], v[120:123]
    v_exp_f32 v91, v91
    v_mfma_f32_16x16x32_bf16 v[108:111], a[196:199], a[36:39], v[108:111]
    v_cvt_pk_bf16_f32 v83, v86, v87
    ds_read_b64_tr_b16 a[220:221], v33 offset:32768
    v_mfma_f32_16x16x32_bf16 v[108:111], a[200:203], a[40:43], v[108:111]
    v_cvt_pk_bf16_f32 v88, v88, v89
    ds_read_b64_tr_b16 a[222:223], v33 offset:36864
    v_mfma_f32_16x16x32_bf16 v[108:111], a[204:207], a[44:47], v[108:111]
    s_waitcnt lgkmcnt(5)
    v_exp_f32 v96, v96
    v_mfma_f32_16x16x32_bf16 v[128:131], a[208:211], v[56:59], v[128:131]
    v_cvt_pk_bf16_f32 v89, v90, v91
    ds_read_b64_tr_b16 a[224:225], v34 offset:32768
    v_mfma_f32_16x16x32_bf16 v[160:163], a[208:211], v[64:67], v[160:163]
    v_exp_f32 v97, v97
    v_mfma_f32_16x16x32_bf16 v[192:195], a[208:211], v[72:75], v[192:195]
    v_cvt_pk_bf16_f32 v96, v96, v97
    ds_read_b64_tr_b16 a[226:227], v34 offset:36864
    v_mfma_f32_16x16x32_bf16 v[224:227], a[208:211], v[80:83], v[224:227]
    v_exp_f32 v98, v98
    v_mfma_f32_16x16x32_bf16 a[64:67], a[80:83], v[56:59], a[64:67]
    ds_read_b64_tr_b16 a[228:229], v35 offset:32768
    v_mfma_f32_16x16x32_bf16 a[68:71], a[80:83], v[64:67], a[68:71]
    v_exp_f32 v99, v99
    v_mfma_f32_16x16x32_bf16 a[72:75], a[80:83], v[72:75], a[72:75]
    ds_read_b64_tr_b16 a[230:231], v35 offset:36864
    v_cvt_pk_bf16_f32 v97, v98, v99
    v_mfma_f32_16x16x32_bf16 a[76:79], a[80:83], v[80:83], a[76:79]
    s_waitcnt lgkmcnt(4)
    v_exp_f32 v104, v104
    v_mfma_f32_16x16x32_bf16 v[132:135], a[212:215], v[56:59], v[132:135]
    ds_read_b64_tr_b16 a[232:233], v36 offset:32768
    v_mfma_f32_16x16x32_bf16 v[164:167], a[212:215], v[64:67], v[164:167]
    v_exp_f32 v105, v105
    v_mfma_f32_16x16x32_bf16 v[196:199], a[212:215], v[72:75], v[196:199]
    buffer_load_dwordx4 v13, s[32:35], s54 offen offset:1024 nt lds
    v_mfma_f32_16x16x32_bf16 v[228:231], a[212:215], v[80:83], v[228:231]
    v_cvt_pk_bf16_f32 v104, v104, v105
    ds_read_b64_tr_b16 a[234:235], v36 offset:36864
    v_mfma_f32_16x16x32_bf16 v[136:139], a[216:219], v[56:59], v[136:139]
    v_exp_f32 v106, v106
    v_mfma_f32_16x16x32_bf16 v[168:171], a[216:219], v[64:67], v[168:171]
    ds_read_b64_tr_b16 a[236:237], v37 offset:32768
    v_mfma_f32_16x16x32_bf16 v[200:203], a[216:219], v[72:75], v[200:203]
    ds_read_b64_tr_b16 a[238:239], v37 offset:36864
    v_mfma_f32_16x16x32_bf16 v[232:235], a[216:219], v[80:83], v[232:235]
    v_exp_f32 v107, v107
    v_mfma_f32_16x16x32_bf16 v[140:143], a[220:223], v[56:59], v[140:143]
    ds_read_b128 a[240:243], v22 offset:16384
    v_cvt_pk_bf16_f32 v105, v106, v107
    v_mfma_f32_16x16x32_bf16 v[172:175], a[220:223], v[64:67], v[172:175]
    v_exp_f32 v92, v92
    v_mfma_f32_16x16x32_bf16 v[204:207], a[220:223], v[72:75], v[204:207]
    ds_read_b128 a[244:247], v23 offset:16384
    v_mfma_f32_16x16x32_bf16 v[236:239], a[220:223], v[80:83], v[236:239]
    s_waitcnt lgkmcnt(4)
    v_exp_f32 v93, v93
    v_mfma_f32_16x16x32_bf16 v[144:147], a[224:227], v[56:59], v[144:147]
    v_cvt_pk_bf16_f32 v90, v92, v93
    ds_read_b128 a[248:251], v24 offset:16384
    v_mfma_f32_16x16x32_bf16 v[176:179], a[224:227], v[64:67], v[176:179]
    ds_read_b128 a[252:255], v25 offset:16384
    v_mfma_f32_16x16x32_bf16 v[208:211], a[224:227], v[72:75], v[208:211]
    v_exp_f32 v94, v94
    v_mfma_f32_16x16x32_bf16 v[240:243], a[224:227], v[80:83], v[240:243]
    ds_read_b128 a[192:195], v22 offset:20480
    v_mfma_f32_16x16x32_bf16 v[148:151], a[228:231], v[56:59], v[148:151]
    buffer_load_dwordx4 v12, s[32:35], s54 offen offset:2048 nt lds
    v_mfma_f32_16x16x32_bf16 v[180:183], a[228:231], v[64:67], v[180:183]
    v_exp_f32 v95, v95
    v_mfma_f32_16x16x32_bf16 v[212:215], a[228:231], v[72:75], v[212:215]
    ds_read_b128 a[196:199], v23 offset:20480
    v_cvt_pk_bf16_f32 v91, v94, v95
    v_mfma_f32_16x16x32_bf16 v[244:247], a[228:231], v[80:83], v[244:247]
    v_exp_f32 v100, v100
    v_mfma_f32_16x16x32_bf16 v[152:155], a[232:235], v[56:59], v[152:155]
    ds_read_b128 a[200:203], v24 offset:20480
    v_mfma_f32_16x16x32_bf16 v[184:187], a[232:235], v[64:67], v[184:187]
    v_exp_f32 v101, v101
    v_mfma_f32_16x16x32_bf16 v[216:219], a[232:235], v[72:75], v[216:219]
    v_cvt_pk_bf16_f32 v98, v100, v101
    ds_read_b128 a[204:207], v25 offset:20480
    v_mfma_f32_16x16x32_bf16 v[248:251], a[232:235], v[80:83], v[248:251]
    s_waitcnt lgkmcnt(3)
    v_exp_f32 v102, v102
    v_mfma_f32_16x16x32_bf16 v[156:159], a[236:239], v[56:59], v[156:159]
    ds_read_b64_tr_b16 a[208:209], v38 offset:32768
    v_mfma_f32_16x16x32_bf16 v[188:191], a[236:239], v[64:67], v[188:191]
    v_exp_f32 v103, v103
    v_mfma_f32_16x16x32_bf16 v[220:223], a[236:239], v[72:75], v[220:223]
    v_cvt_pk_bf16_f32 v99, v102, v103
    ds_read_b64_tr_b16 a[210:211], v38 offset:36864
    v_mfma_f32_16x16x32_bf16 v[252:255], a[236:239], v[80:83], v[252:255]
    v_exp_f32 v108, v108
    v_mfma_f32_16x16x32_bf16 v[56:59], a[240:243], a[0:3], v[112:115]
    ds_read_b64_tr_b16 a[212:213], v39 offset:32768
    v_mfma_f32_16x16x32_bf16 v[56:59], a[244:247], a[4:7], v[56:59]
    v_exp_f32 v109, v109
    v_mfma_f32_16x16x32_bf16 v[56:59], a[248:251], a[8:11], v[56:59]
    ds_read_b64_tr_b16 a[214:215], v39 offset:36864
    v_cvt_pk_bf16_f32 v106, v108, v109
    v_mfma_f32_16x16x32_bf16 v[56:59], a[252:255], a[12:15], v[56:59]
    buffer_load_dwordx4 v13, s[32:35], s54 offen offset:3072 nt lds
    v_mfma_f32_16x16x32_bf16 v[64:67], a[240:243], a[16:19], v[116:119]
    v_exp_f32 v110, v110
    v_mfma_f32_16x16x32_bf16 v[64:67], a[244:247], a[20:23], v[64:67]
    ds_read_b64_tr_b16 a[216:217], v40 offset:32768
    v_mfma_f32_16x16x32_bf16 v[64:67], a[248:251], a[24:27], v[64:67]
    v_exp_f32 v111, v111
    v_mfma_f32_16x16x32_bf16 v[64:67], a[252:255], a[28:31], v[64:67]
    v_cvt_pk_bf16_f32 v107, v110, v111
    ds_read_b64_tr_b16 a[218:219], v40 offset:36864
    v_mfma_f32_16x16x32_bf16 v[72:75], a[240:243], a[32:35], v[120:123]
    v_exp_f32 v56, v56
    v_mfma_f32_16x16x32_bf16 v[72:75], a[244:247], a[36:39], v[72:75]
    ds_read_b64_tr_b16 a[220:221], v41 offset:32768
    v_mfma_f32_16x16x32_bf16 v[72:75], a[248:251], a[40:43], v[72:75]
    v_exp_f32 v57, v57
    v_mfma_f32_16x16x32_bf16 v[72:75], a[252:255], a[44:47], v[72:75]
    ds_read_b64_tr_b16 a[222:223], v41 offset:36864
    v_cvt_pk_bf16_f32 v56, v56, v57
    v_mfma_f32_16x16x32_bf16 v[80:83], a[240:243], a[48:51], v[124:127]
    v_exp_f32 v58, v58
    v_mfma_f32_16x16x32_bf16 v[80:83], a[244:247], a[52:55], v[80:83]
    ds_read_b64_tr_b16 a[224:225], v42 offset:32768
    v_mfma_f32_16x16x32_bf16 v[80:83], a[248:251], a[56:59], v[80:83]
    v_exp_f32 v59, v59
    v_mfma_f32_16x16x32_bf16 v[80:83], a[252:255], a[60:63], v[80:83]
    s_waitcnt lgkmcnt(3)
    v_cvt_pk_bf16_f32 v57, v58, v59
    ds_read_b64_tr_b16 a[226:227], v42 offset:36864
    v_mfma_f32_16x16x32_bf16 v[60:63], a[192:195], a[0:3], v[112:115]
    s_add_u32 m0, s15, 0x24000
    v_exp_f32 v64, v64
    v_mfma_f32_16x16x32_bf16 v[60:63], a[196:199], a[4:7], v[60:63]
    s_add_u32 s54, s12, 0x10000
    ds_read_b64_tr_b16 a[228:229], v43 offset:32768
    v_mfma_f32_16x16x32_bf16 v[60:63], a[200:203], a[8:11], v[60:63]
    buffer_load_dwordx4 v8, s[28:31], s54 offen offset:0 nt lds
    v_mfma_f32_16x16x32_bf16 v[60:63], a[204:207], a[12:15], v[60:63]
    v_exp_f32 v65, v65
    v_mfma_f32_16x16x32_bf16 v[68:71], a[192:195], a[16:19], v[116:119]
    v_cvt_pk_bf16_f32 v64, v64, v65
    ds_read_b64_tr_b16 a[230:231], v43 offset:36864
    v_mfma_f32_16x16x32_bf16 v[68:71], a[196:199], a[20:23], v[68:71]
    v_exp_f32 v66, v66
    v_mfma_f32_16x16x32_bf16 v[68:71], a[200:203], a[24:27], v[68:71]
    ds_read_b64_tr_b16 a[232:233], v44 offset:32768
    v_mfma_f32_16x16x32_bf16 v[68:71], a[204:207], a[28:31], v[68:71]
    v_exp_f32 v67, v67
    v_mfma_f32_16x16x32_bf16 v[76:79], a[192:195], a[32:35], v[120:123]
    ds_read_b64_tr_b16 a[234:235], v44 offset:36864
    v_cvt_pk_bf16_f32 v65, v66, v67
    v_mfma_f32_16x16x32_bf16 v[76:79], a[196:199], a[36:39], v[76:79]
    v_exp_f32 v72, v72
    v_mfma_f32_16x16x32_bf16 v[76:79], a[200:203], a[40:43], v[76:79]
    ds_read_b64_tr_b16 a[236:237], v45 offset:32768
    v_mfma_f32_16x16x32_bf16 v[76:79], a[204:207], a[44:47], v[76:79]
    v_exp_f32 v73, v73
    v_mfma_f32_16x16x32_bf16 v[84:87], a[192:195], a[48:51], v[124:127]
    v_cvt_pk_bf16_f32 v72, v72, v73
    ds_read_b64_tr_b16 a[238:239], v45 offset:36864
    v_mfma_f32_16x16x32_bf16 v[84:87], a[196:199], a[52:55], v[84:87]
    v_exp_f32 v74, v74
    v_mfma_f32_16x16x32_bf16 v[84:87], a[200:203], a[56:59], v[84:87]
    ds_read_b128 a[240:243], v26 offset:16384
    v_mfma_f32_16x16x32_bf16 v[84:87], a[204:207], a[60:63], v[84:87]
    v_exp_f32 v75, v75
    v_mfma_f32_16x16x32_bf16 v[128:131], a[208:211], v[88:91], v[128:131]
    buffer_load_dwordx4 v9, s[28:31], s54 offen offset:1024 nt lds
    v_mfma_f32_16x16x32_bf16 v[160:163], a[208:211], v[96:99], v[160:163]
    v_exp_f32 v80, v80
    v_mfma_f32_16x16x32_bf16 v[192:195], a[208:211], v[104:107], v[192:195]
    ds_read_b128 a[244:247], v27 offset:16384
    v_cvt_pk_bf16_f32 v73, v74, v75
    v_mfma_f32_16x16x32_bf16 a[64:67], a[80:83], v[88:91], a[64:67]
    v_exp_f32 v81, v81
    v_mfma_f32_16x16x32_bf16 a[68:71], a[80:83], v[96:99], a[68:71]
    v_cvt_pk_bf16_f32 v80, v80, v81
    ds_read_b128 a[248:251], v28 offset:16384
    v_mfma_f32_16x16x32_bf16 a[72:75], a[80:83], v[104:107], a[72:75]
    v_exp_f32 v82, v82
    v_mfma_f32_16x16x32_bf16 v[132:135], a[212:215], v[88:91], v[132:135]
    ds_read_b128 a[252:255], v29 offset:16384
    v_mfma_f32_16x16x32_bf16 v[164:167], a[212:215], v[96:99], v[164:167]
    v_exp_f32 v83, v83
    v_mfma_f32_16x16x32_bf16 v[196:199], a[212:215], v[104:107], v[196:199]
    v_cvt_pk_bf16_f32 v81, v82, v83
    ds_read_b128 a[192:195], v26 offset:20480
    v_mfma_f32_16x16x32_bf16 v[136:139], a[216:219], v[88:91], v[136:139]
    v_exp_f32 v60, v60
    v_mfma_f32_16x16x32_bf16 v[168:171], a[216:219], v[96:99], v[168:171]
    ds_read_b128 a[196:199], v27 offset:20480
    v_mfma_f32_16x16x32_bf16 v[200:203], a[216:219], v[104:107], v[200:203]
    s_waitcnt lgkmcnt(4)
    v_exp_f32 v61, v61
    v_mfma_f32_16x16x32_bf16 v[140:143], a[220:223], v[88:91], v[140:143]
    ds_read_b128 a[200:203], v28 offset:20480
    v_cvt_pk_bf16_f32 v58, v60, v61
    v_mfma_f32_16x16x32_bf16 v[172:175], a[220:223], v[96:99], v[172:175]
    v_exp_f32 v62, v62
    v_mfma_f32_16x16x32_bf16 v[204:207], a[220:223], v[104:107], v[204:207]
    ds_read_b128 a[204:207], v29 offset:20480
    v_mfma_f32_16x16x32_bf16 v[144:147], a[224:227], v[88:91], v[144:147]
    buffer_load_dwordx4 v10, s[28:31], s54 offen offset:2048 nt lds
    v_mfma_f32_16x16x32_bf16 v[176:179], a[224:227], v[96:99], v[176:179]
    v_exp_f32 v63, v63
    v_mfma_f32_16x16x32_bf16 v[208:211], a[224:227], v[104:107], v[208:211]
    v_exp_f32 v68, v68
    v_mfma_f32_16x16x32_bf16 v[148:151], a[228:231], v[88:91], v[148:151]
    v_exp_f32 v69, v69
    v_mfma_f32_16x16x32_bf16 v[180:183], a[228:231], v[96:99], v[180:183]
    v_exp_f32 v70, v70
    v_mfma_f32_16x16x32_bf16 v[212:215], a[228:231], v[104:107], v[212:215]
    v_exp_f32 v71, v71
    v_mfma_f32_16x16x32_bf16 v[152:155], a[232:235], v[88:91], v[152:155]
    v_exp_f32 v76, v76
    v_mfma_f32_16x16x32_bf16 v[184:187], a[232:235], v[96:99], v[184:187]
    v_exp_f32 v77, v77
    v_mfma_f32_16x16x32_bf16 v[216:219], a[232:235], v[104:107], v[216:219]
    v_exp_f32 v78, v78
    v_mfma_f32_16x16x32_bf16 v[156:159], a[236:239], v[88:91], v[156:159]
    v_exp_f32 v79, v79
    v_mfma_f32_16x16x32_bf16 v[188:191], a[236:239], v[96:99], v[188:191]
    v_exp_f32 v84, v84
    v_mfma_f32_16x16x32_bf16 v[220:223], a[236:239], v[104:107], v[220:223]
    v_exp_f32 v85, v85
    v_mfma_f32_16x16x32_bf16 v[88:91], a[240:243], a[0:3], v[112:115]
    v_exp_f32 v86, v86
    v_mfma_f32_16x16x32_bf16 v[88:91], a[244:247], a[4:7], v[88:91]
    s_waitcnt lgkmcnt(0)
    v_exp_f32 v87, v87
    v_mfma_f32_16x16x32_bf16 v[88:91], a[248:251], a[8:11], v[88:91]
    v_cvt_pk_bf16_f32 v59, v62, v63
    v_cvt_pk_bf16_f32 v66, v68, v69
    v_mfma_f32_16x16x32_bf16 v[88:91], a[252:255], a[12:15], v[88:91]
    buffer_load_dwordx4 v11, s[28:31], s54 offen offset:3072 nt lds
    v_mfma_f32_16x16x32_bf16 v[96:99], a[240:243], a[16:19], v[116:119]
    v_cvt_pk_bf16_f32 v67, v70, v71
    v_cvt_pk_bf16_f32 v74, v76, v77
    v_mfma_f32_16x16x32_bf16 v[96:99], a[244:247], a[20:23], v[96:99]
    v_cvt_pk_bf16_f32 v75, v78, v79
    v_cvt_pk_bf16_f32 v82, v84, v85
    v_mfma_f32_16x16x32_bf16 v[96:99], a[248:251], a[24:27], v[96:99]
    v_cvt_pk_bf16_f32 v83, v86, v87
    v_mfma_f32_16x16x32_bf16 v[96:99], a[252:255], a[28:31], v[96:99]
    v_mfma_f32_16x16x32_bf16 v[104:107], a[240:243], a[32:35], v[120:123]
    v_exp_f32 v88, v88
    v_mfma_f32_16x16x32_bf16 v[104:107], a[244:247], a[36:39], v[104:107]
    v_exp_f32 v89, v89
    v_mfma_f32_16x16x32_bf16 v[104:107], a[248:251], a[40:43], v[104:107]
    s_waitcnt vmcnt(10)
    v_exp_f32 v90, v90
    v_mfma_f32_16x16x32_bf16 v[104:107], a[252:255], a[44:47], v[104:107]
    s_barrier
    v_cvt_pk_bf16_f32 v88, v88, v89
    ds_read_b64_tr_b16 a[208:209], v30 offset:16384
    v_mfma_f32_16x16x32_bf16 v[92:95], a[192:195], a[0:3], v[112:115]
    ds_read_b64_tr_b16 a[210:211], v30 offset:20480
    v_mfma_f32_16x16x32_bf16 v[92:95], a[196:199], a[4:7], v[92:95]
    ds_read_b64_tr_b16 a[212:213], v31 offset:16384
    v_mfma_f32_16x16x32_bf16 v[92:95], a[200:203], a[8:11], v[92:95]
    ds_read_b64_tr_b16 a[214:215], v31 offset:20480
    v_mfma_f32_16x16x32_bf16 v[92:95], a[204:207], a[12:15], v[92:95]
    v_exp_f32 v91, v91
    v_mfma_f32_16x16x32_bf16 v[100:103], a[192:195], a[16:19], v[116:119]
    ds_read_b64_tr_b16 a[216:217], v32 offset:16384
    v_cvt_pk_bf16_f32 v89, v90, v91
    v_mfma_f32_16x16x32_bf16 v[100:103], a[196:199], a[20:23], v[100:103]
    s_add_u32 m0, s15, 0x14000
    v_exp_f32 v96, v96
    v_mfma_f32_16x16x32_bf16 v[100:103], a[200:203], a[24:27], v[100:103]
    s_add_u32 s54, s12, 0x10000
    ds_read_b64_tr_b16 a[218:219], v32 offset:20480
    v_mfma_f32_16x16x32_bf16 v[100:103], a[204:207], a[28:31], v[100:103]
    buffer_load_dwordx4 v12, s[32:35], s54 offen offset:0 nt lds
    v_mfma_f32_16x16x32_bf16 v[108:111], a[192:195], a[32:35], v[120:123]
    v_exp_f32 v97, v97
    v_mfma_f32_16x16x32_bf16 v[108:111], a[196:199], a[36:39], v[108:111]
    v_cvt_pk_bf16_f32 v96, v96, v97
    ds_read_b64_tr_b16 a[220:221], v33 offset:16384
    v_mfma_f32_16x16x32_bf16 v[108:111], a[200:203], a[40:43], v[108:111]
    ds_read_b64_tr_b16 a[222:223], v33 offset:20480
    v_mfma_f32_16x16x32_bf16 v[108:111], a[204:207], a[44:47], v[108:111]
    s_waitcnt lgkmcnt(4)
    v_exp_f32 v98, v98
    v_mfma_f32_16x16x32_bf16 v[128:131], a[208:211], v[56:59], v[128:131]
    ds_read_b64_tr_b16 a[224:225], v34 offset:16384
    v_mfma_f32_16x16x32_bf16 v[160:163], a[208:211], v[64:67], v[160:163]
    v_exp_f32 v99, v99
    v_mfma_f32_16x16x32_bf16 v[192:195], a[208:211], v[72:75], v[192:195]
    v_cvt_pk_bf16_f32 v97, v98, v99
    ds_read_b64_tr_b16 a[226:227], v34 offset:20480
    v_mfma_f32_16x16x32_bf16 v[224:227], a[208:211], v[80:83], v[224:227]
    v_exp_f32 v104, v104
    v_mfma_f32_16x16x32_bf16 a[64:67], a[80:83], v[56:59], a[64:67]
    ds_read_b64_tr_b16 a[228:229], v35 offset:16384
    v_mfma_f32_16x16x32_bf16 a[68:71], a[80:83], v[64:67], a[68:71]
    v_exp_f32 v105, v105
    v_mfma_f32_16x16x32_bf16 a[72:75], a[80:83], v[72:75], a[72:75]
    ds_read_b64_tr_b16 a[230:231], v35 offset:20480
    v_cvt_pk_bf16_f32 v104, v104, v105
    v_mfma_f32_16x16x32_bf16 a[76:79], a[80:83], v[80:83], a[76:79]
    v_exp_f32 v106, v106
    v_mfma_f32_16x16x32_bf16 v[132:135], a[212:215], v[56:59], v[132:135]
    ds_read_b64_tr_b16 a[232:233], v36 offset:16384
    v_mfma_f32_16x16x32_bf16 v[164:167], a[212:215], v[64:67], v[164:167]
    v_exp_f32 v107, v107
    v_mfma_f32_16x16x32_bf16 v[196:199], a[212:215], v[72:75], v[196:199]
    buffer_load_dwordx4 v13, s[32:35], s54 offen offset:1024 nt lds
    v_mfma_f32_16x16x32_bf16 v[228:231], a[212:215], v[80:83], v[228:231]
    s_waitcnt lgkmcnt(3)
    ds_read_b64_tr_b16 a[234:235], v36 offset:20480
    v_cvt_pk_bf16_f32 v105, v106, v107
    v_mfma_f32_16x16x32_bf16 v[136:139], a[216:219], v[56:59], v[136:139]
    v_exp_f32 v92, v92
    v_mfma_f32_16x16x32_bf16 v[168:171], a[216:219], v[64:67], v[168:171]
    ds_read_b64_tr_b16 a[236:237], v37 offset:16384
    v_mfma_f32_16x16x32_bf16 v[200:203], a[216:219], v[72:75], v[200:203]
    ds_read_b64_tr_b16 a[238:239], v37 offset:20480
    v_mfma_f32_16x16x32_bf16 v[232:235], a[216:219], v[80:83], v[232:235]
    v_exp_f32 v93, v93
    v_mfma_f32_16x16x32_bf16 v[140:143], a[220:223], v[56:59], v[140:143]
    ds_read_b128 a[240:243], v22 offset:0
    v_cvt_pk_bf16_f32 v90, v92, v93
    v_mfma_f32_16x16x32_bf16 v[172:175], a[220:223], v[64:67], v[172:175]
    v_exp_f32 v94, v94
    v_mfma_f32_16x16x32_bf16 v[204:207], a[220:223], v[72:75], v[204:207]
    ds_read_b128 a[244:247], v23 offset:0
    v_mfma_f32_16x16x32_bf16 v[236:239], a[220:223], v[80:83], v[236:239]
    v_exp_f32 v95, v95
    v_mfma_f32_16x16x32_bf16 v[144:147], a[224:227], v[56:59], v[144:147]
    v_cvt_pk_bf16_f32 v91, v94, v95
    ds_read_b128 a[248:251], v24 offset:0
    v_mfma_f32_16x16x32_bf16 v[176:179], a[224:227], v[64:67], v[176:179]
    ds_read_b128 a[252:255], v25 offset:0
    v_mfma_f32_16x16x32_bf16 v[208:211], a[224:227], v[72:75], v[208:211]
    v_exp_f32 v100, v100
    v_mfma_f32_16x16x32_bf16 v[240:243], a[224:227], v[80:83], v[240:243]
    s_waitcnt lgkmcnt(4)
    ds_read_b128 a[192:195], v22 offset:4096
    v_mfma_f32_16x16x32_bf16 v[148:151], a[228:231], v[56:59], v[148:151]
    buffer_load_dwordx4 v12, s[32:35], s54 offen offset:2048 nt lds
    v_mfma_f32_16x16x32_bf16 v[180:183], a[228:231], v[64:67], v[180:183]
    v_exp_f32 v101, v101
    v_mfma_f32_16x16x32_bf16 v[212:215], a[228:231], v[72:75], v[212:215]
    ds_read_b128 a[196:199], v23 offset:4096
    v_cvt_pk_bf16_f32 v98, v100, v101
    v_mfma_f32_16x16x32_bf16 v[244:247], a[228:231], v[80:83], v[244:247]
    v_exp_f32 v102, v102
    v_mfma_f32_16x16x32_bf16 v[152:155], a[232:235], v[56:59], v[152:155]
    ds_read_b128 a[200:203], v24 offset:4096
    v_mfma_f32_16x16x32_bf16 v[184:187], a[232:235], v[64:67], v[184:187]
    v_exp_f32 v103, v103
    v_mfma_f32_16x16x32_bf16 v[216:219], a[232:235], v[72:75], v[216:219]
    ds_read_b128 a[204:207], v25 offset:4096
    v_cvt_pk_bf16_f32 v99, v102, v103
    v_mfma_f32_16x16x32_bf16 v[248:251], a[232:235], v[80:83], v[248:251]
    v_exp_f32 v108, v108
    v_mfma_f32_16x16x32_bf16 v[156:159], a[236:239], v[56:59], v[156:159]
    ds_read_b64_tr_b16 a[208:209], v38 offset:16384
    v_mfma_f32_16x16x32_bf16 v[188:191], a[236:239], v[64:67], v[188:191]
    v_exp_f32 v109, v109
    v_mfma_f32_16x16x32_bf16 v[220:223], a[236:239], v[72:75], v[220:223]
    v_cvt_pk_bf16_f32 v106, v108, v109
    ds_read_b64_tr_b16 a[210:211], v38 offset:20480
    v_mfma_f32_16x16x32_bf16 v[252:255], a[236:239], v[80:83], v[252:255]
    s_waitcnt lgkmcnt(4)
    v_exp_f32 v110, v110
    v_mfma_f32_16x16x32_bf16 v[56:59], a[240:243], a[0:3], v[112:115]
    ds_read_b64_tr_b16 a[212:213], v39 offset:16384
    v_mfma_f32_16x16x32_bf16 v[56:59], a[244:247], a[4:7], v[56:59]
    v_exp_f32 v111, v111
    v_mfma_f32_16x16x32_bf16 v[56:59], a[248:251], a[8:11], v[56:59]
    ds_read_b64_tr_b16 a[214:215], v39 offset:20480
    v_cvt_pk_bf16_f32 v107, v110, v111
    v_mfma_f32_16x16x32_bf16 v[56:59], a[252:255], a[12:15], v[56:59]
    buffer_load_dwordx4 v13, s[32:35], s54 offen offset:3072 nt lds
    v_mfma_f32_16x16x32_bf16 v[64:67], a[240:243], a[16:19], v[116:119]
    ds_read_b64_tr_b16 a[216:217], v40 offset:16384
    v_mfma_f32_16x16x32_bf16 v[64:67], a[244:247], a[20:23], v[64:67]
    ds_read_b64_tr_b16 a[218:219], v40 offset:20480
    v_mfma_f32_16x16x32_bf16 v[64:67], a[248:251], a[24:27], v[64:67]
    ds_read_b64_tr_b16 a[220:221], v41 offset:16384
    v_mfma_f32_16x16x32_bf16 v[64:67], a[252:255], a[28:31], v[64:67]
    ds_read_b64_tr_b16 a[222:223], v41 offset:20480
    v_mfma_f32_16x16x32_bf16 v[72:75], a[240:243], a[32:35], v[120:123]
    v_exp_f32 v56, v56
    v_mfma_f32_16x16x32_bf16 v[72:75], a[244:247], a[36:39], v[72:75]
    ds_read_b64_tr_b16 a[224:225], v42 offset:16384
    v_mfma_f32_16x16x32_bf16 v[72:75], a[248:251], a[40:43], v[72:75]
    v_exp_f32 v57, v57
    v_mfma_f32_16x16x32_bf16 v[72:75], a[252:255], a[44:47], v[72:75]
    ds_read_b64_tr_b16 a[226:227], v42 offset:20480
    v_cvt_pk_bf16_f32 v56, v56, v57
    v_mfma_f32_16x16x32_bf16 v[80:83], a[240:243], a[48:51], v[124:127]
    v_exp_f32 v58, v58
    v_mfma_f32_16x16x32_bf16 v[80:83], a[244:247], a[52:55], v[80:83]
    ds_read_b64_tr_b16 a[228:229], v43 offset:16384
    v_mfma_f32_16x16x32_bf16 v[80:83], a[248:251], a[56:59], v[80:83]
    v_exp_f32 v59, v59
    v_mfma_f32_16x16x32_bf16 v[80:83], a[252:255], a[60:63], v[80:83]
    s_waitcnt lgkmcnt(3)
    ds_read_b64_tr_b16 a[230:231], v43 offset:20480
    v_cvt_pk_bf16_f32 v57, v58, v59
    v_mfma_f32_16x16x32_bf16 v[60:63], a[192:195], a[0:3], v[112:115]
    s_add_u32 m0, s15, 0x20000
    v_exp_f32 v64, v64
    v_mfma_f32_16x16x32_bf16 v[60:63], a[196:199], a[4:7], v[60:63]
    s_add_u32 s54, s12, 0x14000
    ds_read_b64_tr_b16 a[232:233], v44 offset:16384
    v_mfma_f32_16x16x32_bf16 v[60:63], a[200:203], a[8:11], v[60:63]
    buffer_load_dwordx4 v8, s[28:31], s54 offen offset:0 nt lds
    v_mfma_f32_16x16x32_bf16 v[60:63], a[204:207], a[12:15], v[60:63]
    v_exp_f32 v65, v65
    v_mfma_f32_16x16x32_bf16 v[68:71], a[192:195], a[16:19], v[116:119]
    v_cvt_pk_bf16_f32 v64, v64, v65
    ds_read_b64_tr_b16 a[234:235], v44 offset:20480
    v_mfma_f32_16x16x32_bf16 v[68:71], a[196:199], a[20:23], v[68:71]
    v_exp_f32 v66, v66
    v_mfma_f32_16x16x32_bf16 v[68:71], a[200:203], a[24:27], v[68:71]
    ds_read_b64_tr_b16 a[236:237], v45 offset:16384
    v_mfma_f32_16x16x32_bf16 v[68:71], a[204:207], a[28:31], v[68:71]
    v_exp_f32 v67, v67
    v_mfma_f32_16x16x32_bf16 v[76:79], a[192:195], a[32:35], v[120:123]
    ds_read_b64_tr_b16 a[238:239], v45 offset:20480
    v_cvt_pk_bf16_f32 v65, v66, v67
    v_mfma_f32_16x16x32_bf16 v[76:79], a[196:199], a[36:39], v[76:79]
    v_exp_f32 v72, v72
    v_mfma_f32_16x16x32_bf16 v[76:79], a[200:203], a[40:43], v[76:79]
    ds_read_b128 a[240:243], v26 offset:0
    v_mfma_f32_16x16x32_bf16 v[76:79], a[204:207], a[44:47], v[76:79]
    v_exp_f32 v73, v73
    v_mfma_f32_16x16x32_bf16 v[84:87], a[192:195], a[48:51], v[124:127]
    ds_read_b128 a[244:247], v27 offset:0
    v_cvt_pk_bf16_f32 v72, v72, v73
    v_mfma_f32_16x16x32_bf16 v[84:87], a[196:199], a[52:55], v[84:87]
    v_exp_f32 v74, v74
    v_mfma_f32_16x16x32_bf16 v[84:87], a[200:203], a[56:59], v[84:87]
    ds_read_b128 a[248:251], v28 offset:0
    v_mfma_f32_16x16x32_bf16 v[84:87], a[204:207], a[60:63], v[84:87]
    v_exp_f32 v75, v75
    v_mfma_f32_16x16x32_bf16 v[128:131], a[208:211], v[88:91], v[128:131]
    buffer_load_dwordx4 v9, s[28:31], s54 offen offset:1024 nt lds
    v_mfma_f32_16x16x32_bf16 v[160:163], a[208:211], v[96:99], v[160:163]
    v_exp_f32 v80, v80
    v_mfma_f32_16x16x32_bf16 v[192:195], a[208:211], v[104:107], v[192:195]
    v_cvt_pk_bf16_f32 v73, v74, v75
    ds_read_b128 a[252:255], v29 offset:0
    v_mfma_f32_16x16x32_bf16 a[64:67], a[80:83], v[88:91], a[64:67]
    v_exp_f32 v81, v81
    v_mfma_f32_16x16x32_bf16 a[68:71], a[80:83], v[96:99], a[68:71]
    ds_read_b128 a[192:195], v26 offset:4096
    v_cvt_pk_bf16_f32 v80, v80, v81
    v_mfma_f32_16x16x32_bf16 a[72:75], a[80:83], v[104:107], a[72:75]
    v_exp_f32 v82, v82
    v_mfma_f32_16x16x32_bf16 v[132:135], a[212:215], v[88:91], v[132:135]
    ds_read_b128 a[196:199], v27 offset:4096
    v_mfma_f32_16x16x32_bf16 v[164:167], a[212:215], v[96:99], v[164:167]
    v_exp_f32 v83, v83
    v_mfma_f32_16x16x32_bf16 v[196:199], a[212:215], v[104:107], v[196:199]
L_pad4:
    s_cbranch_execz L_pad8
    ds_read_b128 a[200:203], v28 offset:4096
    v_cvt_pk_bf16_f32 v81, v82, v83
    v_mfma_f32_16x16x32_bf16 v[136:139], a[216:219], v[88:91], v[136:139]
    v_exp_f32 v60, v60
    v_mfma_f32_16x16x32_bf16 v[168:171], a[216:219], v[96:99], v[168:171]
    ds_read_b128 a[204:207], v29 offset:4096
    v_mfma_f32_16x16x32_bf16 v[200:203], a[216:219], v[104:107], v[200:203]
    v_exp_f32 v61, v61
    v_mfma_f32_16x16x32_bf16 v[140:143], a[220:223], v[88:91], v[140:143]
    v_exp_f32 v62, v62
    v_mfma_f32_16x16x32_bf16 v[172:175], a[220:223], v[96:99], v[172:175]
    v_exp_f32 v63, v63
    v_mfma_f32_16x16x32_bf16 v[204:207], a[220:223], v[104:107], v[204:207]
    s_waitcnt lgkmcnt(2)
    v_exp_f32 v68, v68
    v_mfma_f32_16x16x32_bf16 v[144:147], a[224:227], v[88:91], v[144:147]
    buffer_load_dwordx4 v10, s[28:31], s54 offen offset:2048 nt lds
    v_mfma_f32_16x16x32_bf16 v[176:179], a[224:227], v[96:99], v[176:179]
    v_exp_f32 v69, v69
    v_mfma_f32_16x16x32_bf16 v[208:211], a[224:227], v[104:107], v[208:211]
    v_exp_f32 v70, v70
    v_mfma_f32_16x16x32_bf16 v[148:151], a[228:231], v[88:91], v[148:151]
    v_exp_f32 v71, v71
    v_mfma_f32_16x16x32_bf16 v[180:183], a[228:231], v[96:99], v[180:183]
    v_exp_f32 v76, v76
    v_mfma_f32_16x16x32_bf16 v[212:215], a[228:231], v[104:107], v[212:215]
    v_exp_f32 v77, v77
    v_mfma_f32_16x16x32_bf16 v[152:155], a[232:235], v[88:91], v[152:155]
    v_exp_f32 v78, v78
    v_mfma_f32_16x16x32_bf16 v[184:187], a[232:235], v[96:99], v[184:187]
    v_exp_f32 v79, v79
    v_mfma_f32_16x16x32_bf16 v[216:219], a[232:235], v[104:107], v[216:219]
    v_exp_f32 v84, v84
    v_mfma_f32_16x16x32_bf16 v[156:159], a[236:239], v[88:91], v[156:159]
    v_exp_f32 v85, v85
    v_mfma_f32_16x16x32_bf16 v[188:191], a[236:239], v[96:99], v[188:191]
    v_exp_f32 v86, v86
    v_mfma_f32_16x16x32_bf16 v[220:223], a[236:239], v[104:107], v[220:223]
    v_exp_f32 v87, v87
    v_mfma_f32_16x16x32_bf16 v[88:91], a[240:243], a[0:3], v[112:115]
    v_cvt_pk_bf16_f32 v58, v60, v61
    v_cvt_pk_bf16_f32 v59, v62, v63
    v_mfma_f32_16x16x32_bf16 v[88:91], a[244:247], a[4:7], v[88:91]
    v_cvt_pk_bf16_f32 v66, v68, v69
    v_cvt_pk_bf16_f32 v67, v70, v71
    v_mfma_f32_16x16x32_bf16 v[88:91], a[248:251], a[8:11], v[88:91]
    v_cvt_pk_bf16_f32 v74, v76, v77
    v_cvt_pk_bf16_f32 v75, v78, v79
    v_mfma_f32_16x16x32_bf16 v[88:91], a[252:255], a[12:15], v[88:91]
    buffer_load_dwordx4 v11, s[28:31], s54 offen offset:3072 nt lds
    v_mfma_f32_16x16x32_bf16 v[96:99], a[240:243], a[16:19], v[116:119]
    v_cvt_pk_bf16_f32 v82, v84, v85
    v_cvt_pk_bf16_f32 v83, v86, v87
    v_mfma_f32_16x16x32_bf16 v[96:99], a[244:247], a[20:23], v[96:99]
    v_mfma_f32_16x16x32_bf16 v[96:99], a[248:251], a[24:27], v[96:99]
    v_mfma_f32_16x16x32_bf16 v[96:99], a[252:255], a[28:31], v[96:99]
    v_mfma_f32_16x16x32_bf16 v[104:107], a[240:243], a[32:35], v[120:123]
    v_exp_f32 v88, v88
    v_mfma_f32_16x16x32_bf16 v[104:107], a[244:247], a[36:39], v[104:107]
    v_exp_f32 v89, v89
    v_mfma_f32_16x16x32_bf16 v[104:107], a[248:251], a[40:43], v[104:107]
    s_waitcnt vmcnt(8) lgkmcnt(0)
    v_exp_f32 v90, v90
    v_mfma_f32_16x16x32_bf16 v[104:107], a[252:255], a[44:47], v[104:107]
    s_barrier
    v_cvt_pk_bf16_f32 v88, v88, v89
    ds_read_b64_tr_b16 a[208:209], v30 offset:0
    v_mfma_f32_16x16x32_bf16 v[92:95], a[192:195], a[0:3], v[112:115]
    ds_read_b64_tr_b16 a[210:211], v30 offset:4096
    v_mfma_f32_16x16x32_bf16 v[92:95], a[196:199], a[4:7], v[92:95]
    ds_read_b64_tr_b16 a[212:213], v31 offset:0
    v_mfma_f32_16x16x32_bf16 v[92:95], a[200:203], a[8:11], v[92:95]
    ds_read_b64_tr_b16 a[214:215], v31 offset:4096
    v_mfma_f32_16x16x32_bf16 v[92:95], a[204:207], a[12:15], v[92:95]
    v_exp_f32 v91, v91
    v_mfma_f32_16x16x32_bf16 v[100:103], a[192:195], a[16:19], v[116:119]
    buffer_atomic_or v47, v19, s[48:51], s62 offen
    v_mfma_f32_16x16x32_bf16 v[100:103], a[196:199], a[20:23], v[100:103]
    s_add_u32 m0, s15, 0x10000
    ds_read_b64_tr_b16 a[216:217], v32 offset:0
    v_cvt_pk_bf16_f32 v89, v90, v91
    v_mfma_f32_16x16x32_bf16 v[100:103], a[200:203], a[24:27], v[100:103]
    s_add_u32 s54, s12, 0x14000
    ds_read_b64_tr_b16 a[218:219], v32 offset:4096
    v_mfma_f32_16x16x32_bf16 v[100:103], a[204:207], a[28:31], v[100:103]
    buffer_load_dwordx4 v12, s[32:35], s54 offen offset:0 nt lds
    v_mfma_f32_16x16x32_bf16 v[108:111], a[192:195], a[32:35], v[120:123]
    v_exp_f32 v96, v96
    v_mfma_f32_16x16x32_bf16 v[108:111], a[196:199], a[36:39], v[108:111]
    ds_read_b64_tr_b16 a[220:221], v33 offset:0
    v_mfma_f32_16x16x32_bf16 v[108:111], a[200:203], a[40:43], v[108:111]
    ds_read_b64_tr_b16 a[222:223], v33 offset:4096
    v_mfma_f32_16x16x32_bf16 v[108:111], a[204:207], a[44:47], v[108:111]
    s_waitcnt lgkmcnt(4)
    v_exp_f32 v97, v97
    v_mfma_f32_16x16x32_bf16 v[128:131], a[208:211], v[56:59], v[128:131]
    ds_read_b64_tr_b16 a[224:225], v34 offset:0
    v_cvt_pk_bf16_f32 v96, v96, v97
    v_mfma_f32_16x16x32_bf16 v[160:163], a[208:211], v[64:67], v[160:163]
    v_exp_f32 v98, v98
    v_mfma_f32_16x16x32_bf16 v[192:195], a[208:211], v[72:75], v[192:195]
    ds_read_b64_tr_b16 a[226:227], v34 offset:4096
    v_mfma_f32_16x16x32_bf16 v[224:227], a[208:211], v[80:83], v[224:227]
    v_exp_f32 v99, v99
    v_mfma_f32_16x16x32_bf16 a[64:67], a[80:83], v[56:59], a[64:67]
    ds_read_b64_tr_b16 a[228:229], v35 offset:0
    v_cvt_pk_bf16_f32 v97, v98, v99
    v_mfma_f32_16x16x32_bf16 a[68:71], a[80:83], v[64:67], a[68:71]
    v_exp_f32 v104, v104
    v_mfma_f32_16x16x32_bf16 a[72:75], a[80:83], v[72:75], a[72:75]
    ds_read_b64_tr_b16 a[230:231], v35 offset:4096
    v_mfma_f32_16x16x32_bf16 a[76:79], a[80:83], v[80:83], a[76:79]
    v_exp_f32 v105, v105
    v_mfma_f32_16x16x32_bf16 v[132:135], a[212:215], v[56:59], v[132:135]
    ds_read_b64_tr_b16 a[232:233], v36 offset:0
    v_cvt_pk_bf16_f32 v104, v104, v105
    v_mfma_f32_16x16x32_bf16 v[164:167], a[212:215], v[64:67], v[164:167]
    v_exp_f32 v106, v106
    v_mfma_f32_16x16x32_bf16 v[196:199], a[212:215], v[72:75], v[196:199]
    buffer_load_dwordx4 v13, s[32:35], s54 offen offset:1024 nt lds
    v_mfma_f32_16x16x32_bf16 v[228:231], a[212:215], v[80:83], v[228:231]
    s_waitcnt lgkmcnt(3)
    ds_read_b64_tr_b16 a[234:235], v36 offset:4096
    v_mfma_f32_16x16x32_bf16 v[136:139], a[216:219], v[56:59], v[136:139]
    v_exp_f32 v107, v107
    v_mfma_f32_16x16x32_bf16 v[168:171], a[216:219], v[64:67], v[168:171]
    ds_read_b64_tr_b16 a[236:237], v37 offset:0
    v_cvt_pk_bf16_f32 v105, v106, v107
    v_mfma_f32_16x16x32_bf16 v[200:203], a[216:219], v[72:75], v[200:203]
    ds_read_b64_tr_b16 a[238:239], v37 offset:4096
    v_mfma_f32_16x16x32_bf16 v[232:235], a[216:219], v[80:83], v[232:235]
    v_exp_f32 v92, v92
    v_mfma_f32_16x16x32_bf16 v[140:143], a[220:223], v[56:59], v[140:143]
    ds_read_b128 a[240:243], v22 offset:49152
    v_mfma_f32_16x16x32_bf16 v[172:175], a[220:223], v[64:67], v[172:175]
    v_exp_f32 v93, v93
    v_mfma_f32_16x16x32_bf16 v[204:207], a[220:223], v[72:75], v[204:207]
    ds_read_b128 a[244:247], v23 offset:49152
    v_cvt_pk_bf16_f32 v90, v92, v93
    v_mfma_f32_16x16x32_bf16 v[236:239], a[220:223], v[80:83], v[236:239]
    v_exp_f32 v94, v94
    v_mfma_f32_16x16x32_bf16 v[144:147], a[224:227], v[56:59], v[144:147]
    ds_read_b128 a[248:251], v24 offset:49152
    v_mfma_f32_16x16x32_bf16 v[176:179], a[224:227], v[64:67], v[176:179]
    ds_read_b128 a[252:255], v25 offset:49152
    v_mfma_f32_16x16x32_bf16 v[208:211], a[224:227], v[72:75], v[208:211]
    v_exp_f32 v95, v95
    v_mfma_f32_16x16x32_bf16 v[240:243], a[224:227], v[80:83], v[240:243]
    s_waitcnt lgkmcnt(4)
    ds_read_b128 a[192:195], v22 offset:53248
    v_cvt_pk_bf16_f32 v91, v94, v95
    v_mfma_f32_16x16x32_bf16 v[148:151], a[228:231], v[56:59], v[148:151]
    buffer_load_dwordx4 v12, s[32:35], s54 offen offset:2048 nt lds
    v_mfma_f32_16x16x32_bf16 v[180:183], a[228:231], v[64:67], v[180:183]
    v_exp_f32 v100, v100
    v_mfma_f32_16x16x32_bf16 v[212:215], a[228:231], v[72:75], v[212:215]
    ds_read_b128 a[196:199], v23 offset:53248
    v_mfma_f32_16x16x32_bf16 v[244:247], a[228:231], v[80:83], v[244:247]
    v_exp_f32 v101, v101
    v_mfma_f32_16x16x32_bf16 v[152:155], a[232:235], v[56:59], v[152:155]
    ds_read_b128 a[200:203], v24 offset:53248
    v_cvt_pk_bf16_f32 v98, v100, v101
    v_mfma_f32_16x16x32_bf16 v[184:187], a[232:235], v[64:67], v[184:187]
    v_exp_f32 v102, v102
    v_mfma_f32_16x16x32_bf16 v[216:219], a[232:235], v[72:75], v[216:219]
    ds_read_b128 a[204:207], v25 offset:53248
    v_mfma_f32_16x16x32_bf16 v[248:251], a[232:235], v[80:83], v[248:251]
    v_exp_f32 v103, v103
    v_mfma_f32_16x16x32_bf16 v[156:159], a[236:239], v[56:59], v[156:159]
    ds_read_b64_tr_b16 a[208:209], v38 offset:0
    v_cvt_pk_bf16_f32 v99, v102, v103
    v_mfma_f32_16x16x32_bf16 v[188:191], a[236:239], v[64:67], v[188:191]
    v_exp_f32 v108, v108
    v_mfma_f32_16x16x32_bf16 v[220:223], a[236:239], v[72:75], v[220:223]
    ds_read_b64_tr_b16 a[210:211], v38 offset:4096
    v_mfma_f32_16x16x32_bf16 v[252:255], a[236:239], v[80:83], v[252:255]
    s_waitcnt lgkmcnt(4)
    v_exp_f32 v109, v109
    v_mfma_f32_16x16x32_bf16 v[56:59], a[240:243], a[0:3], v[112:115]
    ds_read_b64_tr_b16 a[212:213], v39 offset:0
    v_cvt_pk_bf16_f32 v106, v108, v109
    v_mfma_f32_16x16x32_bf16 v[56:59], a[244:247], a[4:7], v[56:59]
    v_exp_f32 v110, v110
    v_mfma_f32_16x16x32_bf16 v[56:59], a[248:251], a[8:11], v[56:59]
    ds_read_b64_tr_b16 a[214:215], v39 offset:4096
    v_mfma_f32_16x16x32_bf16 v[56:59], a[252:255], a[12:15], v[56:59]
    buffer_load_dwordx4 v13, s[32:35], s54 offen offset:3072 nt lds
    v_mfma_f32_16x16x32_bf16 v[64:67], a[240:243], a[16:19], v[116:119]
    v_exp_f32 v111, v111
    v_mfma_f32_16x16x32_bf16 v[64:67], a[244:247], a[20:23], v[64:67]
    ds_read_b64_tr_b16 a[216:217], v40 offset:0
    v_cvt_pk_bf16_f32 v107, v110, v111
    v_mfma_f32_16x16x32_bf16 v[64:67], a[248:251], a[24:27], v[64:67]
    ds_read_b64_tr_b16 a[218:219], v40 offset:4096
    v_mfma_f32_16x16x32_bf16 v[64:67], a[252:255], a[28:31], v[64:67]
    ds_read_b64_tr_b16 a[220:221], v41 offset:0
    v_mfma_f32_16x16x32_bf16 v[72:75], a[240:243], a[32:35], v[120:123]
    v_exp_f32 v56, v56
    v_mfma_f32_16x16x32_bf16 v[72:75], a[244:247], a[36:39], v[72:75]
    ds_read_b64_tr_b16 a[222:223], v41 offset:4096
    v_mfma_f32_16x16x32_bf16 v[72:75], a[248:251], a[40:43], v[72:75]
    v_exp_f32 v57, v57
    v_mfma_f32_16x16x32_bf16 v[72:75], a[252:255], a[44:47], v[72:75]
    ds_read_b64_tr_b16 a[224:225], v42 offset:0
    v_cvt_pk_bf16_f32 v56, v56, v57
    v_mfma_f32_16x16x32_bf16 v[80:83], a[240:243], a[48:51], v[124:127]
    v_exp_f32 v58, v58
    v_mfma_f32_16x16x32_bf16 v[80:83], a[244:247], a[52:55], v[80:83]
    ds_read_b64_tr_b16 a[226:227], v42 offset:4096
    v_mfma_f32_16x16x32_bf16 v[80:83], a[248:251], a[56:59], v[80:83]
    v_exp_f32 v59, v59
    v_mfma_f32_16x16x32_bf16 v[80:83], a[252:255], a[60:63], v[80:83]
    s_waitcnt lgkmcnt(3)
    ds_read_b64_tr_b16 a[228:229], v43 offset:0
    v_cvt_pk_bf16_f32 v57, v58, v59
    v_mfma_f32_16x16x32_bf16 v[60:63], a[192:195], a[0:3], v[112:115]
    s_add_u32 m0, s15, 0x1c000
    v_exp_f32 v64, v64
    v_mfma_f32_16x16x32_bf16 v[60:63], a[196:199], a[4:7], v[60:63]
    s_add_u32 s54, s12, 0x18000
    ds_read_b64_tr_b16 a[230:231], v43 offset:4096
    v_mfma_f32_16x16x32_bf16 v[60:63], a[200:203], a[8:11], v[60:63]
    buffer_load_dwordx4 v8, s[28:31], s54 offen offset:0 nt lds
    v_mfma_f32_16x16x32_bf16 v[60:63], a[204:207], a[12:15], v[60:63]
    v_exp_f32 v65, v65
    v_mfma_f32_16x16x32_bf16 v[68:71], a[192:195], a[16:19], v[116:119]
    ds_read_b64_tr_b16 a[232:233], v44 offset:0
    v_cvt_pk_bf16_f32 v64, v64, v65
    v_mfma_f32_16x16x32_bf16 v[68:71], a[196:199], a[20:23], v[68:71]
    v_exp_f32 v66, v66
    v_mfma_f32_16x16x32_bf16 v[68:71], a[200:203], a[24:27], v[68:71]
    ds_read_b64_tr_b16 a[234:235], v44 offset:4096
    v_mfma_f32_16x16x32_bf16 v[68:71], a[204:207], a[28:31], v[68:71]
    v_exp_f32 v67, v67
    v_mfma_f32_16x16x32_bf16 v[76:79], a[192:195], a[32:35], v[120:123]
    ds_read_b64_tr_b16 a[236:237], v45 offset:0
    v_cvt_pk_bf16_f32 v65, v66, v67
    v_mfma_f32_16x16x32_bf16 v[76:79], a[196:199], a[36:39], v[76:79]
    v_exp_f32 v72, v72
    v_mfma_f32_16x16x32_bf16 v[76:79], a[200:203], a[40:43], v[76:79]
    ds_read_b64_tr_b16 a[238:239], v45 offset:4096
    v_mfma_f32_16x16x32_bf16 v[76:79], a[204:207], a[44:47], v[76:79]
    v_exp_f32 v73, v73
    v_mfma_f32_16x16x32_bf16 v[84:87], a[192:195], a[48:51], v[124:127]
    ds_read_b128 a[240:243], v26 offset:49152
    v_cvt_pk_bf16_f32 v72, v72, v73
    v_mfma_f32_16x16x32_bf16 v[84:87], a[196:199], a[52:55], v[84:87]
    v_exp_f32 v74, v74
    v_mfma_f32_16x16x32_bf16 v[84:87], a[200:203], a[56:59], v[84:87]
    ds_read_b128 a[244:247], v27 offset:49152
    v_mfma_f32_16x16x32_bf16 v[84:87], a[204:207], a[60:63], v[84:87]
    v_exp_f32 v75, v75
    v_mfma_f32_16x16x32_bf16 v[128:131], a[208:211], v[88:91], v[128:131]
    buffer_load_dwordx4 v9, s[28:31], s54 offen offset:1024 nt lds
    v_mfma_f32_16x16x32_bf16 v[160:163], a[208:211], v[96:99], v[160:163]
    v_exp_f32 v80, v80
    v_mfma_f32_16x16x32_bf16 v[192:195], a[208:211], v[104:107], v[192:195]
    ds_read_b128 a[248:251], v28 offset:49152
    v_cvt_pk_bf16_f32 v73, v74, v75
    v_mfma_f32_16x16x32_bf16 a[64:67], a[80:83], v[88:91], a[64:67]
    v_exp_f32 v81, v81
    v_mfma_f32_16x16x32_bf16 a[68:71], a[80:83], v[96:99], a[68:71]
    ds_read_b128 a[252:255], v29 offset:49152
    v_cvt_pk_bf16_f32 v80, v80, v81
    v_mfma_f32_16x16x32_bf16 a[72:75], a[80:83], v[104:107], a[72:75]
    v_exp_f32 v82, v82
    v_mfma_f32_16x16x32_bf16 v[132:135], a[212:215], v[88:91], v[132:135]
    ds_read_b128 a[192:195], v26 offset:53248
    v_mfma_f32_16x16x32_bf16 v[164:167], a[212:215], v[96:99], v[164:167]
    v_exp_f32 v83, v83
    v_mfma_f32_16x16x32_bf16 v[196:199], a[212:215], v[104:107], v[196:199]
    ds_read_b128 a[196:199], v27 offset:53248
    v_cvt_pk_bf16_f32 v81, v82, v83
    v_mfma_f32_16x16x32_bf16 v[136:139], a[216:219], v[88:91], v[136:139]
    v_exp_f32 v60, v60
    v_mfma_f32_16x16x32_bf16 v[168:171], a[216:219], v[96:99], v[168:171]
    ds_read_b128 a[200:203], v28 offset:53248
    v_mfma_f32_16x16x32_bf16 v[200:203], a[216:219], v[104:107], v[200:203]
    s_waitcnt lgkmcnt(4)
    v_exp_f32 v61, v61
    v_mfma_f32_16x16x32_bf16 v[140:143], a[220:223], v[88:91], v[140:143]
    ds_read_b128 a[204:207], v29 offset:53248
    v_cvt_pk_bf16_f32 v58, v60, v61
    v_mfma_f32_16x16x32_bf16 v[172:175], a[220:223], v[96:99], v[172:175]
    v_exp_f32 v62, v62
    v_mfma_f32_16x16x32_bf16 v[204:207], a[220:223], v[104:107], v[204:207]
    v_exp_f32 v63, v63
    v_mfma_f32_16x16x32_bf16 v[144:147], a[224:227], v[88:91], v[144:147]
    buffer_load_dwordx4 v10, s[28:31], s54 offen offset:2048 nt lds
    v_mfma_f32_16x16x32_bf16 v[176:179], a[224:227], v[96:99], v[176:179]
    v_exp_f32 v68, v68
    v_mfma_f32_16x16x32_bf16 v[208:211], a[224:227], v[104:107], v[208:211]
    v_exp_f32 v69, v69
    v_mfma_f32_16x16x32_bf16 v[148:151], a[228:231], v[88:91], v[148:151]
    v_exp_f32 v70, v70
    v_mfma_f32_16x16x32_bf16 v[180:183], a[228:231], v[96:99], v[180:183]
    v_exp_f32 v71, v71
    v_mfma_f32_16x16x32_bf16 v[212:215], a[228:231], v[104:107], v[212:215]
    v_exp_f32 v76, v76
    v_mfma_f32_16x16x32_bf16 v[152:155], a[232:235], v[88:91], v[152:155]
    v_exp_f32 v77, v77
    v_mfma_f32_16x16x32_bf16 v[184:187], a[232:235], v[96:99], v[184:187]
    v_exp_f32 v78, v78
    v_mfma_f32_16x16x32_bf16 v[216:219], a[232:235], v[104:107], v[216:219]
    v_exp_f32 v79, v79
    v_mfma_f32_16x16x32_bf16 v[156:159], a[236:239], v[88:91], v[156:159]
    v_exp_f32 v84, v84
    v_mfma_f32_16x16x32_bf16 v[188:191], a[236:239], v[96:99], v[188:191]
    v_exp_f32 v85, v85
    v_mfma_f32_16x16x32_bf16 v[220:223], a[236:239], v[104:107], v[220:223]
    v_exp_f32 v86, v86
    v_mfma_f32_16x16x32_bf16 v[88:91], a[240:243], a[0:3], v[112:115]
    v_exp_f32 v87, v87
    v_mfma_f32_16x16x32_bf16 v[88:91], a[244:247], a[4:7], v[88:91]
    v_cvt_pk_bf16_f32 v59, v62, v63
    v_cvt_pk_bf16_f32 v66, v68, v69
    v_mfma_f32_16x16x32_bf16 v[88:91], a[248:251], a[8:11], v[88:91]
    s_waitcnt lgkmcnt(0)
    v_cvt_pk_bf16_f32 v67, v70, v71
    v_cvt_pk_bf16_f32 v74, v76, v77
    v_mfma_f32_16x16x32_bf16 v[88:91], a[252:255], a[12:15], v[88:91]
    buffer_load_dwordx4 v11, s[28:31], s54 offen offset:3072 nt lds
    v_mfma_f32_16x16x32_bf16 v[96:99], a[240:243], a[16:19], v[116:119]
    v_cvt_pk_bf16_f32 v75, v78, v79
    v_cvt_pk_bf16_f32 v82, v84, v85
    v_mfma_f32_16x16x32_bf16 v[96:99], a[244:247], a[20:23], v[96:99]
    v_cvt_pk_bf16_f32 v83, v86, v87
    v_mfma_f32_16x16x32_bf16 v[96:99], a[248:251], a[24:27], v[96:99]
    v_mfma_f32_16x16x32_bf16 v[96:99], a[252:255], a[28:31], v[96:99]
    v_mfma_f32_16x16x32_bf16 v[104:107], a[240:243], a[32:35], v[120:123]
    v_exp_f32 v88, v88
    v_mfma_f32_16x16x32_bf16 v[104:107], a[244:247], a[36:39], v[104:107]
    v_exp_f32 v89, v89
    v_mfma_f32_16x16x32_bf16 v[104:107], a[248:251], a[40:43], v[104:107]
    s_waitcnt vmcnt(9)
    v_exp_f32 v90, v90
    v_mfma_f32_16x16x32_bf16 v[104:107], a[252:255], a[44:47], v[104:107]
    s_barrier
    ds_read_b64_tr_b16 a[208:209], v30 offset:49152
    v_cvt_pk_bf16_f32 v88, v88, v89
    v_mfma_f32_16x16x32_bf16 v[92:95], a[192:195], a[0:3], v[112:115]
    ds_read_b64_tr_b16 a[210:211], v30 offset:53248
    v_mfma_f32_16x16x32_bf16 v[92:95], a[196:199], a[4:7], v[92:95]
    ds_read_b64_tr_b16 a[212:213], v31 offset:49152
    v_mfma_f32_16x16x32_bf16 v[92:95], a[200:203], a[8:11], v[92:95]
    ds_read_b64_tr_b16 a[214:215], v31 offset:53248
    v_mfma_f32_16x16x32_bf16 v[92:95], a[204:207], a[12:15], v[92:95]
    v_exp_f32 v91, v91
    v_mfma_f32_16x16x32_bf16 v[100:103], a[192:195], a[16:19], v[116:119]
    ds_read_b64_tr_b16 a[216:217], v32 offset:49152
    v_cvt_pk_bf16_f32 v89, v90, v91
    v_mfma_f32_16x16x32_bf16 v[100:103], a[196:199], a[20:23], v[100:103]
    s_add_u32 m0, s15, 0xc000
    v_exp_f32 v96, v96
    v_mfma_f32_16x16x32_bf16 v[100:103], a[200:203], a[24:27], v[100:103]
    s_add_u32 s54, s12, 0x18000
    ds_read_b64_tr_b16 a[218:219], v32 offset:53248
    v_mfma_f32_16x16x32_bf16 v[100:103], a[204:207], a[28:31], v[100:103]
    buffer_load_dwordx4 v12, s[32:35], s54 offen offset:0 nt lds
    v_mfma_f32_16x16x32_bf16 v[108:111], a[192:195], a[32:35], v[120:123]
    v_exp_f32 v97, v97
    v_mfma_f32_16x16x32_bf16 v[108:111], a[196:199], a[36:39], v[108:111]
    ds_read_b64_tr_b16 a[220:221], v33 offset:49152
    v_cvt_pk_bf16_f32 v96, v96, v97
    v_mfma_f32_16x16x32_bf16 v[108:111], a[200:203], a[40:43], v[108:111]
    ds_read_b64_tr_b16 a[222:223], v33 offset:53248
    v_mfma_f32_16x16x32_bf16 v[108:111], a[204:207], a[44:47], v[108:111]
    s_waitcnt lgkmcnt(4)
    v_exp_f32 v98, v98
    v_mfma_f32_16x16x32_bf16 v[128:131], a[208:211], v[56:59], v[128:131]
    ds_read_b64_tr_b16 a[224:225], v34 offset:49152
    v_mfma_f32_16x16x32_bf16 v[160:163], a[208:211], v[64:67], v[160:163]
    v_exp_f32 v99, v99
    v_mfma_f32_16x16x32_bf16 v[192:195], a[208:211], v[72:75], v[192:195]
    ds_read_b64_tr_b16 a[226:227], v34 offset:53248
    v_cvt_pk_bf16_f32 v97, v98, v99
    v_mfma_f32_16x16x32_bf16 v[224:227], a[208:211], v[80:83], v[224:227]
    v_exp_f32 v104, v104
    v_mfma_f32_16x16x32_bf16 a[64:67], a[80:83], v[56:59], a[64:67]
    ds_read_b64_tr_b16 a[228:229], v35 offset:49152
    v_mfma_f32_16x16x32_bf16 a[68:71], a[80:83], v[64:67], a[68:71]
    v_exp_f32 v105, v105
    v_mfma_f32_16x16x32_bf16 a[72:75], a[80:83], v[72:75], a[72:75]
    ds_read_b64_tr_b16 a[230:231], v35 offset:53248
    v_cvt_pk_bf16_f32 v104, v104, v105
    v_mfma_f32_16x16x32_bf16 a[76:79], a[80:83], v[80:83], a[76:79]
    v_exp_f32 v106, v106
    v_mfma_f32_16x16x32_bf16 v[132:135], a[212:215], v[56:59], v[132:135]
    ds_read_b64_tr_b16 a[232:233], v36 offset:49152
    v_mfma_f32_16x16x32_bf16 v[164:167], a[212:215], v[64:67], v[164:167]
    v_exp_f32 v107, v107
    v_mfma_f32_16x16x32_bf16 v[196:199], a[212:215], v[72:75], v[196:199]
    buffer_load_dwordx4 v13, s[32:35], s54 offen offset:1024 nt lds
    v_mfma_f32_16x16x32_bf16 v[228:231], a[212:215], v[80:83], v[228:231]
    s_waitcnt lgkmcnt(3)
    ds_read_b64_tr_b16 a[234:235], v36 offset:53248
    v_cvt_pk_bf16_f32 v105, v106, v107
    v_mfma_f32_16x16x32_bf16 v[136:139], a[216:219], v[56:59], v[136:139]
    v_exp_f32 v92, v92
    v_mfma_f32_16x16x32_bf16 v[168:171], a[216:219], v[64:67], v[168:171]
    ds_read_b64_tr_b16 a[236:237], v37 offset:49152
    v_mfma_f32_16x16x32_bf16 v[200:203], a[216:219], v[72:75], v[200:203]
    ds_read_b64_tr_b16 a[238:239], v37 offset:53248
    v_mfma_f32_16x16x32_bf16 v[232:235], a[216:219], v[80:83], v[232:235]
    v_exp_f32 v93, v93
    v_mfma_f32_16x16x32_bf16 v[140:143], a[220:223], v[56:59], v[140:143]
    ds_read_b128 a[240:243], v22 offset:32768
    v_cvt_pk_bf16_f32 v90, v92, v93
    v_mfma_f32_16x16x32_bf16 v[172:175], a[220:223], v[64:67], v[172:175]
    v_exp_f32 v94, v94
    v_mfma_f32_16x16x32_bf16 v[204:207], a[220:223], v[72:75], v[204:207]
    ds_read_b128 a[244:247], v23 offset:32768
    v_mfma_f32_16x16x32_bf16 v[236:239], a[220:223], v[80:83], v[236:239]
    v_exp_f32 v95, v95
    v_mfma_f32_16x16x32_bf16 v[144:147], a[224:227], v[56:59], v[144:147]
    ds_read_b128 a[248:251], v24 offset:32768
    v_cvt_pk_bf16_f32 v91, v94, v95
    v_mfma_f32_16x16x32_bf16 v[176:179], a[224:227], v[64:67], v[176:179]
    ds_read_b128 a[252:255], v25 offset:32768
    v_mfma_f32_16x16x32_bf16 v[208:211], a[224:227], v[72:75], v[208:211]
    v_exp_f32 v100, v100
    v_mfma_f32_16x16x32_bf16 v[240:243], a[224:227], v[80:83], v[240:243]
    s_waitcnt lgkmcnt(4)
    ds_read_b128 a[192:195], v22 offset:36864
    v_mfma_f32_16x16x32_bf16 v[148:151], a[228:231], v[56:59], v[148:151]
    buffer_load_dwordx4 v12, s[32:35], s54 offen offset:2048 nt lds
    v_mfma_f32_16x16x32_bf16 v[180:183], a[228:231], v[64:67], v[180:183]
    v_exp_f32 v101, v101
    v_mfma_f32_16x16x32_bf16 v[212:215], a[228:231], v[72:75], v[212:215]
    ds_read_b128 a[196:199], v23 offset:36864
    v_cvt_pk_bf16_f32 v98, v100, v101
    v_mfma_f32_16x16x32_bf16 v[244:247], a[228:231], v[80:83], v[244:247]
    v_exp_f32 v102, v102
    v_mfma_f32_16x16x32_bf16 v[152:155], a[232:235], v[56:59], v[152:155]
    ds_read_b128 a[200:203], v24 offset:36864
    v_mfma_f32_16x16x32_bf16 v[184:187], a[232:235], v[64:67], v[184:187]
    v_exp_f32 v103, v103
    v_mfma_f32_16x16x32_bf16 v[216:219], a[232:235], v[72:75], v[216:219]
    ds_read_b128 a[204:207], v25 offset:36864
    v_cvt_pk_bf16_f32 v99, v102, v103
    v_mfma_f32_16x16x32_bf16 v[248:251], a[232:235], v[80:83], v[248:251]
    v_exp_f32 v108, v108
    v_mfma_f32_16x16x32_bf16 v[156:159], a[236:239], v[56:59], v[156:159]
    ds_read_b64_tr_b16 a[208:209], v38 offset:49152
    v_mfma_f32_16x16x32_bf16 v[188:191], a[236:239], v[64:67], v[188:191]
    v_exp_f32 v109, v109
    v_mfma_f32_16x16x32_bf16 v[220:223], a[236:239], v[72:75], v[220:223]
    ds_read_b64_tr_b16 a[210:211], v38 offset:53248
    v_cvt_pk_bf16_f32 v106, v108, v109
    v_mfma_f32_16x16x32_bf16 v[252:255], a[236:239], v[80:83], v[252:255]
    s_waitcnt lgkmcnt(4)
    v_exp_f32 v110, v110
    v_mfma_f32_16x16x32_bf16 v[56:59], a[240:243], a[0:3], v[112:115]
    ds_read_b64_tr_b16 a[212:213], v39 offset:49152
    v_mfma_f32_16x16x32_bf16 v[56:59], a[244:247], a[4:7], v[56:59]
    v_exp_f32 v111, v111
    v_mfma_f32_16x16x32_bf16 v[56:59], a[248:251], a[8:11], v[56:59]
    ds_read_b64_tr_b16 a[214:215], v39 offset:53248
    v_cvt_pk_bf16_f32 v107, v110, v111
    v_mfma_f32_16x16x32_bf16 v[56:59], a[252:255], a[12:15], v[56:59]
    buffer_load_dwordx4 v13, s[32:35], s54 offen offset:3072 nt lds
    v_mfma_f32_16x16x32_bf16 v[64:67], a[240:243], a[16:19], v[116:119]
    ds_read_b64_tr_b16 a[216:217], v40 offset:49152
    v_mfma_f32_16x16x32_bf16 v[64:67], a[244:247], a[20:23], v[64:67]
    ds_read_b64_tr_b16 a[218:219], v40 offset:53248
    v_mfma_f32_16x16x32_bf16 v[64:67], a[248:251], a[24:27], v[64:67]
    ds_read_b64_tr_b16 a[220:221], v41 offset:49152
    v_mfma_f32_16x16x32_bf16 v[64:67], a[252:255], a[28:31], v[64:67]
    ds_read_b64_tr_b16 a[222:223], v41 offset:53248
    v_mfma_f32_16x16x32_bf16 v[72:75], a[240:243], a[32:35], v[120:123]
    v_exp_f32 v56, v56
    v_mfma_f32_16x16x32_bf16 v[72:75], a[244:247], a[36:39], v[72:75]
    ds_read_b64_tr_b16 a[224:225], v42 offset:49152
    v_mfma_f32_16x16x32_bf16 v[72:75], a[248:251], a[40:43], v[72:75]
    v_exp_f32 v57, v57
    v_mfma_f32_16x16x32_bf16 v[72:75], a[252:255], a[44:47], v[72:75]
    ds_read_b64_tr_b16 a[226:227], v42 offset:53248
    v_cvt_pk_bf16_f32 v56, v56, v57
    v_mfma_f32_16x16x32_bf16 v[80:83], a[240:243], a[48:51], v[124:127]
    v_exp_f32 v58, v58
    v_mfma_f32_16x16x32_bf16 v[80:83], a[244:247], a[52:55], v[80:83]
    ds_read_b64_tr_b16 a[228:229], v43 offset:49152
    v_mfma_f32_16x16x32_bf16 v[80:83], a[248:251], a[56:59], v[80:83]
    v_exp_f32 v59, v59
    v_mfma_f32_16x16x32_bf16 v[80:83], a[252:255], a[60:63], v[80:83]
    s_waitcnt lgkmcnt(3)
    ds_read_b64_tr_b16 a[230:231], v43 offset:53248
    v_cvt_pk_bf16_f32 v57, v58, v59
    v_mfma_f32_16x16x32_bf16 v[60:63], a[192:195], a[0:3], v[112:115]
    s_add_u32 m0, s15, 0x18000
    v_exp_f32 v64, v64
    v_mfma_f32_16x16x32_bf16 v[60:63], a[196:199], a[4:7], v[60:63]
    s_add_u32 s54, s12, 0x1c000
    ds_read_b64_tr_b16 a[232:233], v44 offset:49152
    v_mfma_f32_16x16x32_bf16 v[60:63], a[200:203], a[8:11], v[60:63]
    buffer_load_dwordx4 v8, s[28:31], s54 offen offset:0 nt lds
    v_mfma_f32_16x16x32_bf16 v[60:63], a[204:207], a[12:15], v[60:63]
    v_exp_f32 v65, v65
    v_mfma_f32_16x16x32_bf16 v[68:71], a[192:195], a[16:19], v[116:119]
    ds_read_b64_tr_b16 a[234:235], v44 offset:53248
    v_cvt_pk_bf16_f32 v64, v64, v65
    v_mfma_f32_16x16x32_bf16 v[68:71], a[196:199], a[20:23], v[68:71]
    v_exp_f32 v66, v66
    v_mfma_f32_16x16x32_bf16 v[68:71], a[200:203], a[24:27], v[68:71]
    ds_read_b64_tr_b16 a[236:237], v45 offset:49152
    v_mfma_f32_16x16x32_bf16 v[68:71], a[204:207], a[28:31], v[68:71]
    v_exp_f32 v67, v67
    v_mfma_f32_16x16x32_bf16 v[76:79], a[192:195], a[32:35], v[120:123]
    ds_read_b64_tr_b16 a[238:239], v45 offset:53248
    v_cvt_pk_bf16_f32 v65, v66, v67
    v_mfma_f32_16x16x32_bf16 v[76:79], a[196:199], a[36:39], v[76:79]
    v_exp_f32 v72, v72
    v_mfma_f32_16x16x32_bf16 v[76:79], a[200:203], a[40:43], v[76:79]
    ds_read_b128 a[240:243], v26 offset:32768
    v_mfma_f32_16x16x32_bf16 v[76:79], a[204:207], a[44:47], v[76:79]
    v_exp_f32 v73, v73
    v_mfma_f32_16x16x32_bf16 v[84:87], a[192:195], a[48:51], v[124:127]
    ds_read_b128 a[244:247], v27 offset:32768
    v_cvt_pk_bf16_f32 v72, v72, v73
    v_mfma_f32_16x16x32_bf16 v[84:87], a[196:199], a[52:55], v[84:87]
    v_exp_f32 v74, v74
    v_mfma_f32_16x16x32_bf16 v[84:87], a[200:203], a[56:59], v[84:87]
    ds_read_b128 a[248:251], v28 offset:32768
    v_mfma_f32_16x16x32_bf16 v[84:87], a[204:207], a[60:63], v[84:87]
    v_exp_f32 v75, v75
    v_mfma_f32_16x16x32_bf16 v[128:131], a[208:211], v[88:91], v[128:131]
    buffer_load_dwordx4 v9, s[28:31], s54 offen offset:1024 nt lds
    v_mfma_f32_16x16x32_bf16 v[160:163], a[208:211], v[96:99], v[160:163]
    v_exp_f32 v80, v80
    v_mfma_f32_16x16x32_bf16 v[192:195], a[208:211], v[104:107], v[192:195]
    ds_read_b128 a[252:255], v29 offset:32768
    v_cvt_pk_bf16_f32 v73, v74, v75
    v_mfma_f32_16x16x32_bf16 a[64:67], a[80:83], v[88:91], a[64:67]
    v_exp_f32 v81, v81
    v_mfma_f32_16x16x32_bf16 a[68:71], a[80:83], v[96:99], a[68:71]
    ds_read_b128 a[192:195], v26 offset:36864
    v_cvt_pk_bf16_f32 v80, v80, v81
    v_mfma_f32_16x16x32_bf16 a[72:75], a[80:83], v[104:107], a[72:75]
    v_exp_f32 v82, v82
    v_mfma_f32_16x16x32_bf16 v[132:135], a[212:215], v[88:91], v[132:135]
    ds_read_b128 a[196:199], v27 offset:36864
    v_mfma_f32_16x16x32_bf16 v[164:167], a[212:215], v[96:99], v[164:167]
    v_exp_f32 v83, v83
    v_mfma_f32_16x16x32_bf16 v[196:199], a[212:215], v[104:107], v[196:199]
    ds_read_b128 a[200:203], v28 offset:36864
    v_cvt_pk_bf16_f32 v81, v82, v83
    v_mfma_f32_16x16x32_bf16 v[136:139], a[216:219], v[88:91], v[136:139]
    v_exp_f32 v60, v60
    v_mfma_f32_16x16x32_bf16 v[168:171], a[216:219], v[96:99], v[168:171]
    ds_read_b128 a[204:207], v29 offset:36864
    v_mfma_f32_16x16x32_bf16 v[200:203], a[216:219], v[104:107], v[200:203]
    v_exp_f32 v61, v61
    v_mfma_f32_16x16x32_bf16 v[140:143], a[220:223], v[88:91], v[140:143]
    v_exp_f32 v62, v62
    v_mfma_f32_16x16x32_bf16 v[172:175], a[220:223], v[96:99], v[172:175]
    v_exp_f32 v63, v63
    v_mfma_f32_16x16x32_bf16 v[204:207], a[220:223], v[104:107], v[204:207]
    s_waitcnt lgkmcnt(2)
    v_exp_f32 v68, v68
    v_mfma_f32_16x16x32_bf16 v[144:147], a[224:227], v[88:91], v[144:147]
    buffer_load_dwordx4 v10, s[28:31], s54 offen offset:2048 nt lds
    v_mfma_f32_16x16x32_bf16 v[176:179], a[224:227], v[96:99], v[176:179]
    v_exp_f32 v69, v69
    v_mfma_f32_16x16x32_bf16 v[208:211], a[224:227], v[104:107], v[208:211]
    v_exp_f32 v70, v70
    v_mfma_f32_16x16x32_bf16 v[148:151], a[228:231], v[88:91], v[148:151]
    v_exp_f32 v71, v71
    v_mfma_f32_16x16x32_bf16 v[180:183], a[228:231], v[96:99], v[180:183]
    v_exp_f32 v76, v76
    v_mfma_f32_16x16x32_bf16 v[212:215], a[228:231], v[104:107], v[212:215]
    v_exp_f32 v77, v77
    v_mfma_f32_16x16x32_bf16 v[152:155], a[232:235], v[88:91], v[152:155]
    v_exp_f32 v78, v78
    v_mfma_f32_16x16x32_bf16 v[184:187], a[232:235], v[96:99], v[184:187]
    v_exp_f32 v79, v79
    v_mfma_f32_16x16x32_bf16 v[216:219], a[232:235], v[104:107], v[216:219]
    v_exp_f32 v84, v84
    v_mfma_f32_16x16x32_bf16 v[156:159], a[236:239], v[88:91], v[156:159]
    v_exp_f32 v85, v85
    v_mfma_f32_16x16x32_bf16 v[188:191], a[236:239], v[96:99], v[188:191]
    v_exp_f32 v86, v86
    v_mfma_f32_16x16x32_bf16 v[220:223], a[236:239], v[104:107], v[220:223]
    v_exp_f32 v87, v87
    v_mfma_f32_16x16x32_bf16 v[88:91], a[240:243], a[0:3], v[112:115]
L_pad5:
    s_cbranch_execz L_wret
    v_cvt_pk_bf16_f32 v58, v60, v61
    v_cvt_pk_bf16_f32 v59, v62, v63
    v_mfma_f32_16x16x32_bf16 v[88:91], a[244:247], a[4:7], v[88:91]
    v_cvt_pk_bf16_f32 v66, v68, v69
    v_cvt_pk_bf16_f32 v67, v70, v71
    v_mfma_f32_16x16x32_bf16 v[88:91], a[248:251], a[8:11], v[88:91]
    v_cvt_pk_bf16_f32 v74, v76, v77
    v_cvt_pk_bf16_f32 v75, v78, v79
    v_mfma_f32_16x16x32_bf16 v[88:91], a[252:255], a[12:15], v[88:91]
    buffer_load_dwordx4 v11, s[28:31], s54 offen offset:3072 nt lds
    v_mfma_f32_16x16x32_bf16 v[96:99], a[240:243], a[16:19], v[116:119]
    v_cvt_pk_bf16_f32 v82, v84, v85
    v_cvt_pk_bf16_f32 v83, v86, v87
    v_mfma_f32_16x16x32_bf16 v[96:99], a[244:247], a[20:23], v[96:99]
    v_mfma_f32_16x16x32_bf16 v[96:99], a[248:251], a[24:27], v[96:99]
    v_mfma_f32_16x16x32_bf16 v[96:99], a[252:255], a[28:31], v[96:99]
    v_mfma_f32_16x16x32_bf16 v[104:107], a[240:243], a[32:35], v[120:123]
    v_exp_f32 v88, v88
    v_mfma_f32_16x16x32_bf16 v[104:107], a[244:247], a[36:39], v[104:107]
    v_exp_f32 v89, v89
    v_mfma_f32_16x16x32_bf16 v[104:107], a[248:251], a[40:43], v[104:107]
    s_waitcnt vmcnt(8) lgkmcnt(0)
    v_exp_f32 v90, v90
    v_mfma_f32_16x16x32_bf16 v[104:107], a[252:255], a[44:47], v[104:107]
    s_barrier
    ds_read_b64_tr_b16 a[208:209], v30 offset:32768
    v_cvt_pk_bf16_f32 v88, v88, v89
    v_mfma_f32_16x16x32_bf16 v[92:95], a[192:195], a[0:3], v[112:115]
    ds_read_b64_tr_b16 a[210:211], v30 offset:36864
    v_mfma_f32_16x16x32_bf16 v[92:95], a[196:199], a[4:7], v[92:95]
    ds_read_b64_tr_b16 a[212:213], v31 offset:32768
    v_mfma_f32_16x16x32_bf16 v[92:95], a[200:203], a[8:11], v[92:95]
    ds_read_b64_tr_b16 a[214:215], v31 offset:36864
    v_mfma_f32_16x16x32_bf16 v[92:95], a[204:207], a[12:15], v[92:95]
    v_exp_f32 v91, v91
    v_mfma_f32_16x16x32_bf16 v[100:103], a[192:195], a[16:19], v[116:119]
    ds_read_b64_tr_b16 a[216:217], v32 offset:32768
    v_cvt_pk_bf16_f32 v89, v90, v91
    v_mfma_f32_16x16x32_bf16 v[100:103], a[196:199], a[20:23], v[100:103]
    s_add_u32 m0, s15, 0x8000
    v_exp_f32 v96, v96
    v_mfma_f32_16x16x32_bf16 v[100:103], a[200:203], a[24:27], v[100:103]
    s_add_u32 s54, s12, 0x1c000
    ds_read_b64_tr_b16 a[218:219], v32 offset:36864
    v_mfma_f32_16x16x32_bf16 v[100:103], a[204:207], a[28:31], v[100:103]
    buffer_load_dwordx4 v12, s[32:35], s54 offen offset:0 nt lds
    v_mfma_f32_16x16x32_bf16 v[108:111], a[192:195], a[32:35], v[120:123]
    v_exp_f32 v97, v97
    v_mfma_f32_16x16x32_bf16 v[108:111], a[196:199], a[36:39], v[108:111]
    ds_read_b64_tr_b16 a[220:221], v33 offset:32768
    v_cvt_pk_bf16_f32 v96, v96, v97
    v_mfma_f32_16x16x32_bf16 v[108:111], a[200:203], a[40:43], v[108:111]
    ds_read_b64_tr_b16 a[222:223], v33 offset:36864
    v_mfma_f32_16x16x32_bf16 v[108:111], a[204:207], a[44:47], v[108:111]
    s_waitcnt lgkmcnt(4)
    v_exp_f32 v98, v98
    v_mfma_f32_16x16x32_bf16 v[128:131], a[208:211], v[56:59], v[128:131]
    ds_read_b64_tr_b16 a[224:225], v34 offset:32768
    v_mfma_f32_16x16x32_bf16 v[160:163], a[208:211], v[64:67], v[160:163]
    v_exp_f32 v99, v99
    v_mfma_f32_16x16x32_bf16 v[192:195], a[208:211], v[72:75], v[192:195]
    ds_read_b64_tr_b16 a[226:227], v34 offset:36864
    v_cvt_pk_bf16_f32 v97, v98, v99
    v_mfma_f32_16x16x32_bf16 v[224:227], a[208:211], v[80:83], v[224:227]
    v_exp_f32 v104, v104
    v_mfma_f32_16x16x32_bf16 a[64:67], a[80:83], v[56:59], a[64:67]
    ds_read_b64_tr_b16 a[228:229], v35 offset:32768
    v_mfma_f32_16x16x32_bf16 a[68:71], a[80:83], v[64:67], a[68:71]
    v_exp_f32 v105, v105
    v_mfma_f32_16x16x32_bf16 a[72:75], a[80:83], v[72:75], a[72:75]
    ds_read_b64_tr_b16 a[230:231], v35 offset:36864
    v_cvt_pk_bf16_f32 v104, v104, v105
    v_mfma_f32_16x16x32_bf16 a[76:79], a[80:83], v[80:83], a[76:79]
    v_exp_f32 v106, v106
    v_mfma_f32_16x16x32_bf16 v[132:135], a[212:215], v[56:59], v[132:135]
    ds_read_b64_tr_b16 a[232:233], v36 offset:32768
    v_mfma_f32_16x16x32_bf16 v[164:167], a[212:215], v[64:67], v[164:167]
    v_exp_f32 v107, v107
    v_mfma_f32_16x16x32_bf16 v[196:199], a[212:215], v[72:75], v[196:199]
    buffer_load_dwordx4 v13, s[32:35], s54 offen offset:1024 nt lds
    v_mfma_f32_16x16x32_bf16 v[228:231], a[212:215], v[80:83], v[228:231]
    s_waitcnt lgkmcnt(3)
    ds_read_b64_tr_b16 a[234:235], v36 offset:36864
    v_cvt_pk_bf16_f32 v105, v106, v107
    v_mfma_f32_16x16x32_bf16 v[136:139], a[216:219], v[56:59], v[136:139]
    v_exp_f32 v92, v92
    v_mfma_f32_16x16x32_bf16 v[168:171], a[216:219], v[64:67], v[168:171]
    ds_read_b64_tr_b16 a[236:237], v37 offset:32768
    v_mfma_f32_16x16x32_bf16 v[200:203], a[216:219], v[72:75], v[200:203]
    ds_read_b64_tr_b16 a[238:239], v37 offset:36864
    v_mfma_f32_16x16x32_bf16 v[232:235], a[216:219], v[80:83], v[232:235]
    v_exp_f32 v93, v93
    v_mfma_f32_16x16x32_bf16 v[140:143], a[220:223], v[56:59], v[140:143]
    ds_read_b128 a[240:243], v22 offset:16384
    v_cvt_pk_bf16_f32 v90, v92, v93
    v_mfma_f32_16x16x32_bf16 v[172:175], a[220:223], v[64:67], v[172:175]
    v_exp_f32 v94, v94
    v_mfma_f32_16x16x32_bf16 v[204:207], a[220:223], v[72:75], v[204:207]
    ds_read_b128 a[244:247], v23 offset:16384
    v_mfma_f32_16x16x32_bf16 v[236:239], a[220:223], v[80:83], v[236:239]
    v_exp_f32 v95, v95
    v_mfma_f32_16x16x32_bf16 v[144:147], a[224:227], v[56:59], v[144:147]
    ds_read_b128 a[248:251], v24 offset:16384
    v_cvt_pk_bf16_f32 v91, v94, v95
    v_mfma_f32_16x16x32_bf16 v[176:179], a[224:227], v[64:67], v[176:179]
    ds_read_b128 a[252:255], v25 offset:16384
    v_mfma_f32_16x16x32_bf16 v[208:211], a[224:227], v[72:75], v[208:211]
    v_exp_f32 v100, v100
    v_mfma_f32_16x16x32_bf16 v[240:243], a[224:227], v[80:83], v[240:243]
    s_waitcnt lgkmcnt(4)
    ds_read_b128 a[192:195], v22 offset:20480
    v_mfma_f32_16x16x32_bf16 v[148:151], a[228:231], v[56:59], v[148:151]
    buffer_load_dwordx4 v12, s[32:35], s54 offen offset:2048 nt lds
    v_mfma_f32_16x16x32_bf16 v[180:183], a[228:231], v[64:67], v[180:183]
    v_exp_f32 v101, v101
    v_mfma_f32_16x16x32_bf16 v[212:215], a[228:231], v[72:75], v[212:215]
    ds_read_b128 a[196:199], v23 offset:20480
    v_cvt_pk_bf16_f32 v98, v100, v101
    v_mfma_f32_16x16x32_bf16 v[244:247], a[228:231], v[80:83], v[244:247]
    v_exp_f32 v102, v102
    v_mfma_f32_16x16x32_bf16 v[152:155], a[232:235], v[56:59], v[152:155]
    ds_read_b128 a[200:203], v24 offset:20480
    v_mfma_f32_16x16x32_bf16 v[184:187], a[232:235], v[64:67], v[184:187]
    v_exp_f32 v103, v103
    v_mfma_f32_16x16x32_bf16 v[216:219], a[232:235], v[72:75], v[216:219]
    ds_read_b128 a[204:207], v25 offset:20480
    v_cvt_pk_bf16_f32 v99, v102, v103
    v_mfma_f32_16x16x32_bf16 v[248:251], a[232:235], v[80:83], v[248:251]
    v_exp_f32 v108, v108
    v_mfma_f32_16x16x32_bf16 v[156:159], a[236:239], v[56:59], v[156:159]
    ds_read_b64_tr_b16 a[208:209], v38 offset:32768
    v_mfma_f32_16x16x32_bf16 v[188:191], a[236:239], v[64:67], v[188:191]
    v_exp_f32 v109, v109
    v_mfma_f32_16x16x32_bf16 v[220:223], a[236:239], v[72:75], v[220:223]
    ds_read_b64_tr_b16 a[210:211], v38 offset:36864
    v_cvt_pk_bf16_f32 v106, v108, v109
    v_mfma_f32_16x16x32_bf16 v[252:255], a[236:239], v[80:83], v[252:255]
    s_waitcnt lgkmcnt(4)
    v_exp_f32 v110, v110
    v_mfma_f32_16x16x32_bf16 v[56:59], a[240:243], a[0:3], v[112:115]
    ds_read_b64_tr_b16 a[212:213], v39 offset:32768
    v_mfma_f32_16x16x32_bf16 v[56:59], a[244:247], a[4:7], v[56:59]
    v_exp_f32 v111, v111
    v_mfma_f32_16x16x32_bf16 v[56:59], a[248:251], a[8:11], v[56:59]
    ds_read_b64_tr_b16 a[214:215], v39 offset:36864
    v_cvt_pk_bf16_f32 v107, v110, v111
    v_mfma_f32_16x16x32_bf16 v[56:59], a[252:255], a[12:15], v[56:59]
    buffer_load_dwordx4 v13, s[32:35], s54 offen offset:3072 nt lds
    v_mfma_f32_16x16x32_bf16 v[64:67], a[240:243], a[16:19], v[116:119]
    ds_read_b64_tr_b16 a[216:217], v40 offset:32768
    v_mfma_f32_16x16x32_bf16 v[64:67], a[244:247], a[20:23], v[64:67]
    ds_read_b64_tr_b16 a[218:219], v40 offset:36864
    v_mfma_f32_16x16x32_bf16 v[64:67], a[248:251], a[24:27], v[64:67]
    ds_read_b64_tr_b16 a[220:221], v41 offset:32768
    v_mfma_f32_16x16x32_bf16 v[64:67], a[252:255], a[28:31], v[64:67]
    ds_read_b64_tr_b16 a[222:223], v41 offset:36864
    v_mfma_f32_16x16x32_bf16 v[72:75], a[240:243], a[32:35], v[120:123]
    v_exp_f32 v56, v56
    v_mfma_f32_16x16x32_bf16 v[72:75], a[244:247], a[36:39], v[72:75]
    ds_read_b64_tr_b16 a[224:225], v42 offset:32768
    v_mfma_f32_16x16x32_bf16 v[72:75], a[248:251], a[40:43], v[72:75]
    v_exp_f32 v57, v57
    v_mfma_f32_16x16x32_bf16 v[72:75], a[252:255], a[44:47], v[72:75]
    ds_read_b64_tr_b16 a[226:227], v42 offset:36864
    v_cvt_pk_bf16_f32 v56, v56, v57
    v_mfma_f32_16x16x32_bf16 v[80:83], a[240:243], a[48:51], v[124:127]
    v_exp_f32 v58, v58
    v_mfma_f32_16x16x32_bf16 v[80:83], a[244:247], a[52:55], v[80:83]
    ds_read_b64_tr_b16 a[228:229], v43 offset:32768
    v_mfma_f32_16x16x32_bf16 v[80:83], a[248:251], a[56:59], v[80:83]
    v_exp_f32 v59, v59
    v_mfma_f32_16x16x32_bf16 v[80:83], a[252:255], a[60:63], v[80:83]
    ds_read_b64_tr_b16 a[230:231], v43 offset:36864
    v_cvt_pk_bf16_f32 v57, v58, v59
    v_mfma_f32_16x16x32_bf16 v[60:63], a[192:195], a[0:3], v[112:115]
    v_exp_f32 v64, v64
    v_mfma_f32_16x16x32_bf16 v[60:63], a[196:199], a[4:7], v[60:63]
    s_waitcnt lgkmcnt(3)
    ds_read_b64_tr_b16 a[232:233], v44 offset:32768
    v_mfma_f32_16x16x32_bf16 v[60:63], a[200:203], a[8:11], v[60:63]
    v_exp_f32 v65, v65
    v_mfma_f32_16x16x32_bf16 v[60:63], a[204:207], a[12:15], v[60:63]
    ds_read_b64_tr_b16 a[234:235], v44 offset:36864
    v_cvt_pk_bf16_f32 v64, v64, v65
    v_mfma_f32_16x16x32_bf16 v[68:71], a[192:195], a[16:19], v[116:119]
    v_exp_f32 v66, v66
    v_mfma_f32_16x16x32_bf16 v[68:71], a[196:199], a[20:23], v[68:71]
    ds_read_b64_tr_b16 a[236:237], v45 offset:32768
    v_mfma_f32_16x16x32_bf16 v[68:71], a[200:203], a[24:27], v[68:71]
    v_exp_f32 v67, v67
    v_mfma_f32_16x16x32_bf16 v[68:71], a[204:207], a[28:31], v[68:71]
    ds_read_b64_tr_b16 a[238:239], v45 offset:36864
    v_cvt_pk_bf16_f32 v65, v66, v67
    v_mfma_f32_16x16x32_bf16 v[76:79], a[192:195], a[32:35], v[120:123]
    v_exp_f32 v72, v72
    v_mfma_f32_16x16x32_bf16 v[76:79], a[196:199], a[36:39], v[76:79]
    ds_read_b128 a[240:243], v26 offset:16384
    v_mfma_f32_16x16x32_bf16 v[76:79], a[200:203], a[40:43], v[76:79]
    v_exp_f32 v73, v73
    v_mfma_f32_16x16x32_bf16 v[76:79], a[204:207], a[44:47], v[76:79]
    ds_read_b128 a[244:247], v27 offset:16384
    v_cvt_pk_bf16_f32 v72, v72, v73
    v_mfma_f32_16x16x32_bf16 v[84:87], a[192:195], a[48:51], v[124:127]
    v_exp_f32 v74, v74
    v_mfma_f32_16x16x32_bf16 v[84:87], a[196:199], a[52:55], v[84:87]
    ds_read_b128 a[248:251], v28 offset:16384
    v_mfma_f32_16x16x32_bf16 v[84:87], a[200:203], a[56:59], v[84:87]
    v_exp_f32 v75, v75
    v_mfma_f32_16x16x32_bf16 v[84:87], a[204:207], a[60:63], v[84:87]
    s_xor_b32 s54, s9, 0x0
    ds_read_b128 a[252:255], v29 offset:16384
    v_cvt_pk_bf16_f32 v73, v74, v75
    v_mfma_f32_16x16x32_bf16 v[128:131], a[208:211], v[88:91], v[128:131]
    buffer_load_dword a85, v3, s[36:39], s54 offen
    v_mfma_f32_16x16x32_bf16 v[160:163], a[208:211], v[96:99], v[160:163]
    v_exp_f32 v80, v80
    v_mfma_f32_16x16x32_bf16 v[192:195], a[208:211], v[104:107], v[192:195]
    ds_read_b128 a[192:195], v26 offset:20480
    v_mfma_f32_16x16x32_bf16 a[64:67], a[80:83], v[88:91], a[64:67]
    v_exp_f32 v81, v81
    v_mfma_f32_16x16x32_bf16 a[68:71], a[80:83], v[96:99], a[68:71]
    ds_read_b128 a[196:199], v27 offset:20480
    v_cvt_pk_bf16_f32 v80, v80, v81
    v_mfma_f32_16x16x32_bf16 a[72:75], a[80:83], v[104:107], a[72:75]
    v_exp_f32 v82, v82
    v_mfma_f32_16x16x32_bf16 v[132:135], a[212:215], v[88:91], v[132:135]
    ds_read_b128 a[200:203], v28 offset:20480
    v_mfma_f32_16x16x32_bf16 v[164:167], a[212:215], v[96:99], v[164:167]
    v_exp_f32 v83, v83
    v_mfma_f32_16x16x32_bf16 v[196:199], a[212:215], v[104:107], v[196:199]
    ds_read_b128 a[204:207], v29 offset:20480
    v_cvt_pk_bf16_f32 v81, v82, v83
    v_mfma_f32_16x16x32_bf16 v[136:139], a[216:219], v[88:91], v[136:139]
    v_exp_f32 v60, v60
    v_mfma_f32_16x16x32_bf16 v[168:171], a[216:219], v[96:99], v[168:171]
    v_exp_f32 v61, v61
    v_mfma_f32_16x16x32_bf16 v[200:203], a[216:219], v[104:107], v[200:203]
    v_exp_f32 v62, v62
    v_mfma_f32_16x16x32_bf16 v[140:143], a[220:223], v[88:91], v[140:143]
    v_exp_f32 v63, v63
    v_mfma_f32_16x16x32_bf16 v[172:175], a[220:223], v[96:99], v[172:175]
    v_exp_f32 v68, v68
    v_mfma_f32_16x16x32_bf16 v[204:207], a[220:223], v[104:107], v[204:207]
    s_waitcnt lgkmcnt(1)
    v_exp_f32 v69, v69
    v_mfma_f32_16x16x32_bf16 v[144:147], a[224:227], v[88:91], v[144:147]
    v_exp_f32 v70, v70
    v_mfma_f32_16x16x32_bf16 v[176:179], a[224:227], v[96:99], v[176:179]
    v_exp_f32 v71, v71
    v_mfma_f32_16x16x32_bf16 v[208:211], a[224:227], v[104:107], v[208:211]
    v_exp_f32 v76, v76
    v_mfma_f32_16x16x32_bf16 v[148:151], a[228:231], v[88:91], v[148:151]
    v_exp_f32 v77, v77
    v_mfma_f32_16x16x32_bf16 v[180:183], a[228:231], v[96:99], v[180:183]
    v_exp_f32 v78, v78
    v_mfma_f32_16x16x32_bf16 v[212:215], a[228:231], v[104:107], v[212:215]
    v_exp_f32 v79, v79
    v_mfma_f32_16x16x32_bf16 v[152:155], a[232:235], v[88:91], v[152:155]
    v_exp_f32 v84, v84
    v_mfma_f32_16x16x32_bf16 v[184:187], a[232:235], v[96:99], v[184:187]
    v_exp_f32 v85, v85
    v_mfma_f32_16x16x32_bf16 v[216:219], a[232:235], v[104:107], v[216:219]
    v_exp_f32 v86, v86
    v_mfma_f32_16x16x32_bf16 v[156:159], a[236:239], v[88:91], v[156:159]
    v_exp_f32 v87, v87
    v_mfma_f32_16x16x32_bf16 v[188:191], a[236:239], v[96:99], v[188:191]
    v_cvt_pk_bf16_f32 v58, v60, v61
    v_cvt_pk_bf16_f32 v59, v62, v63
    v_mfma_f32_16x16x32_bf16 v[220:223], a[236:239], v[104:107], v[220:223]
    v_cvt_pk_bf16_f32 v66, v68, v69
    v_cvt_pk_bf16_f32 v67, v70, v71
    v_mfma_f32_16x16x32_bf16 v[88:91], a[240:243], a[0:3], v[112:115]
    v_cvt_pk_bf16_f32 v74, v76, v77
    v_cvt_pk_bf16_f32 v75, v78, v79
    v_mfma_f32_16x16x32_bf16 v[88:91], a[244:247], a[4:7], v[88:91]
    v_cvt_pk_bf16_f32 v82, v84, v85
    v_cvt_pk_bf16_f32 v83, v86, v87
    v_mfma_f32_16x16x32_bf16 v[88:91], a[248:251], a[8:11], v[88:91]
    s_xor_b32 s54, s9, 0x20000
    v_mfma_f32_16x16x32_bf16 v[88:91], a[252:255], a[12:15], v[88:91]
    buffer_load_dword a86, v3, s[36:39], s54 offen
    v_mfma_f32_16x16x32_bf16 v[96:99], a[240:243], a[16:19], v[116:119]
    v_mfma_f32_16x16x32_bf16 v[96:99], a[244:247], a[20:23], v[96:99]
    v_mfma_f32_16x16x32_bf16 v[96:99], a[248:251], a[24:27], v[96:99]
    v_mfma_f32_16x16x32_bf16 v[96:99], a[252:255], a[28:31], v[96:99]
    v_mfma_f32_16x16x32_bf16 v[104:107], a[240:243], a[32:35], v[120:123]
    s_nop 1
    v_exp_f32 v88, v88
    v_mfma_f32_16x16x32_bf16 v[104:107], a[244:247], a[36:39], v[104:107]
    s_lshl_b32 s58, s4, 5
    v_exp_f32 v89, v89
    v_mfma_f32_16x16x32_bf16 v[104:107], a[248:251], a[40:43], v[104:107]
    s_waitcnt vmcnt(6) lgkmcnt(0)
    v_exp_f32 v90, v90
    v_mfma_f32_16x16x32_bf16 v[104:107], a[252:255], a[44:47], v[104:107]
    s_barrier
    ds_read_b64_tr_b16 a[208:209], v30 offset:16384
    v_cvt_pk_bf16_f32 v88, v88, v89
    v_mfma_f32_16x16x32_bf16 v[92:95], a[192:195], a[0:3], v[112:115]
    buffer_load_dword v54, v55, s[48:51], s58 offen sc1
    v_mfma_f32_16x16x32_bf16 v[92:95], a[196:199], a[4:7], v[92:95]
    ds_read_b64_tr_b16 a[210:211], v30 offset:20480
    v_mfma_f32_16x16x32_bf16 v[92:95], a[200:203], a[8:11], v[92:95]
    ds_read_b64_tr_b16 a[212:213], v31 offset:16384
    v_mfma_f32_16x16x32_bf16 v[92:95], a[204:207], a[12:15], v[92:95]
    ds_read_b64_tr_b16 a[214:215], v31 offset:20480
    v_mfma_f32_16x16x32_bf16 v[100:103], a[192:195], a[16:19], v[116:119]
    v_exp_f32 v91, v91
    v_mfma_f32_16x16x32_bf16 v[100:103], a[196:199], a[20:23], v[100:103]
    ds_read_b64_tr_b16 a[216:217], v32 offset:16384
    v_cvt_pk_bf16_f32 v89, v90, v91
    v_mfma_f32_16x16x32_bf16 v[100:103], a[200:203], a[24:27], v[100:103]
    ds_read_b64_tr_b16 a[218:219], v32 offset:20480
    v_mfma_f32_16x16x32_bf16 v[100:103], a[204:207], a[28:31], v[100:103]
    v_exp_f32 v96, v96
    v_mfma_f32_16x16x32_bf16 v[108:111], a[192:195], a[32:35], v[120:123]
    s_xor_b32 s54, s9, 0x40000
    ds_read_b64_tr_b16 a[220:221], v33 offset:16384
    v_mfma_f32_16x16x32_bf16 v[108:111], a[196:199], a[36:39], v[108:111]
    buffer_load_dword a87, v3, s[36:39], s54 offen
    v_mfma_f32_16x16x32_bf16 v[108:111], a[200:203], a[40:43], v[108:111]
    s_waitcnt lgkmcnt(4)
    ds_read_b64_tr_b16 a[222:223], v33 offset:20480
    v_mfma_f32_16x16x32_bf16 v[108:111], a[204:207], a[44:47], v[108:111]
    s_add_u32 m0, s15, 0x0
    v_exp_f32 v97, v97
    v_mfma_f32_16x16x32_bf16 v[128:131], a[208:211], v[56:59], v[128:131]
    s_xor_b32 s54, s13, 0x0
    ds_read_b64_tr_b16 a[224:225], v34 offset:16384
    v_cvt_pk_bf16_f32 v96, v96, v97
    v_mfma_f32_16x16x32_bf16 v[160:163], a[208:211], v[64:67], v[160:163]
    buffer_load_dwordx4 v14, s[36:39], s54 offen offset:0 lds
    v_mfma_f32_16x16x32_bf16 v[192:195], a[208:211], v[72:75], v[192:195]
    ds_read_b64_tr_b16 a[226:227], v34 offset:20480
    v_mfma_f32_16x16x32_bf16 v[224:227], a[208:211], v[80:83], v[224:227]
    v_exp_f32 v98, v98
    v_mfma_f32_16x16x32_bf16 a[64:67], a[80:83], v[56:59], a[64:67]
    ds_read_b64_tr_b16 a[228:229], v35 offset:16384
    v_mfma_f32_16x16x32_bf16 a[68:71], a[80:83], v[64:67], a[68:71]
    v_exp_f32 v99, v99
    v_mfma_f32_16x16x32_bf16 a[72:75], a[80:83], v[72:75], a[72:75]
    buffer_load_dwordx4 v15, s[36:39], s54 offen offset:1024 lds
    v_mfma_f32_16x16x32_bf16 a[76:79], a[80:83], v[80:83], a[76:79]
    s_waitcnt lgkmcnt(3)
    ds_read_b64_tr_b16 a[230:231], v35 offset:20480
    v_cvt_pk_bf16_f32 v97, v98, v99
    v_mfma_f32_16x16x32_bf16 v[132:135], a[212:215], v[56:59], v[132:135]
    v_exp_f32 v104, v104
    v_mfma_f32_16x16x32_bf16 v[164:167], a[212:215], v[64:67], v[164:167]
    ds_read_b64_tr_b16 a[232:233], v36 offset:16384
    v_mfma_f32_16x16x32_bf16 v[196:199], a[212:215], v[72:75], v[196:199]
    buffer_load_dwordx4 v16, s[36:39], s54 offen offset:2048 lds
    v_mfma_f32_16x16x32_bf16 v[228:231], a[212:215], v[80:83], v[228:231]
    ds_read_b64_tr_b16 a[234:235], v36 offset:20480
    v_mfma_f32_16x16x32_bf16 v[136:139], a[216:219], v[56:59], v[136:139]
    v_exp_f32 v105, v105
    v_mfma_f32_16x16x32_bf16 v[168:171], a[216:219], v[64:67], v[168:171]
    ds_read_b64_tr_b16 a[236:237], v37 offset:16384
    v_cvt_pk_bf16_f32 v104, v104, v105
    v_mfma_f32_16x16x32_bf16 v[200:203], a[216:219], v[72:75], v[200:203]
    buffer_load_dwordx4 v17, s[36:39], s54 offen offset:3072 lds
    v_mfma_f32_16x16x32_bf16 v[232:235], a[216:219], v[80:83], v[232:235]
    ds_read_b64_tr_b16 a[238:239], v37 offset:20480
    v_mfma_f32_16x16x32_bf16 v[140:143], a[220:223], v[56:59], v[140:143]
    s_add_u32 m0, s15, 0x4000
    v_exp_f32 v106, v106
    v_mfma_f32_16x16x32_bf16 v[172:175], a[220:223], v[64:67], v[172:175]
    s_xor_b32 s54, s13, 0x10000
    ds_read_b128 a[240:243], v22 offset:0
    v_mfma_f32_16x16x32_bf16 v[204:207], a[220:223], v[72:75], v[204:207]
    buffer_load_dwordx4 v14, s[36:39], s54 offen offset:0 lds
    v_mfma_f32_16x16x32_bf16 v[236:239], a[220:223], v[80:83], v[236:239]
    s_waitcnt lgkmcnt(3)
    ds_read_b128 a[244:247], v23 offset:0
    v_mfma_f32_16x16x32_bf16 v[144:147], a[224:227], v[56:59], v[144:147]
    ds_read_b128 a[248:251], v24 offset:0
    v_mfma_f32_16x16x32_bf16 v[176:179], a[224:227], v[64:67], v[176:179]
    ds_read_b128 a[252:255], v25 offset:0
    v_mfma_f32_16x16x32_bf16 v[208:211], a[224:227], v[72:75], v[208:211]
    buffer_load_dwordx4 v15, s[36:39], s54 offen offset:1024 lds
    v_mfma_f32_16x16x32_bf16 v[240:243], a[224:227], v[80:83], v[240:243]
    v_exp_f32 v107, v107
    v_mfma_f32_16x16x32_bf16 v[148:151], a[228:231], v[56:59], v[148:151]
    ds_read_b128 a[192:195], v22 offset:4096
    v_cvt_pk_bf16_f32 v105, v106, v107
    v_mfma_f32_16x16x32_bf16 v[180:183], a[228:231], v[64:67], v[180:183]
    v_exp_f32 v92, v92
    v_mfma_f32_16x16x32_bf16 v[212:215], a[228:231], v[72:75], v[212:215]
    buffer_load_dwordx4 v16, s[36:39], s54 offen offset:2048 lds
    v_mfma_f32_16x16x32_bf16 v[244:247], a[228:231], v[80:83], v[244:247]
    v_exp_f32 v93, v93
    v_mfma_f32_16x16x32_bf16 v[152:155], a[232:235], v[56:59], v[152:155]
    ds_read_b128 a[196:199], v23 offset:4096
    v_cvt_pk_bf16_f32 v90, v92, v93
    v_mfma_f32_16x16x32_bf16 v[184:187], a[232:235], v[64:67], v[184:187]
    v_exp_f32 v94, v94
    v_mfma_f32_16x16x32_bf16 v[216:219], a[232:235], v[72:75], v[216:219]
    s_waitcnt lgkmcnt(2)
    ds_read_b128 a[200:203], v24 offset:4096
    v_mfma_f32_16x16x32_bf16 v[248:251], a[232:235], v[80:83], v[248:251]
    buffer_load_dwordx4 v17, s[36:39], s54 offen offset:3072 lds
    v_mfma_f32_16x16x32_bf16 v[156:159], a[236:239], v[56:59], v[156:159]
    v_exp_f32 v95, v95
    v_mfma_f32_16x16x32_bf16 v[188:191], a[236:239], v[64:67], v[188:191]
    ds_read_b128 a[204:207], v25 offset:4096
    v_cvt_pk_bf16_f32 v91, v94, v95
    v_mfma_f32_16x16x32_bf16 v[220:223], a[236:239], v[72:75], v[220:223]
    v_exp_f32 v100, v100
    v_mfma_f32_16x16x32_bf16 v[252:255], a[236:239], v[80:83], v[252:255]
    ds_read_b64_tr_b16 a[208:209], v38 offset:16384
    v_mfma_f32_16x16x32_bf16 v[56:59], a[240:243], a[0:3], v[112:115]
    v_exp_f32 v101, v101
    v_mfma_f32_16x16x32_bf16 v[56:59], a[244:247], a[4:7], v[56:59]
    ds_read_b64_tr_b16 a[210:211], v38 offset:20480
    v_cvt_pk_bf16_f32 v98, v100, v101
    v_mfma_f32_16x16x32_bf16 v[56:59], a[248:251], a[8:11], v[56:59]
    v_exp_f32 v102, v102
    v_mfma_f32_16x16x32_bf16 v[56:59], a[252:255], a[12:15], v[56:59]
    ds_read_b64_tr_b16 a[212:213], v39 offset:16384
    v_mfma_f32_16x16x32_bf16 v[64:67], a[240:243], a[16:19], v[116:119]
    v_exp_f32 v103, v103
    v_mfma_f32_16x16x32_bf16 v[64:67], a[244:247], a[20:23], v[64:67]
    ds_read_b64_tr_b16 a[214:215], v39 offset:20480
    v_cvt_pk_bf16_f32 v99, v102, v103
    v_mfma_f32_16x16x32_bf16 v[64:67], a[248:251], a[24:27], v[64:67]
    v_exp_f32 v108, v108
    v_mfma_f32_16x16x32_bf16 v[64:67], a[252:255], a[28:31], v[64:67]
    ds_read_b64_tr_b16 a[216:217], v40 offset:16384
    v_mfma_f32_16x16x32_bf16 v[72:75], a[240:243], a[32:35], v[120:123]
    v_exp_f32 v109, v109
    v_mfma_f32_16x16x32_bf16 v[72:75], a[244:247], a[36:39], v[72:75]
    ds_read_b64_tr_b16 a[218:219], v40 offset:20480
    v_cvt_pk_bf16_f32 v106, v108, v109
    v_mfma_f32_16x16x32_bf16 v[72:75], a[248:251], a[40:43], v[72:75]
    s_xor_b32 s54, s9, 0x60000
    v_exp_f32 v110, v110
    v_mfma_f32_16x16x32_bf16 v[72:75], a[252:255], a[44:47], v[72:75]
    buffer_load_dword a88, v3, s[36:39], s54 offen
    v_mfma_f32_16x16x32_bf16 v[80:83], a[240:243], a[48:51], v[124:127]
    v_exp_f32 v111, v111
    v_mfma_f32_16x16x32_bf16 v[80:83], a[244:247], a[52:55], v[80:83]
    s_waitcnt lgkmcnt(2)
    ds_read_b64_tr_b16 a[220:221], v41 offset:16384
    v_cvt_pk_bf16_f32 v107, v110, v111
    v_mfma_f32_16x16x32_bf16 v[80:83], a[248:251], a[56:59], v[80:83]
    s_add_u32 m0, s15, 0x24000
    v_exp_f32 v56, v56
    v_mfma_f32_16x16x32_bf16 v[80:83], a[252:255], a[60:63], v[80:83]
    s_xor_b32 s54, s13, 0x20000
    ds_read_b64_tr_b16 a[222:223], v41 offset:20480
    v_mfma_f32_16x16x32_bf16 v[60:63], a[192:195], a[0:3], v[112:115]
    buffer_load_dwordx4 v14, s[36:39], s54 offen offset:0 lds
    v_mfma_f32_16x16x32_bf16 v[60:63], a[196:199], a[4:7], v[60:63]
    v_exp_f32 v57, v57
    v_mfma_f32_16x16x32_bf16 v[60:63], a[200:203], a[8:11], v[60:63]
    ds_read_b64_tr_b16 a[224:225], v42 offset:16384
    v_cvt_pk_bf16_f32 v56, v56, v57
    v_mfma_f32_16x16x32_bf16 v[60:63], a[204:207], a[12:15], v[60:63]
    v_exp_f32 v58, v58
    v_mfma_f32_16x16x32_bf16 v[68:71], a[192:195], a[16:19], v[116:119]
    buffer_load_dwordx4 v15, s[36:39], s54 offen offset:1024 lds
    v_mfma_f32_16x16x32_bf16 v[68:71], a[196:199], a[20:23], v[68:71]
    v_exp_f32 v59, v59
    v_mfma_f32_16x16x32_bf16 v[68:71], a[200:203], a[24:27], v[68:71]
    ds_read_b64_tr_b16 a[226:227], v42 offset:20480
    v_cvt_pk_bf16_f32 v57, v58, v59
    v_mfma_f32_16x16x32_bf16 v[68:71], a[204:207], a[28:31], v[68:71]
    v_exp_f32 v64, v64
    v_mfma_f32_16x16x32_bf16 v[76:79], a[192:195], a[32:35], v[120:123]
    buffer_load_dwordx4 v16, s[36:39], s54 offen offset:2048 lds
    v_mfma_f32_16x16x32_bf16 v[76:79], a[196:199], a[36:39], v[76:79]
    v_exp_f32 v65, v65
    v_mfma_f32_16x16x32_bf16 v[76:79], a[200:203], a[40:43], v[76:79]
    ds_read_b64_tr_b16 a[228:229], v43 offset:16384
    v_cvt_pk_bf16_f32 v64, v64, v65
    v_mfma_f32_16x16x32_bf16 v[76:79], a[204:207], a[44:47], v[76:79]
    v_exp_f32 v66, v66
    v_mfma_f32_16x16x32_bf16 v[84:87], a[192:195], a[48:51], v[124:127]
    buffer_load_dwordx4 v17, s[36:39], s54 offen offset:3072 lds
    v_mfma_f32_16x16x32_bf16 v[84:87], a[196:199], a[52:55], v[84:87]
    v_exp_f32 v67, v67
    v_mfma_f32_16x16x32_bf16 v[84:87], a[200:203], a[56:59], v[84:87]
    s_add_u32 m0, s15, 0x1c000
    ds_read_b64_tr_b16 a[230:231], v43 offset:20480
    v_cvt_pk_bf16_f32 v65, v66, v67
    v_mfma_f32_16x16x32_bf16 v[84:87], a[204:207], a[60:63], v[84:87]
    s_xor_b32 s54, s13, 0x30000
    v_exp_f32 v72, v72
    v_mfma_f32_16x16x32_bf16 v[128:131], a[208:211], v[88:91], v[128:131]
    buffer_load_dwordx4 v14, s[36:39], s54 offen offset:0 lds
    v_mfma_f32_16x16x32_bf16 v[160:163], a[208:211], v[96:99], v[160:163]
    v_exp_f32 v73, v73
    v_mfma_f32_16x16x32_bf16 v[192:195], a[208:211], v[104:107], v[192:195]
    ds_read_b64_tr_b16 a[232:233], v44 offset:16384
    v_cvt_pk_bf16_f32 v72, v72, v73
    v_mfma_f32_16x16x32_bf16 a[64:67], a[80:83], v[88:91], a[64:67]
    ds_read_b64_tr_b16 a[234:235], v44 offset:20480
    v_mfma_f32_16x16x32_bf16 a[68:71], a[80:83], v[96:99], a[68:71]
    buffer_load_dwordx4 v15, s[36:39], s54 offen offset:1024 lds
    v_mfma_f32_16x16x32_bf16 a[72:75], a[80:83], v[104:107], a[72:75]
    ds_read_b64_tr_b16 a[236:237], v45 offset:16384
    v_mfma_f32_16x16x32_bf16 v[132:135], a[212:215], v[88:91], v[132:135]
    ds_read_b64_tr_b16 a[238:239], v45 offset:20480
    v_mfma_f32_16x16x32_bf16 v[164:167], a[212:215], v[96:99], v[164:167]
    v_exp_f32 v74, v74
    v_mfma_f32_16x16x32_bf16 v[196:199], a[212:215], v[104:107], v[196:199]
    s_waitcnt lgkmcnt(4)
    ds_read_b128 a[240:243], v26 offset:0
    v_mfma_f32_16x16x32_bf16 v[136:139], a[216:219], v[88:91], v[136:139]
    buffer_load_dwordx4 v16, s[36:39], s54 offen offset:2048 lds
    v_mfma_f32_16x16x32_bf16 v[168:171], a[216:219], v[96:99], v[168:171]
    ds_read_b128 a[244:247], v27 offset:0
    v_mfma_f32_16x16x32_bf16 v[200:203], a[216:219], v[104:107], v[200:203]
    ds_read_b128 a[248:251], v28 offset:0
    v_mfma_f32_16x16x32_bf16 v[140:143], a[220:223], v[88:91], v[140:143]
    ds_read_b128 a[252:255], v29 offset:0
    v_mfma_f32_16x16x32_bf16 v[172:175], a[220:223], v[96:99], v[172:175]
    buffer_load_dwordx4 v17, s[36:39], s54 offen offset:3072 lds
    v_mfma_f32_16x16x32_bf16 v[204:207], a[220:223], v[104:107], v[204:207]
    v_exp_f32 v75, v75
    v_mfma_f32_16x16x32_bf16 v[144:147], a[224:227], v[88:91], v[144:147]
    s_add_u32 m0, s15, 0x20000
    ds_read_b128 a[192:195], v26 offset:4096
    v_cvt_pk_bf16_f32 v73, v74, v75
    v_mfma_f32_16x16x32_bf16 v[176:179], a[224:227], v[96:99], v[176:179]
    s_xor_b32 s54, s13, 0x40000
    v_exp_f32 v80, v80
    v_mfma_f32_16x16x32_bf16 v[208:211], a[224:227], v[104:107], v[208:211]
    buffer_load_dwordx4 v14, s[36:39], s54 offen offset:0 lds
    v_mfma_f32_16x16x32_bf16 v[148:151], a[228:231], v[88:91], v[148:151]
    v_exp_f32 v81, v81
    v_mfma_f32_16x16x32_bf16 v[180:183], a[228:231], v[96:99], v[180:183]
    ds_read_b128 a[196:199], v27 offset:4096
    v_cvt_pk_bf16_f32 v80, v80, v81
    v_mfma_f32_16x16x32_bf16 v[212:215], a[228:231], v[104:107], v[212:215]
    s_waitcnt lgkmcnt(2)
    v_exp_f32 v82, v82
    v_mfma_f32_16x16x32_bf16 v[152:155], a[232:235], v[88:91], v[152:155]
    buffer_load_dwordx4 v15, s[36:39], s54 offen offset:1024 lds
    v_mfma_f32_16x16x32_bf16 v[184:187], a[232:235], v[96:99], v[184:187]
    v_exp_f32 v83, v83
    v_mfma_f32_16x16x32_bf16 v[216:219], a[232:235], v[104:107], v[216:219]
    ds_read_b128 a[200:203], v28 offset:4096
    v_cvt_pk_bf16_f32 v81, v82, v83
    v_mfma_f32_16x16x32_bf16 v[156:159], a[236:239], v[88:91], v[156:159]
    ds_read_b128 a[204:207], v29 offset:4096
    v_mfma_f32_16x16x32_bf16 v[188:191], a[236:239], v[96:99], v[188:191]
    buffer_load_dwordx4 v16, s[36:39], s54 offen offset:2048 lds
    v_mfma_f32_16x16x32_bf16 v[220:223], a[236:239], v[104:107], v[220:223]
    v_exp_f32 v60, v60
    v_mfma_f32_16x16x32_bf16 v[88:91], a[240:243], a[0:3], v[112:115]
    v_exp_f32 v61, v61
    v_mfma_f32_16x16x32_bf16 v[88:91], a[244:247], a[4:7], v[88:91]
    v_exp_f32 v62, v62
    v_mfma_f32_16x16x32_bf16 v[88:91], a[248:251], a[8:11], v[88:91]
    v_exp_f32 v63, v63
    v_mfma_f32_16x16x32_bf16 v[88:91], a[252:255], a[12:15], v[88:91]
    buffer_load_dwordx4 v17, s[36:39], s54 offen offset:3072 lds
    v_mfma_f32_16x16x32_bf16 v[96:99], a[240:243], a[16:19], v[116:119]
    v_exp_f32 v68, v68
    v_mfma_f32_16x16x32_bf16 v[96:99], a[244:247], a[20:23], v[96:99]
    v_exp_f32 v69, v69
    v_mfma_f32_16x16x32_bf16 v[96:99], a[248:251], a[24:27], v[96:99]
    v_exp_f32 v70, v70
    v_mfma_f32_16x16x32_bf16 v[96:99], a[252:255], a[28:31], v[96:99]
    v_exp_f32 v71, v71
    v_mfma_f32_16x16x32_bf16 v[104:107], a[240:243], a[32:35], v[120:123]
    v_exp_f32 v76, v76
    v_exp_f32 v88, v88
    v_mfma_f32_16x16x32_bf16 v[104:107], a[244:247], a[36:39], v[104:107]
    s_add_u32 m0, s15, 0x10000
    v_exp_f32 v77, v77
    v_exp_f32 v89, v89
    v_mfma_f32_16x16x32_bf16 v[104:107], a[248:251], a[40:43], v[104:107]
    s_waitcnt vmcnt(25) lgkmcnt(0)
    v_exp_f32 v78, v78
    v_exp_f32 v90, v90
    v_mfma_f32_16x16x32_bf16 v[104:107], a[252:255], a[44:47], v[104:107]
L_pad6:
    s_cbranch_execz L_wret
    s_barrier
    ds_read_b64_tr_b16 a[208:209], v30 offset:0
    v_cvt_pk_bf16_f32 v58, v60, v61
    v_cvt_pk_bf16_f32 v88, v88, v89
    v_mfma_f32_16x16x32_bf16 v[92:95], a[192:195], a[0:3], v[112:115]
    s_xor_b32 s54, s13, 0x50000
    ds_read_b64_tr_b16 a[210:211], v30 offset:4096
    v_cvt_pk_bf16_f32 v59, v62, v63
    v_exp_f32 v91, v91
    v_mfma_f32_16x16x32_bf16 v[92:95], a[196:199], a[4:7], v[92:95]
    buffer_load_dwordx4 v14, s[36:39], s54 offen offset:0 lds
    v_exp_f32 v96, v96
    v_mfma_f32_16x16x32_bf16 v[92:95], a[200:203], a[8:11], v[92:95]
    buffer_load_dwordx4 v15, s[36:39], s54 offen offset:1024 lds
    v_exp_f32 v97, v97
    v_mfma_f32_16x16x32_bf16 v[92:95], a[204:207], a[12:15], v[92:95]
    v_exp_f32 v79, v79
    v_exp_f32 v98, v98
    v_mfma_f32_16x16x32_bf16 v[100:103], a[192:195], a[16:19], v[116:119]
    ds_read_b64_tr_b16 a[212:213], v31 offset:0
    v_cvt_pk_bf16_f32 v66, v68, v69
    v_cvt_pk_bf16_f32 v96, v96, v97
    v_mfma_f32_16x16x32_bf16 v[100:103], a[196:199], a[20:23], v[100:103]
    v_exp_f32 v84, v84
    v_exp_f32 v99, v99
    v_mfma_f32_16x16x32_bf16 v[100:103], a[200:203], a[24:27], v[100:103]
    ds_read_b64_tr_b16 a[214:215], v31 offset:4096
    v_cvt_pk_bf16_f32 v67, v70, v71
    v_cvt_pk_bf16_f32 v89, v90, v91
    v_mfma_f32_16x16x32_bf16 v[100:103], a[204:207], a[28:31], v[100:103]
    v_exp_f32 v85, v85
    v_exp_f32 v104, v104
    v_mfma_f32_16x16x32_bf16 v[108:111], a[192:195], a[32:35], v[120:123]
    buffer_load_dwordx4 v16, s[36:39], s54 offen offset:2048 lds
    v_exp_f32 v105, v105
    v_mfma_f32_16x16x32_bf16 v[108:111], a[196:199], a[36:39], v[108:111]
    v_exp_f32 v86, v86
    v_exp_f32 v106, v106
    v_mfma_f32_16x16x32_bf16 v[108:111], a[200:203], a[40:43], v[108:111]
    v_exp_f32 v87, v87
    v_cvt_pk_bf16_f32 v104, v104, v105
    v_mfma_f32_16x16x32_bf16 v[108:111], a[204:207], a[44:47], v[108:111]
    s_waitcnt lgkmcnt(2)
    ds_read_b64_tr_b16 a[216:217], v32 offset:0
    v_cvt_pk_bf16_f32 v74, v76, v77
    v_exp_f32 v107, v107
    v_mfma_f32_16x16x32_bf16 v[128:131], a[208:211], v[56:59], v[128:131]
    ds_read_b64_tr_b16 a[218:219], v32 offset:4096
    v_cvt_pk_bf16_f32 v75, v78, v79
    v_cvt_pk_bf16_f32 v97, v98, v99
    v_mfma_f32_16x16x32_bf16 v[160:163], a[208:211], v[64:67], v[160:163]
    buffer_load_dwordx4 v17, s[36:39], s54 offen offset:3072 lds
    v_cvt_pk_bf16_f32 v82, v84, v85
    v_cvt_pk_bf16_f32 v83, v86, v87
    v_mfma_f32_16x16x32_bf16 v[192:195], a[208:211], v[72:75], v[192:195]
    s_add_u32 m0, s15, 0x14000
    ds_read_b64_tr_b16 a[220:221], v33 offset:0
    v_exp_f32 v92, v92
    v_mfma_f32_16x16x32_bf16 v[224:227], a[208:211], v[80:83], v[224:227]
    s_xor_b32 s54, s13, 0x60000
    ds_read_b64_tr_b16 a[222:223], v33 offset:4096
    v_exp_f32 v93, v93
    v_mfma_f32_16x16x32_bf16 a[64:67], a[80:83], v[56:59], a[64:67]
    buffer_load_dwordx4 v14, s[36:39], s54 offen offset:0 lds
    v_mfma_f32_16x16x32_bf16 a[68:71], a[80:83], v[64:67], a[68:71]
    ds_read_b64_tr_b16 a[224:225], v38 offset:0
    v_exp_f32 v94, v94
    v_mfma_f32_16x16x32_bf16 a[72:75], a[80:83], v[72:75], a[72:75]
    s_waitcnt lgkmcnt(5)
    ds_read_b64_tr_b16 a[226:227], v38 offset:4096
    v_cvt_pk_bf16_f32 v90, v92, v93
    v_exp_f32 v95, v95
    v_mfma_f32_16x16x32_bf16 a[76:79], a[80:83], v[80:83], a[76:79]
    buffer_load_dwordx4 v15, s[36:39], s54 offen offset:1024 lds
    v_cvt_pk_bf16_f32 v105, v106, v107
    v_mfma_f32_16x16x32_bf16 v[132:135], a[212:215], v[56:59], v[132:135]
    ds_read_b64_tr_b16 a[228:229], v39 offset:0
    v_exp_f32 v100, v100
    v_mfma_f32_16x16x32_bf16 v[164:167], a[212:215], v[64:67], v[164:167]
    ds_read_b64_tr_b16 a[230:231], v39 offset:4096
    v_exp_f32 v101, v101
    v_mfma_f32_16x16x32_bf16 v[196:199], a[212:215], v[72:75], v[196:199]
    buffer_load_dwordx4 v16, s[36:39], s54 offen offset:2048 lds
    v_mfma_f32_16x16x32_bf16 v[228:231], a[212:215], v[80:83], v[228:231]
    s_waitcnt lgkmcnt(4)
    ds_read_b64_tr_b16 a[232:233], v40 offset:0
    v_exp_f32 v102, v102
    v_mfma_f32_16x16x32_bf16 v[136:139], a[216:219], v[56:59], v[136:139]
    ds_read_b64_tr_b16 a[234:235], v40 offset:4096
    v_cvt_pk_bf16_f32 v98, v100, v101
    v_exp_f32 v103, v103
    v_mfma_f32_16x16x32_bf16 v[168:171], a[216:219], v[64:67], v[168:171]
    ds_read_b64_tr_b16 a[236:237], v41 offset:0
    v_cvt_pk_bf16_f32 v91, v94, v95
    v_mfma_f32_16x16x32_bf16 v[200:203], a[216:219], v[72:75], v[200:203]
    buffer_load_dwordx4 v17, s[36:39], s54 offen offset:3072 lds
    v_exp_f32 v108, v108
    v_mfma_f32_16x16x32_bf16 v[232:235], a[216:219], v[80:83], v[232:235]
    ds_read_b64_tr_b16 a[238:239], v41 offset:4096
    v_exp_f32 v109, v109
    v_mfma_f32_16x16x32_bf16 v[140:143], a[220:223], v[56:59], v[140:143]
    ds_read_b64_tr_b16 a[240:241], v34 offset:0
    v_exp_f32 v110, v110
    v_mfma_f32_16x16x32_bf16 v[172:175], a[220:223], v[64:67], v[172:175]
    s_xor_b32 s54, s13, 0x70000
    ds_read_b64_tr_b16 a[242:243], v34 offset:4096
    v_cvt_pk_bf16_f32 v106, v108, v109
    v_mfma_f32_16x16x32_bf16 v[204:207], a[220:223], v[72:75], v[204:207]
    buffer_load_dwordx4 a[172:175], v14, s[36:39], s54 offen offset:0
    v_exp_f32 v111, v111
    v_mfma_f32_16x16x32_bf16 v[236:239], a[220:223], v[80:83], v[236:239]
    s_waitcnt lgkmcnt(5)
    ds_read_b64_tr_b16 a[244:245], v35 offset:0
    v_cvt_pk_bf16_f32 v99, v102, v103
    v_mfma_f32_16x16x32_bf16 v[128:131], a[224:227], v[88:91], v[128:131]
    ds_read_b64_tr_b16 a[246:247], v35 offset:4096
    v_cvt_pk_bf16_f32 v107, v110, v111
    v_mfma_f32_16x16x32_bf16 v[160:163], a[224:227], v[96:99], v[160:163]
    ds_read_b64_tr_b16 a[248:249], v36 offset:0
    v_accvgpr_read_b32 v49, a76
    v_mfma_f32_16x16x32_bf16 v[192:195], a[224:227], v[104:107], v[192:195]
    buffer_load_dwordx4 a[176:179], v15, s[36:39], s54 offen offset:1024
    v_mfma_f32_16x16x32_bf16 a[64:67], a[80:83], v[88:91], a[64:67]
    ds_read_b64_tr_b16 a[250:251], v36 offset:4096
    v_mfma_f32_16x16x32_bf16 a[68:71], a[80:83], v[96:99], a[68:71]
    ds_read_b64_tr_b16 a[252:253], v37 offset:0
    v_mfma_f32_16x16x32_bf16 a[72:75], a[80:83], v[104:107], a[72:75]
    ds_read_b64_tr_b16 a[254:255], v37 offset:4096
    v_mfma_f32_16x16x32_bf16 v[132:135], a[228:231], v[88:91], v[132:135]
    buffer_load_dwordx4 a[180:183], v16, s[36:39], s54 offen offset:2048
    v_mfma_f32_16x16x32_bf16 v[164:167], a[228:231], v[96:99], v[164:167]
    ds_read_b64_tr_b16 a[192:193], v42 offset:0
    v_mfma_f32_16x16x32_bf16 v[196:199], a[228:231], v[104:107], v[196:199]
    s_waitcnt lgkmcnt(5)
    ds_read_b64_tr_b16 a[194:195], v42 offset:4096
    v_accvgpr_read_b32 v46, a64
    v_mfma_f32_16x16x32_bf16 v[136:139], a[232:235], v[88:91], v[136:139]
    v_rcp_f32 v2, v46
    v_mfma_f32_16x16x32_bf16 v[168:171], a[232:235], v[96:99], v[168:171]
    ds_read_b64_tr_b16 a[196:197], v43 offset:0
    v_accvgpr_read_b32 v47, a68
    v_mfma_f32_16x16x32_bf16 v[200:203], a[232:235], v[104:107], v[200:203]
    v_rcp_f32 v4, v47
    v_mfma_f32_16x16x32_bf16 v[140:143], a[236:239], v[88:91], v[140:143]
    buffer_load_dwordx4 a[184:187], v17, s[36:39], s54 offen offset:3072
    v_mfma_f32_16x16x32_bf16 v[172:175], a[236:239], v[96:99], v[172:175]
    ds_read_b64_tr_b16 a[198:199], v43 offset:4096
    v_accvgpr_read_b32 v48, a72
    v_mfma_f32_16x16x32_bf16 v[204:207], a[236:239], v[104:107], v[204:207]
    v_rcp_f32 v6, v48
    v_mfma_f32_16x16x32_bf16 v[144:147], a[240:243], v[56:59], v[144:147]
    ds_read_b64_tr_b16 a[200:201], v44 offset:0
    v_max3_f32 v50, v46, v47, v48
    v_mfma_f32_16x16x32_bf16 v[176:179], a[240:243], v[64:67], v[176:179]
    ds_read_b64_tr_b16 a[202:203], v44 offset:4096
    v_max_f32 v50, v50, v49
    v_mfma_f32_16x16x32_bf16 v[208:211], a[240:243], v[72:75], v[208:211]
    ds_read_b64_tr_b16 a[204:205], v45 offset:0
    v_mfma_f32_16x16x32_bf16 v[240:243], a[240:243], v[80:83], v[240:243]
L_normA:
    v_pk_mul_f32 v[136:137], v[136:137], v[2:3] op_sel_hi:[1,0]
    v_pk_mul_f32 v[138:139], v[138:139], v[2:3] op_sel_hi:[1,0]
    v_pk_mul_f32 v[140:141], v[140:141], v[2:3] op_sel_hi:[1,0]
    v_pk_mul_f32 v[142:143], v[142:143], v[2:3] op_sel_hi:[1,0]
    v_cvt_pk_bf16_f32 v60, v136, v137
    v_cvt_pk_bf16_f32 v61, v138, v139
    v_cvt_pk_bf16_f32 v62, v140, v141
    v_cvt_pk_bf16_f32 v63, v142, v143
    buffer_store_dwordx4 v[60:63], v18, s[40:43], s92 offen offset:0 sc1
    v_pk_mul_f32 v[168:169], v[168:169], v[4:5] op_sel_hi:[1,0]
    v_pk_mul_f32 v[170:171], v[170:171], v[4:5] op_sel_hi:[1,0]
    v_pk_mul_f32 v[172:173], v[172:173], v[4:5] op_sel_hi:[1,0]
    v_pk_mul_f32 v[174:175], v[174:175], v[4:5] op_sel_hi:[1,0]
    v_cvt_pk_bf16_f32 v68, v168, v169
    v_cvt_pk_bf16_f32 v69, v170, v171
    v_cvt_pk_bf16_f32 v70, v172, v173
    v_cvt_pk_bf16_f32 v71, v174, v175
    buffer_store_dwordx4 v[68:71], v18, s[40:43], s92 offen offset:1024 sc1
    v_pk_mul_f32 v[200:201], v[200:201], v[6:7] op_sel_hi:[1,0]
    v_pk_mul_f32 v[202:203], v[202:203], v[6:7] op_sel_hi:[1,0]
    v_pk_mul_f32 v[204:205], v[204:205], v[6:7] op_sel_hi:[1,0]
    v_pk_mul_f32 v[206:207], v[206:207], v[6:7] op_sel_hi:[1,0]
    v_cvt_pk_bf16_f32 v76, v200, v201
    v_cvt_pk_bf16_f32 v77, v202, v203
    v_cvt_pk_bf16_f32 v78, v204, v205
    v_cvt_pk_bf16_f32 v79, v206, v207
    buffer_store_dwordx4 v[76:79], v18, s[40:43], s93 offen offset:0 sc1
    v_pk_mul_f32 v[128:129], v[128:129], v[2:3] op_sel_hi:[1,0]
    v_pk_mul_f32 v[130:131], v[130:131], v[2:3] op_sel_hi:[1,0]
    v_pk_mul_f32 v[132:133], v[132:133], v[2:3] op_sel_hi:[1,0]
    v_pk_mul_f32 v[134:135], v[134:135], v[2:3] op_sel_hi:[1,0]
    v_cvt_pk_bf16_f32 v84, v128, v129
    v_cvt_pk_bf16_f32 v85, v130, v131
    v_cvt_pk_bf16_f32 v86, v132, v133
    v_cvt_pk_bf16_f32 v87, v134, v135
    v_pk_mul_f32 v[160:161], v[160:161], v[4:5] op_sel_hi:[1,0]
    v_pk_mul_f32 v[162:163], v[162:163], v[4:5] op_sel_hi:[1,0]
    v_pk_mul_f32 v[164:165], v[164:165], v[4:5] op_sel_hi:[1,0]
    v_pk_mul_f32 v[166:167], v[166:167], v[4:5] op_sel_hi:[1,0]
    v_cvt_pk_bf16_f32 v92, v160, v161
    v_cvt_pk_bf16_f32 v93, v162, v163
    v_cvt_pk_bf16_f32 v94, v164, v165
    v_cvt_pk_bf16_f32 v95, v166, v167
    v_pk_mul_f32 v[192:193], v[192:193], v[6:7] op_sel_hi:[1,0]
    v_pk_mul_f32 v[194:195], v[194:195], v[6:7] op_sel_hi:[1,0]
    v_pk_mul_f32 v[196:197], v[196:197], v[6:7] op_sel_hi:[1,0]
    v_pk_mul_f32 v[198:199], v[198:199], v[6:7] op_sel_hi:[1,0]
    v_cvt_pk_bf16_f32 v100, v192, v193
    v_cvt_pk_bf16_f32 v101, v194, v195
    v_cvt_pk_bf16_f32 v102, v196, v197
    v_cvt_pk_bf16_f32 v103, v198, v199
    v_mfma_f32_16x16x32_bf16 v[148:151], a[244:247], v[56:59], v[148:151]
    s_waitcnt vmcnt(37)
    v_subrev_u32 v5, 0x01010101, v54
    v_not_b32 v3, v54
    v_mfma_f32_16x16x32_bf16 v[180:183], a[244:247], v[64:67], v[180:183]
    v_and_b32 v5, v5, v3
    v_and_b32 v5, 0x80808080, v5
    v_mfma_f32_16x16x32_bf16 v[212:215], a[244:247], v[72:75], v[212:215]
    v_cmp_ne_u32 vcc, 0, v5
    s_cbranch_vccnz L_hello_spin
L_hello_ok:
    v_readfirstlane_b32 s100, v54
    s_lshl3_add_u32 s58, s7, 1
    v_mfma_f32_16x16x32_bf16 v[244:247], a[244:247], v[80:83], v[244:247]
    s_waitcnt lgkmcnt(3)
    ds_read_b64_tr_b16 a[206:207], v45 offset:4096
    v_mov_b32 v7, 1
    v_mfma_f32_16x16x32_bf16 v[152:155], a[248:251], v[56:59], v[152:155]
    ds_write_b32 v51, v49
    v_xor_b32 v30, s56, v30
    v_mfma_f32_16x16x32_bf16 v[184:187], a[248:251], v[64:67], v[184:187]
    s_xor_b32 s55, s58, 8
    ds_write_b32 v51, v50 offset:1024
    v_xor_b32 v31, s56, v31
    v_mfma_f32_16x16x32_bf16 v[216:219], a[248:251], v[72:75], v[216:219]
    s_lshr_b32 s55, s100, s55
    ds_write_b128 v21, v[232:235] offset:16384
    v_xor_b32 v32, s56, v32
    v_mfma_f32_16x16x32_bf16 v[248:251], a[248:251], v[80:83], v[248:251]
    s_and_b32 s55, s55, 1
    v_xor_b32 v33, s56, v33
    v_xor_b32 v34, s56, v34
    v_mfma_f32_16x16x32_bf16 v[156:159], a[252:255], v[56:59], v[156:159]
    buffer_store_dwordx4 v[84:87], v18, s[40:43], s93 offen offset:1024 sc1
    v_mfma_f32_16x16x32_bf16 v[188:191], a[252:255], v[64:67], v[188:191]
    s_lshl_b32 s55, s55, 13
    ds_write_b128 v21, v[236:239] offset:17408
    v_xor_b32 v35, s56, v35
    v_mfma_f32_16x16x32_bf16 v[220:223], a[252:255], v[72:75], v[220:223]
    s_add_u32 s55, s55, s16
    v_xor_b32 v36, s56, v36
    v_xor_b32 v37, s56, v37
    v_mfma_f32_16x16x32_bf16 v[252:255], a[252:255], v[80:83], v[252:255]
    s_xor_b32 s9, s55, 0x100000
    v_xor_b32 v38, s56, v38
    v_xor_b32 v39, s56, v39
    v_mfma_f32_16x16x32_bf16 v[144:147], a[192:195], v[88:91], v[144:147]
    buffer_store_dwordx4 v[92:95], v18, s[40:43], s94 offen offset:0 sc1
    v_mfma_f32_16x16x32_bf16 v[176:179], a[192:195], v[96:99], v[176:179]
    s_xor_b32 s88, s55, 0x120000
    ds_write_b128 v21, v[248:251] offset:18432
    v_xor_b32 v40, s56, v40
    v_mfma_f32_16x16x32_bf16 v[208:211], a[192:195], v[104:107], v[208:211]
    s_xor_b32 s55, s58, 16
    v_xor_b32 v41, s56, v41
    v_xor_b32 v42, s56, v42
    v_mfma_f32_16x16x32_bf16 v[148:151], a[196:199], v[88:91], v[148:151]
    s_lshr_b32 s55, s100, s55
    v_xor_b32 v43, s56, v43
    v_xor_b32 v44, s56, v44
    v_mfma_f32_16x16x32_bf16 v[180:183], a[196:199], v[96:99], v[180:183]
    buffer_store_dwordx4 v[100:103], v18, s[40:43], s94 offen offset:1024 sc1
    v_mfma_f32_16x16x32_bf16 v[212:215], a[196:199], v[104:107], v[212:215]
    s_waitcnt lgkmcnt(1)
    s_and_b32 s55, s55, 1
    ds_write_b128 v21, v[252:255] offset:19456
    v_xor_b32 v45, s56, v45
    v_mfma_f32_16x16x32_bf16 v[152:155], a[200:203], v[88:91], v[152:155]
    s_lshl_b32 s55, s55, 13
    v_mfma_f32_16x16x32_bf16 v[184:187], a[200:203], v[96:99], v[184:187]
    s_add_u32 s55, s55, s16
    v_mfma_f32_16x16x32_bf16 v[216:219], a[200:203], v[104:107], v[216:219]
    v_mfma_f32_16x16x32_bf16 v[156:159], a[204:207], v[88:91], v[156:159]
    s_xor_b32 s10, s55, 0x200000
    v_mfma_f32_16x16x32_bf16 v[188:191], a[204:207], v[96:99], v[188:191]
    s_xor_b32 s89, s55, 0x220000
    v_mfma_f32_16x16x32_bf16 v[220:223], a[204:207], v[104:107], v[220:223]
    s_xor_b32 s55, s58, 24
L_merge_normalise:
    s_waitcnt vmcnt(31) lgkmcnt(0)
    s_barrier
    ds_read_b128 v[112:115], v1 offset:1024
    ds_read_b32 v50, v52
    ds_read_b128 v[232:235], v53 offset:16384
    ds_read_b128 v[236:239], v53 offset:17408
    ds_read_b128 v[248:251], v53 offset:18432
    ds_read_b128 v[252:255], v53 offset:19456
    v_pk_mul_f32 v[144:145], v[144:145], v[2:3] op_sel_hi:[1,0]
    v_pk_mul_f32 v[146:147], v[146:147], v[2:3] op_sel_hi:[1,0]
    v_pk_mul_f32 v[148:149], v[148:149], v[2:3] op_sel_hi:[1,0]
    v_pk_mul_f32 v[150:151], v[150:151], v[2:3] op_sel_hi:[1,0]
    v_cvt_pk_bf16_f32 v108, v144, v145
    v_cvt_pk_bf16_f32 v109, v146, v147
    v_cvt_pk_bf16_f32 v110, v148, v149
    v_cvt_pk_bf16_f32 v111, v150, v151
    buffer_store_dwordx4 v[108:111], v18, s[40:43], s95 offen offset:0 sc1
    v_pk_mul_f32 v[176:177], v[176:177], v[4:5] op_sel_hi:[1,0]
    v_pk_mul_f32 v[178:179], v[178:179], v[4:5] op_sel_hi:[1,0]
    v_pk_mul_f32 v[180:181], v[180:181], v[4:5] op_sel_hi:[1,0]
    v_pk_mul_f32 v[182:183], v[182:183], v[4:5] op_sel_hi:[1,0]
    v_cvt_pk_bf16_f32 v56, v176, v177
    v_cvt_pk_bf16_f32 v57, v178, v179
    v_cvt_pk_bf16_f32 v58, v180, v181
    v_cvt_pk_bf16_f32 v59, v182, v183
    v_pk_mul_f32 v[208:209], v[208:209], v[6:7] op_sel_hi:[1,0]
    v_pk_mul_f32 v[210:211], v[210:211], v[6:7] op_sel_hi:[1,0]
    v_pk_mul_f32 v[212:213], v[212:213], v[6:7] op_sel_hi:[1,0]
    v_pk_mul_f32 v[214:215], v[214:215], v[6:7] op_sel_hi:[1,0]
    v_cvt_pk_bf16_f32 v64, v208, v209
    v_cvt_pk_bf16_f32 v65, v210, v211
    v_cvt_pk_bf16_f32 v66, v212, v213
    v_cvt_pk_bf16_f32 v67, v214, v215
    s_waitcnt lgkmcnt(5)
    v_max3_f32 v112, v112, v113, v114
    v_max_f32 v112, v112, v115
    s_waitcnt lgkmcnt(4)
    v_add_f32 v49, v49, v50
    v_cmp_lt_f32 vcc, s60, v112
    v_rcp_f32 v46, v49
    s_cbranch_vccnz L_fallback
    s_waitcnt lgkmcnt(3)
    v_pk_add_f32 v[224:225], v[224:225], v[232:233]
    v_pk_add_f32 v[226:227], v[226:227], v[234:235]
    s_waitcnt lgkmcnt(2)
    v_pk_add_f32 v[228:229], v[228:229], v[236:237]
    v_pk_add_f32 v[230:231], v[230:231], v[238:239]
    s_waitcnt lgkmcnt(1)
    v_pk_add_f32 v[240:241], v[240:241], v[248:249]
    v_pk_add_f32 v[242:243], v[242:243], v[250:251]
    s_waitcnt lgkmcnt(0)
    v_pk_add_f32 v[244:245], v[244:245], v[252:253]
    v_pk_add_f32 v[246:247], v[246:247], v[254:255]
    v_pk_mul_f32 v[224:225], v[224:225], v[46:47] op_sel_hi:[1,0]
    v_pk_mul_f32 v[226:227], v[226:227], v[46:47] op_sel_hi:[1,0]
    v_pk_mul_f32 v[228:229], v[228:229], v[46:47] op_sel_hi:[1,0]
    v_pk_mul_f32 v[230:231], v[230:231], v[46:47] op_sel_hi:[1,0]
    v_cvt_pk_bf16_f32 v72, v224, v225
    v_cvt_pk_bf16_f32 v73, v226, v227
    v_cvt_pk_bf16_f32 v74, v228, v229
    v_cvt_pk_bf16_f32 v75, v230, v231
    v_pk_mul_f32 v[240:241], v[240:241], v[46:47] op_sel_hi:[1,0]
    v_pk_mul_f32 v[242:243], v[242:243], v[46:47] op_sel_hi:[1,0]
    v_pk_mul_f32 v[244:245], v[244:245], v[46:47] op_sel_hi:[1,0]
    v_pk_mul_f32 v[246:247], v[246:247], v[46:47] op_sel_hi:[1,0]
    v_cvt_pk_bf16_f32 v80, v240, v241
    v_cvt_pk_bf16_f32 v81, v242, v243
    v_cvt_pk_bf16_f32 v82, v244, v245
    v_cvt_pk_bf16_f32 v83, v246, v247
    ds_read_b64_tr_b16 a[192:193], v31 offset:0
    ds_read_b64_tr_b16 a[194:195], v31 offset:4096
    ds_read_b64_tr_b16 a[196:197], v39 offset:0
    ds_read_b64_tr_b16 a[198:199], v39 offset:4096
    ds_read_b64_tr_b16 a[200:201], v31 offset:16384
    ds_read_b64_tr_b16 a[202:203], v31 offset:20480
    ds_read_b64_tr_b16 a[204:205], v39 offset:16384
    ds_read_b64_tr_b16 a[206:207], v39 offset:20480
    v_pk_mul_f32 v[152:153], v[152:153], v[2:3] op_sel_hi:[1,0]
    v_pk_mul_f32 v[154:155], v[154:155], v[2:3] op_sel_hi:[1,0]
    v_pk_mul_f32 v[156:157], v[156:157], v[2:3] op_sel_hi:[1,0]
    v_pk_mul_f32 v[158:159], v[158:159], v[2:3] op_sel_hi:[1,0]
    v_cvt_pk_bf16_f32 v88, v152, v153
    v_cvt_pk_bf16_f32 v89, v154, v155
    v_cvt_pk_bf16_f32 v90, v156, v157
    v_cvt_pk_bf16_f32 v91, v158, v159
    v_pk_mul_f32 v[184:185], v[184:185], v[4:5] op_sel_hi:[1,0]
    v_pk_mul_f32 v[186:187], v[186:187], v[4:5] op_sel_hi:[1,0]
    v_pk_mul_f32 v[188:189], v[188:189], v[4:5] op_sel_hi:[1,0]
    v_pk_mul_f32 v[190:191], v[190:191], v[4:5] op_sel_hi:[1,0]
    v_cvt_pk_bf16_f32 v96, v184, v185
    v_cvt_pk_bf16_f32 v97, v186, v187
    v_cvt_pk_bf16_f32 v98, v188, v189
    v_cvt_pk_bf16_f32 v99, v190, v191
    v_pk_mul_f32 v[216:217], v[216:217], v[6:7] op_sel_hi:[1,0]
    v_pk_mul_f32 v[218:219], v[218:219], v[6:7] op_sel_hi:[1,0]
    v_pk_mul_f32 v[220:221], v[220:221], v[6:7] op_sel_hi:[1,0]
    v_pk_mul_f32 v[222:223], v[222:223], v[6:7] op_sel_hi:[1,0]
    v_cvt_pk_bf16_f32 v104, v216, v217
    v_cvt_pk_bf16_f32 v105, v218, v219
    v_cvt_pk_bf16_f32 v106, v220, v221
    v_cvt_pk_bf16_f32 v107, v222, v223
L_out_projection:
    s_waitcnt lgkmcnt(6)
    v_mfma_f32_16x16x32_bf16 v[144:147], a[192:195], v[84:87], 0
    s_waitcnt lgkmcnt(4)
    s_lshr_b32 s55, s100, s55
    ds_read_b64_tr_b16 a[208:209], v32 offset:0
    v_add_u32 v3, 0x10000, v21
    v_mfma_f32_16x16x32_bf16 v[144:147], a[196:199], v[60:63], v[144:147]
    s_waitcnt lgkmcnt(3)
    buffer_store_dwordx4 v[56:59], v18, s[40:43], s95 offen offset:1024 sc1
    v_mfma_f32_16x16x32_bf16 v[144:147], a[200:203], v[108:111], v[144:147]
    s_waitcnt lgkmcnt(1)
    s_and_b32 s55, s55, 1
    ds_read_b64_tr_b16 a[210:211], v32 offset:4096
    v_add_u32 v112, 0x20000, v30
    v_mfma_f32_16x16x32_bf16 v[144:147], a[204:207], v[88:91], v[144:147]
    s_lshl_b32 s55, s55, 13
    ds_read_b64_tr_b16 a[212:213], v40 offset:0
    v_add_u32 v113, 0x20000, v31
    v_mfma_f32_16x16x32_bf16 v[148:151], a[192:195], v[92:95], 0
    s_add_u32 s55, s55, s16
    ds_read_b64_tr_b16 a[214:215], v40 offset:4096
    v_add_u32 v114, 0x20000, v32
    v_mfma_f32_16x16x32_bf16 v[148:151], a[196:199], v[68:71], v[148:151]
    s_xor_b32 s11, s55, 0x300000
    ds_read_b64_tr_b16 a[216:217], v32 offset:16384
    v_add_u32 v115, 0x20000, v33
    v_mfma_f32_16x16x32_bf16 v[148:151], a[200:203], v[56:59], v[148:151]
    ds_read_b64_tr_b16 a[218:219], v32 offset:20480
    v_add_u32 v116, 0x20000, v34
    v_mfma_f32_16x16x32_bf16 v[148:151], a[204:207], v[96:99], v[148:151]
    s_xor_b32 s90, s55, 0x320000
    ds_read_b64_tr_b16 a[220:221], v40 offset:16384
    v_add_u32 v117, 0x20000, v35
    v_mfma_f32_16x16x32_bf16 v[152:155], a[192:195], v[100:103], 0
    ds_read_b64_tr_b16 a[222:223], v40 offset:20480
    v_add_u32 v118, 0x20000, v36
    v_mfma_f32_16x16x32_bf16 v[152:155], a[196:199], v[76:79], v[152:155]
    ds_read_b64_tr_b16 a[224:225], v33 offset:0
    v_add_u32 v119, 0x20000, v37
    v_mfma_f32_16x16x32_bf16 v[152:155], a[200:203], v[64:67], v[152:155]
    ds_read_b64_tr_b16 a[226:227], v33 offset:4096
    v_add_u32 v120, 0x20000, v38
    v_mfma_f32_16x16x32_bf16 v[152:155], a[204:207], v[104:107], v[152:155]
    ds_read_b64_tr_b16 a[228:229], v41 offset:0
    v_add_u32 v121, 0x20000, v39
    v_mfma_f32_16x16x32_bf16 v[156:159], a[192:195], v[72:75], 0
    buffer_store_dwordx4 v[64:67], v18, s[40:43], s96 offen offset:0 sc1
    v_mfma_f32_16x16x32_bf16 v[156:159], a[200:203], v[80:83], v[156:159]
    s_waitcnt lgkmcnt(6)
    ds_read_b64_tr_b16 a[230:231], v41 offset:4096
    v_add_u32 v122, 0x20000, v40
    v_mfma_f32_16x16x32_bf16 v[160:163], a[208:211], v[84:87], 0
    ds_read_b64_tr_b16 a[232:233], v33 offset:16384
    v_add_u32 v123, 0x20000, v41
    v_mfma_f32_16x16x32_bf16 v[160:163], a[212:215], v[60:63], v[160:163]
    s_waitcnt lgkmcnt(6)
    ds_read_b64_tr_b16 a[234:235], v33 offset:20480
    v_add_u32 v124, 0x20000, v42
    v_mfma_f32_16x16x32_bf16 v[160:163], a[216:219], v[108:111], v[160:163]
    s_waitcnt lgkmcnt(6)
    ds_read_b64_tr_b16 a[236:237], v41 offset:16384
    v_add_u32 v125, 0x20000, v43
    v_mfma_f32_16x16x32_bf16 v[160:163], a[220:223], v[88:91], v[160:163]
    ds_read_b64_tr_b16 a[238:239], v41 offset:20480
    v_add_u32 v126, 0x20000, v44
    v_mfma_f32_16x16x32_bf16 v[164:167], a[208:211], v[92:95], 0
    ds_read_b64_tr_b16 a[240:241], v34 offset:0
    v_add_u32 v127, 0x20000, v45
    v_mfma_f32_16x16x32_bf16 v[164:167], a[212:215], v[68:71], v[164:167]
    s_waitcnt vmcnt(3)
    ds_read_b64_tr_b16 a[242:243], v34 offset:4096
    v_add_u32 v8, 16384, v18
    v_mfma_f32_16x16x32_bf16 v[164:167], a[216:219], v[56:59], v[164:167]
L_fx20:
    buffer_store_dword v7, v19, s[40:43], s61 offen sc1
    v_mfma_f32_16x16x32_bf16 v[164:167], a[220:223], v[96:99], v[164:167]
    s_barrier
    ds_read_b64_tr_b16 a[244:245], v42 offset:0
    v_add_u32 v9, 32768, v18
    v_mfma_f32_16x16x32_bf16 v[168:171], a[208:211], v[100:103], 0
    ds_read_b64_tr_b16 a[246:247], v42 offset:4096
    v_add_u32 v10, 49152, v18
    v_mfma_f32_16x16x32_bf16 v[168:171], a[212:215], v[76:79], v[168:171]
    ds_read_b64_tr_b16 a[248:249], v34 offset:16384
    v_add_u32 v11, 65536, v18
    v_mfma_f32_16x16x32_bf16 v[168:171], a[216:219], v[64:67], v[168:171]
    buffer_store_dwordx4 v[72:75], v18, s[40:43], s96 offen offset:1024 sc1
    v_mfma_f32_16x16x32_bf16 v[168:171], a[220:223], v[104:107], v[168:171]
    ds_read_b64_tr_b16 a[250:251], v34 offset:20480
    v_add_u32 v12, 81920, v18
    v_mfma_f32_16x16x32_bf16 v[172:175], a[208:211], v[72:75], 0
    ds_read_b64_tr_b16 a[252:253], v42 offset:16384
    v_add_u32 v13, 98304, v18
    v_mfma_f32_16x16x32_bf16 v[172:175], a[216:219], v[80:83], v[172:175]
    s_waitcnt lgkmcnt(5)
    ds_read_b64_tr_b16 a[254:255], v42 offset:20480
    v_and_b32 v4, 15, v0
    v_mfma_f32_16x16x32_bf16 v[176:179], a[224:227], v[84:87], 0
    ds_read_b64_tr_b16 a[192:193], v35 offset:0
    v_lshlrev_b32 v4, 10, v4
    v_mfma_f32_16x16x32_bf16 v[176:179], a[228:231], v[60:63], v[176:179]
    ds_read_b64_tr_b16 a[194:195], v35 offset:4096
    v_lshrrev_b32 v2, 4, v0
    v_mfma_f32_16x16x32_bf16 v[176:179], a[232:235], v[108:111], v[176:179]
    ds_read_b64_tr_b16 a[196:197], v43 offset:0
    v_lshl_add_u32 v55, v2, 3, v4
    v_mfma_f32_16x16x32_bf16 v[176:179], a[236:239], v[88:91], v[176:179]
    ds_read_b64_tr_b16 a[198:199], v43 offset:4096
    v_xor_b32 v1, 0x1000, v21
    v_mfma_f32_16x16x32_bf16 v[180:183], a[224:227], v[92:95], 0
    ds_read_b64_tr_b16 a[200:201], v35 offset:16384
    v_bfe_u32 v2, v54, s58, 1
    v_mfma_f32_16x16x32_bf16 v[180:183], a[228:231], v[68:71], v[180:183]
    ds_read_b64_tr_b16 a[202:203], v35 offset:20480
    v_lshlrev_b32 v2, 13, v2
    v_mfma_f32_16x16x32_bf16 v[180:183], a[232:235], v[56:59], v[180:183]
    ds_read_b64_tr_b16 a[204:205], v43 offset:16384
    v_lshlrev_b32 v4, 22, v0
    v_mfma_f32_16x16x32_bf16 v[180:183], a[236:239], v[96:99], v[180:183]
    ds_read_b64_tr_b16 a[206:207], v43 offset:20480
    v_xor_b32 v4, s17, v4
    v_mfma_f32_16x16x32_bf16 v[184:187], a[224:227], v[100:103], 0
    buffer_store_dwordx4 v[80:83], v18, s[40:43], s97 offen offset:0 sc1
    v_mfma_f32_16x16x32_bf16 v[184:187], a[228:231], v[76:79], v[184:187]
    ds_read_b64_tr_b16 a[208:209], v36 offset:0
    v_add_u32 v2, v2, v4
    v_mfma_f32_16x16x32_bf16 v[184:187], a[232:235], v[64:67], v[184:187]
    ds_read_b64_tr_b16 a[210:211], v36 offset:4096
    v_add_u32 v4, -1, v0
    v_mfma_f32_16x16x32_bf16 v[184:187], a[236:239], v[104:107], v[184:187]
    ds_read_b64_tr_b16 a[212:213], v44 offset:0
    v_lshl_add_u32 v5, v4, 14, v2
    v_mfma_f32_16x16x32_bf16 v[188:191], a[224:227], v[72:75], 0
    ds_write_b128 v3, a[172:175] offset:0
    v_lshl_add_u32 v2, v0, 7, v2
    v_mfma_f32_16x16x32_bf16 v[188:191], a[232:235], v[80:83], v[188:191]
    v_add_u32 v20, 0x1c000, v2
    v_bfrev_b32 v6, 1
    v_mfma_f32_16x16x32_bf16 v[192:195], a[240:243], v[84:87], 0
    s_waitcnt lgkmcnt(5)
    v_mfma_f32_16x16x32_bf16 v[192:195], a[244:247], v[60:63], v[192:195]
    ds_read_b64_tr_b16 a[214:215], v44 offset:4096
    v_mfma_f32_16x16x32_bf16 v[192:195], a[248:251], v[108:111], v[192:195]
    ds_write_b128 v3, a[176:179] offset:1024
    v_mfma_f32_16x16x32_bf16 v[192:195], a[252:255], v[88:91], v[192:195]
    v_mfma_f32_16x16x32_bf16 v[196:199], a[240:243], v[92:95], 0
    v_mfma_f32_16x16x32_bf16 v[196:199], a[244:247], v[68:71], v[196:199]
    ds_read_b64_tr_b16 a[216:217], v36 offset:16384
    v_mfma_f32_16x16x32_bf16 v[196:199], a[248:251], v[56:59], v[196:199]
    ds_write_b128 v3, a[180:183] offset:2048
    v_mfma_f32_16x16x32_bf16 v[196:199], a[252:255], v[96:99], v[196:199]
    buffer_store_dwordx4 v[88:91], v18, s[40:43], s97 offen offset:1024 sc1
    v_mfma_f32_16x16x32_bf16 v[200:203], a[240:243], v[100:103], 0
    v_mfma_f32_16x16x32_bf16 v[200:203], a[244:247], v[76:79], v[200:203]
    ds_read_b64_tr_b16 a[218:219], v36 offset:20480
    v_mfma_f32_16x16x32_bf16 v[200:203], a[248:251], v[64:67], v[200:203]
    ds_write_b128 v3, a[184:187] offset:3072
    v_mfma_f32_16x16x32_bf16 v[200:203], a[252:255], v[104:107], v[200:203]
    v_mfma_f32_16x16x32_bf16 v[204:207], a[240:243], v[72:75], 0
    v_mfma_f32_16x16x32_bf16 v[204:207], a[248:251], v[80:83], v[204:207]
    ds_read_b64_tr_b16 a[220:221], v44 offset:16384
    v_mfma_f32_16x16x32_bf16 v[208:211], a[192:195], v[84:87], 0
    ds_read_b64_tr_b16 a[222:223], v44 offset:20480
    v_mfma_f32_16x16x32_bf16 v[208:211], a[196:199], v[60:63], v[208:211]
    ds_read_b64_tr_b16 a[224:225], v37 offset:0
    v_mfma_f32_16x16x32_bf16 v[208:211], a[200:203], v[108:111], v[208:211]
    s_buffer_load_dword s84, s[40:43], s88 offset:0x1c000 glc
    ds_read_b64_tr_b16 a[226:227], v37 offset:4096
    s_waitcnt lgkmcnt(6)
    v_mfma_f32_16x16x32_bf16 v[208:211], a[204:207], v[88:91], v[208:211]
    s_buffer_load_dword s85, s[40:43], s89 offset:0x1c000 glc
    ds_read_b64_tr_b16 a[228:229], v45 offset:0
    v_mfma_f32_16x16x32_bf16 v[212:215], a[192:195], v[92:95], 0
    s_buffer_load_dword s86, s[40:43], s90 offset:0x1c000 glc
    ds_read_b64_tr_b16 a[230:231], v45 offset:4096
    v_mfma_f32_16x16x32_bf16 v[212:215], a[196:199], v[68:71], v[212:215]
    buffer_store_dwordx4 v[96:99], v18, s[40:43], s98 offen offset:0 sc1
    v_mfma_f32_16x16x32_bf16 v[212:215], a[200:203], v[56:59], v[212:215]
    ds_read_b64_tr_b16 a[232:233], v37 offset:16384
    v_mfma_f32_16x16x32_bf16 v[212:215], a[204:207], v[96:99], v[212:215]
L_pad7:
    s_cbranch_execz L_wret
    ds_read_b64_tr_b16 a[234:235], v37 offset:20480
    v_mfma_f32_16x16x32_bf16 v[216:219], a[192:195], v[100:103], 0
    ds_read_b64_tr_b16 a[236:237], v45 offset:16384
    v_mfma_f32_16x16x32_bf16 v[216:219], a[196:199], v[76:79], v[216:219]
    ds_read_b64_tr_b16 a[238:239], v45 offset:20480
    v_mfma_f32_16x16x32_bf16 v[216:219], a[200:203], v[64:67], v[216:219]
    ds_read_b64_tr_b16 a[240:241], v30 offset:0
    v_mfma_f32_16x16x32_bf16 v[216:219], a[204:207], v[104:107], v[216:219]
    ds_read_b64_tr_b16 a[242:243], v30 offset:4096
    v_mfma_f32_16x16x32_bf16 v[220:223], a[192:195], v[72:75], 0
    ds_read_b64_tr_b16 a[244:245], v38 offset:0
    v_mfma_f32_16x16x32_bf16 v[220:223], a[200:203], v[80:83], v[220:223]
    ds_read_b64_tr_b16 a[246:247], v38 offset:4096
    v_mfma_f32_16x16x32_bf16 v[224:227], a[208:211], v[84:87], 0
    ds_read_b64_tr_b16 a[248:249], v30 offset:16384
    v_mfma_f32_16x16x32_bf16 v[224:227], a[212:215], v[60:63], v[224:227]
    s_waitcnt lgkmcnt(7)
    ds_read_b64_tr_b16 a[250:251], v30 offset:20480
    v_mfma_f32_16x16x32_bf16 v[224:227], a[216:219], v[108:111], v[224:227]
    buffer_store_dwordx4 v[104:107], v18, s[40:43], s98 offen offset:1024 sc1
    v_mfma_f32_16x16x32_bf16 v[224:227], a[220:223], v[88:91], v[224:227]
    ds_read_b64_tr_b16 a[252:253], v38 offset:16384
    v_mfma_f32_16x16x32_bf16 v[228:231], a[208:211], v[92:95], 0
    ds_read_b64_tr_b16 a[254:255], v38 offset:20480
    v_mfma_f32_16x16x32_bf16 v[228:231], a[212:215], v[68:71], v[228:231]
    ds_read_b64_tr_b16 a[192:193], v121 offset:16384
    v_mfma_f32_16x16x32_bf16 v[228:231], a[216:219], v[56:59], v[228:231]
    ds_read_b64_tr_b16 a[194:195], v121 offset:20480
    v_mfma_f32_16x16x32_bf16 v[228:231], a[220:223], v[96:99], v[228:231]
    ds_read_b64_tr_b16 a[196:197], v122 offset:16384
    v_mfma_f32_16x16x32_bf16 v[232:235], a[208:211], v[100:103], 0
    ds_read_b64_tr_b16 a[198:199], v122 offset:20480
    v_mfma_f32_16x16x32_bf16 v[232:235], a[212:215], v[76:79], v[232:235]
    ds_read_b64_tr_b16 a[200:201], v123 offset:16384
    v_mfma_f32_16x16x32_bf16 v[232:235], a[216:219], v[64:67], v[232:235]
    ds_read_b64_tr_b16 a[202:203], v123 offset:20480
    v_mfma_f32_16x16x32_bf16 v[232:235], a[220:223], v[104:107], v[232:235]
    s_waitcnt vmcnt(3)
    ds_read_b64_tr_b16 a[204:205], v124 offset:16384
    v_mfma_f32_16x16x32_bf16 v[236:239], a[208:211], v[72:75], 0
L_fx82:
    buffer_store_dword v7, v19, s[40:43], s61 offen offset:1024 sc1
    v_mfma_f32_16x16x32_bf16 v[236:239], a[216:219], v[80:83], v[236:239]
    ds_read_b64_tr_b16 a[206:207], v124 offset:20480
    v_mfma_f32_16x16x32_bf16 v[240:243], a[224:227], v[84:87], 0
    ds_read_b64_tr_b16 a[208:209], v125 offset:16384
    v_mfma_f32_16x16x32_bf16 v[240:243], a[228:231], v[60:63], v[240:243]
    ds_read_b64_tr_b16 a[210:211], v125 offset:20480
    v_mfma_f32_16x16x32_bf16 v[240:243], a[232:235], v[108:111], v[240:243]
    s_waitcnt lgkmcnt(0)
    s_and_b32 s84, s84, s85
    s_and_b32 s84, s84, s86
    s_cbranch_scc0 L_poll_first
L_poll_ok:
    ds_read_b64_tr_b16 a[212:213], v126 offset:16384
    v_mfma_f32_16x16x32_bf16 v[240:243], a[236:239], v[88:91], v[240:243]
    buffer_load_dwordx4 a[4:7], v18, s[40:43], s9 offen offset:0 sc1
    v_mfma_f32_16x16x32_bf16 v[244:247], a[224:227], v[92:95], 0
    ds_read_b64_tr_b16 a[214:215], v126 offset:20480
    v_mfma_f32_16x16x32_bf16 v[244:247], a[228:231], v[68:71], v[244:247]
    buffer_load_dwordx4 a[20:23], v18, s[40:43], s9 offen offset:1024 sc1
    v_mfma_f32_16x16x32_bf16 v[244:247], a[232:235], v[56:59], v[244:247]
    ds_read_b64_tr_b16 a[216:217], v127 offset:16384
    v_mfma_f32_16x16x32_bf16 v[244:247], a[236:239], v[96:99], v[244:247]
    buffer_load_dwordx4 a[36:39], v8, s[40:43], s9 offen offset:0 sc1
    v_mfma_f32_16x16x32_bf16 v[248:251], a[224:227], v[100:103], 0
    ds_read_b64_tr_b16 a[218:219], v127 offset:20480
    v_mfma_f32_16x16x32_bf16 v[248:251], a[228:231], v[76:79], v[248:251]
    buffer_load_dwordx4 a[60:63], v18, s[40:43], s10 offen offset:0 sc1
    v_mfma_f32_16x16x32_bf16 v[248:251], a[232:235], v[64:67], v[248:251]
    ds_read_b64_tr_b16 a[220:221], v121 offset:0
    v_mfma_f32_16x16x32_bf16 v[248:251], a[236:239], v[104:107], v[248:251]
    buffer_load_dwordx4 a[76:79], v18, s[40:43], s10 offen offset:1024 sc1
    v_mfma_f32_16x16x32_bf16 v[252:255], a[224:227], v[72:75], 0
    ds_read_b64_tr_b16 a[222:223], v121 offset:4096
    v_mfma_f32_16x16x32_bf16 v[252:255], a[232:235], v[80:83], v[252:255]
    buffer_load_dwordx4 a[92:95], v8, s[40:43], s10 offen offset:0 sc1
    v_mfma_f32_16x16x32_bf16 v[128:131], a[240:243], v[84:87], 0
    ds_read_b64_tr_b16 a[224:225], v122 offset:0
    v_mfma_f32_16x16x32_bf16 v[128:131], a[244:247], v[60:63], v[128:131]
    buffer_load_dwordx4 a[116:119], v18, s[40:43], s11 offen offset:0 sc1
    v_mfma_f32_16x16x32_bf16 v[128:131], a[248:251], v[108:111], v[128:131]
    ds_read_b64_tr_b16 a[226:227], v122 offset:4096
    v_add_u32 v30, 0x10000, v30
    v_mfma_f32_16x16x32_bf16 v[128:131], a[252:255], v[88:91], v[128:131]
    buffer_load_dwordx4 a[132:135], v18, s[40:43], s11 offen offset:1024 sc1
    v_mfma_f32_16x16x32_bf16 v[132:135], a[240:243], v[92:95], 0
    ds_read_b64_tr_b16 a[228:229], v123 offset:0
    v_add_u32 v31, 0x10000, v31
    v_mfma_f32_16x16x32_bf16 v[132:135], a[244:247], v[68:71], v[132:135]
    buffer_load_dwordx4 a[148:151], v8, s[40:43], s11 offen offset:0 sc1
    v_mfma_f32_16x16x32_bf16 v[132:135], a[248:251], v[56:59], v[132:135]
    ds_read_b64_tr_b16 a[230:231], v123 offset:4096
    v_add_u32 v32, 0x10000, v32
    v_mfma_f32_16x16x32_bf16 v[132:135], a[252:255], v[96:99], v[132:135]
    buffer_load_dwordx4 a[0:3], v8, s[40:43], s9 offen offset:1024 sc1
    v_mfma_f32_16x16x32_bf16 v[136:139], a[240:243], v[100:103], 0
    ds_read_b64_tr_b16 a[232:233], v124 offset:0
    v_add_u32 v33, 0x10000, v33
    v_mfma_f32_16x16x32_bf16 v[136:139], a[244:247], v[76:79], v[136:139]
    buffer_load_dwordx4 a[16:19], v9, s[40:43], s9 offen offset:0 sc1
    v_mfma_f32_16x16x32_bf16 v[136:139], a[248:251], v[64:67], v[136:139]
    s_buffer_load_dword s84, s[40:43], s88 offset:0x1c400 glc
    ds_read_b64_tr_b16 a[234:235], v124 offset:4096
    v_add_u32 v34, 0x10000, v34
    v_mfma_f32_16x16x32_bf16 v[136:139], a[252:255], v[104:107], v[136:139]
    s_buffer_load_dword s85, s[40:43], s89 offset:0x1c400 glc
    ds_read_b64_tr_b16 a[236:237], v125 offset:0
    v_add_u32 v35, 0x10000, v35
    v_mfma_f32_16x16x32_bf16 v[140:143], a[240:243], v[72:75], 0
    s_buffer_load_dword s86, s[40:43], s90 offset:0x1c400 glc
    ds_read_b64_tr_b16 a[238:239], v125 offset:4096
    v_add_u32 v36, 0x10000, v36
    v_mfma_f32_16x16x32_bf16 v[140:143], a[248:251], v[80:83], v[140:143]
    s_waitcnt vmcnt(10)
    buffer_load_dwordx4 a[32:35], v9, s[40:43], s9 offen offset:1024 sc1
    v_mfma_f32_16x16x32_bf16 v[144:147], a[192:195], a[4:7], v[144:147]
    s_waitcnt vmcnt(10)
    ds_read_b64_tr_b16 a[240:241], v126 offset:0
    v_add_u32 v37, 0x10000, v37
    v_mfma_f32_16x16x32_bf16 v[148:151], a[192:195], a[20:23], v[148:151]
    s_waitcnt vmcnt(9)
    ds_read_b64_tr_b16 a[242:243], v126 offset:4096
    v_add_u32 v38, 0x10000, v38
    v_mfma_f32_16x16x32_bf16 v[152:155], a[192:195], a[36:39], v[152:155]
    ds_read_b64_tr_b16 a[244:245], v127 offset:0
    v_add_u32 v39, 0x10000, v39
    v_mfma_f32_16x16x32_bf16 v[160:163], a[196:199], a[4:7], v[160:163]
    ds_read_b64_tr_b16 a[246:247], v127 offset:4096
    v_add_u32 v40, 0x10000, v40
    v_mfma_f32_16x16x32_bf16 v[164:167], a[196:199], a[20:23], v[164:167]
L_fx116:
    buffer_store_dword v7, v19, s[40:43], s61 offen offset:1152 sc1
    v_mfma_f32_16x16x32_bf16 v[168:171], a[196:199], a[36:39], v[168:171]
    buffer_load_dwordx4 a[56:59], v8, s[40:43], s10 offen offset:1024 sc1
    v_mfma_f32_16x16x32_bf16 v[176:179], a[200:203], a[4:7], v[176:179]
    v_add_u32 v41, 0x10000, v41
    v_add_u32 v42, 0x10000, v42
    v_add_u32 v43, 0x10000, v43
    v_add_u32 v44, 0x10000, v44
    v_add_u32 v45, 0x10000, v45
    v_mfma_f32_16x16x32_bf16 v[180:183], a[200:203], a[20:23], v[180:183]
    buffer_load_dwordx4 a[72:75], v9, s[40:43], s10 offen offset:0 sc1
    v_mfma_f32_16x16x32_bf16 v[184:187], a[200:203], a[36:39], v[184:187]
    ds_read_b64_tr_b16 a[248:249], v39 offset:16384
    v_readlane_b32 s92, v5, 1
    v_mfma_f32_16x16x32_bf16 v[192:195], a[204:207], a[4:7], v[192:195]
    ds_read_b64_tr_b16 a[250:251], v39 offset:20480
    v_readlane_b32 s93, v5, 2
    v_mfma_f32_16x16x32_bf16 v[196:199], a[204:207], a[20:23], v[196:199]
    ds_read_b64_tr_b16 a[252:253], v40 offset:16384
    v_readlane_b32 s94, v5, 3
    v_mfma_f32_16x16x32_bf16 v[200:203], a[204:207], a[36:39], v[200:203]
    buffer_load_dwordx4 a[88:91], v9, s[40:43], s10 offen offset:1024 sc1
    v_mfma_f32_16x16x32_bf16 v[208:211], a[208:211], a[4:7], v[208:211]
    ds_read_b64_tr_b16 a[254:255], v40 offset:20480
    v_readlane_b32 s95, v5, 4
    v_mfma_f32_16x16x32_bf16 v[212:215], a[208:211], a[20:23], v[212:215]
    ds_read_b64_tr_b16 a[192:193], v41 offset:16384
    v_readlane_b32 s96, v5, 5
    v_mfma_f32_16x16x32_bf16 v[216:219], a[208:211], a[36:39], v[216:219]
    s_waitcnt lgkmcnt(5)
    ds_read_b64_tr_b16 a[194:195], v41 offset:20480
    v_readlane_b32 s97, v5, 6
    v_mfma_f32_16x16x32_bf16 v[224:227], a[212:215], a[4:7], v[224:227]
    buffer_load_dwordx4 a[112:115], v8, s[40:43], s11 offen offset:1024 sc1
    v_mfma_f32_16x16x32_bf16 v[228:231], a[212:215], a[20:23], v[228:231]
    ds_read_b64_tr_b16 a[196:197], v42 offset:16384
    v_readlane_b32 s98, v5, 7
    v_mfma_f32_16x16x32_bf16 v[232:235], a[212:215], a[36:39], v[232:235]
    ds_read_b64_tr_b16 a[198:199], v42 offset:20480
    v_lshrrev_b32 v70, 4, v0
    v_mfma_f32_16x16x32_bf16 v[240:243], a[216:219], a[4:7], v[240:243]
    ds_read_b64_tr_b16 a[200:201], v43 offset:16384
    v_lshl_add_u32 v67, s8, 1, v70
    v_mfma_f32_16x16x32_bf16 v[244:247], a[216:219], a[20:23], v[244:247]
    buffer_load_dwordx4 a[128:131], v9, s[40:43], s11 offen offset:0 sc1
    v_mfma_f32_16x16x32_bf16 v[248:251], a[216:219], a[36:39], v[248:251]
    s_waitcnt vmcnt(14)
    ds_read_b64_tr_b16 a[202:203], v43 offset:20480
    v_xor_b32 v67, 3, v67
    v_mfma_f32_16x16x32_bf16 v[144:147], a[220:223], a[60:63], v[144:147]
    s_waitcnt vmcnt(13)
    ds_read_b64_tr_b16 a[204:205], v44 offset:16384
    v_add_u32 v67, -1, v67
    v_mfma_f32_16x16x32_bf16 v[148:151], a[220:223], a[76:79], v[148:151]
    s_waitcnt lgkmcnt(0)
    s_and_b32 s84, s84, s85
    s_and_b32 s84, s84, s86
    s_cbranch_scc0 L_pollb_first
L_pollb_ok:
    ds_read_b64_tr_b16 a[206:207], v44 offset:20480
    v_and_b32 v67, 0x80000000, v67
    s_waitcnt vmcnt(12)
    v_mfma_f32_16x16x32_bf16 v[152:155], a[220:223], a[92:95], v[152:155]
    buffer_load_dwordx4 a[144:147], v9, s[40:43], s11 offen offset:1024 sc1
    v_mfma_f32_16x16x32_bf16 v[160:163], a[224:227], a[60:63], v[160:163]
    buffer_load_dwordx4 a[48:51], v11, s[40:43], s9 offen offset:1024 sc1
    v_mfma_f32_16x16x32_bf16 v[164:167], a[224:227], a[76:79], v[164:167]
    ds_read_b64_tr_b16 a[208:209], v45 offset:16384
    v_or_b32 v60, v67, v18
    v_mfma_f32_16x16x32_bf16 v[168:171], a[224:227], a[92:95], v[168:171]
    ds_read_b64_tr_b16 a[210:211], v45 offset:20480
    v_or_b32 v61, v67, v8
    v_mfma_f32_16x16x32_bf16 v[176:179], a[228:231], a[60:63], v[176:179]
    buffer_load_dwordx4 a[104:107], v11, s[40:43], s10 offen offset:1024 sc1
    v_mfma_f32_16x16x32_bf16 v[180:183], a[228:231], a[76:79], v[180:183]
    ds_read_b64_tr_b16 a[212:213], v113 offset:16384
    v_or_b32 v62, v67, v9
    v_mfma_f32_16x16x32_bf16 v[184:187], a[228:231], a[92:95], v[184:187]
    ds_read_b64_tr_b16 a[214:215], v113 offset:20480
    v_or_b32 v63, v67, v10
    v_mfma_f32_16x16x32_bf16 v[192:195], a[232:235], a[60:63], v[192:195]
    ds_read_b64_tr_b16 a[216:217], v113 offset:0
    v_or_b32 v64, v67, v11
    v_mfma_f32_16x16x32_bf16 v[196:199], a[232:235], a[76:79], v[196:199]
    buffer_load_dwordx4 a[160:163], v11, s[40:43], s11 offen offset:1024 sc1
    v_mfma_f32_16x16x32_bf16 v[200:203], a[232:235], a[92:95], v[200:203]
    ds_read_b64_tr_b16 a[218:219], v113 offset:4096
    v_or_b32 v65, v67, v12
    v_mfma_f32_16x16x32_bf16 v[208:211], a[236:239], a[60:63], v[208:211]
    ds_read_b64_tr_b16 a[220:221], v31 offset:16384
    v_or_b32 v66, v67, v13
    v_mfma_f32_16x16x32_bf16 v[212:215], a[236:239], a[76:79], v[212:215]
    ds_read_b64_tr_b16 a[222:223], v31 offset:20480
    v_and_b32 v71, 15, v0
    v_mfma_f32_16x16x32_bf16 v[216:219], a[236:239], a[92:95], v[216:219]
    buffer_load_dwordx4 a[8:11], v10, s[40:43], s9 offen offset:0 sc1
    v_mfma_f32_16x16x32_bf16 v[224:227], a[240:243], a[60:63], v[224:227]
    ds_read_b64_tr_b16 a[224:225], v114 offset:16384
    v_lshlrev_b32 v71, 10, v71
    v_mfma_f32_16x16x32_bf16 v[228:231], a[240:243], a[76:79], v[228:231]
    ds_read_b64_tr_b16 a[226:227], v114 offset:20480
    v_and_b32 v68, 2, v70
    v_mfma_f32_16x16x32_bf16 v[232:235], a[240:243], a[92:95], v[232:235]
    ds_read_b64_tr_b16 a[228:229], v114 offset:0
    v_lshl_add_u32 v71, v68, 3, v71
    v_mfma_f32_16x16x32_bf16 v[240:243], a[244:247], a[60:63], v[240:243]
    buffer_load_dwordx4 a[24:27], v10, s[40:43], s9 offen offset:1024 sc1
    v_mfma_f32_16x16x32_bf16 v[244:247], a[244:247], a[76:79], v[244:247]
    ds_read_b64_tr_b16 a[230:231], v114 offset:4096
    v_and_b32 v68, 1, v70
    v_mfma_f32_16x16x32_bf16 v[248:251], a[244:247], a[92:95], v[248:251]
    s_waitcnt vmcnt(17)
    ds_read_b64_tr_b16 a[232:233], v32 offset:16384
    v_lshl_add_u32 v68, v68, 14, v71
    v_mfma_f32_16x16x32_bf16 v[144:147], a[248:251], a[116:119], v[144:147]
    s_waitcnt vmcnt(16)
    ds_read_b64_tr_b16 a[234:235], v32 offset:20480
    v_not_b32 v70, v70
    v_mfma_f32_16x16x32_bf16 v[148:151], a[248:251], a[132:135], v[148:151]
    s_waitcnt vmcnt(15)
    buffer_load_dwordx4 a[40:43], v11, s[40:43], s9 offen offset:0 sc1
    v_mfma_f32_16x16x32_bf16 v[152:155], a[248:251], a[148:151], v[152:155]
    s_buffer_load_dword s84, s[40:43], s88 offset:0x1c480 glc
    ds_read_b64_tr_b16 a[236:237], v115 offset:16384
    v_and_b32 v70, s8, v70
    v_mfma_f32_16x16x32_bf16 v[160:163], a[252:255], a[116:119], v[160:163]
    s_buffer_load_dword s85, s[40:43], s89 offset:0x1c480 glc
    ds_read_b64_tr_b16 a[238:239], v115 offset:20480
    v_lshl_add_u32 v69, v70, 16, v68
    v_mfma_f32_16x16x32_bf16 v[164:167], a[252:255], a[132:135], v[164:167]
    s_buffer_load_dword s86, s[40:43], s90 offset:0x1c480 glc
    ds_read_b64_tr_b16 a[240:241], v115 offset:0
    v_or_b32 v69, v67, v69
    v_mfma_f32_16x16x32_bf16 v[168:171], a[252:255], a[148:151], v[168:171]
    buffer_load_dwordx4 a[52:55], v12, s[40:43], s9 offen offset:0 sc1
    v_mfma_f32_16x16x32_bf16 v[176:179], a[192:195], a[116:119], v[176:179]
    s_barrier
    ds_read_b64_tr_b16 a[242:243], v115 offset:4096
    v_subrev_u32 v58, 0x8000, v21
    v_mfma_f32_16x16x32_bf16 v[180:183], a[192:195], a[132:135], v[180:183]
    ds_read_b64_tr_b16 a[244:245], v33 offset:16384
    v_xor_b32 v59, 0x1000, v58
    v_mfma_f32_16x16x32_bf16 v[184:187], a[192:195], a[148:151], v[184:187]
    ds_read_b64_tr_b16 a[246:247], v33 offset:20480
    v_bfe_u32 v56, v0, 2, 2
    v_mfma_f32_16x16x32_bf16 v[192:195], a[196:199], a[116:119], v[192:195]
    buffer_load_dwordx4 a[64:67], v10, s[40:43], s10 offen offset:0 sc1
    v_mfma_f32_16x16x32_bf16 v[196:199], a[196:199], a[132:135], v[196:199]
    ds_read_b64_tr_b16 a[248:249], v116 offset:16384
    v_lshrrev_b32 v57, 4, v0
    v_mfma_f32_16x16x32_bf16 v[200:203], a[196:199], a[148:151], v[200:203]
    ds_read_b64_tr_b16 a[250:251], v116 offset:20480
    v_xor_b32 v56, v56, v57
    v_mfma_f32_16x16x32_bf16 v[208:211], a[200:203], a[116:119], v[208:211]
    ds_read_b64_tr_b16 a[252:253], v116 offset:0
    v_add_u32 v56, -1, v56
    v_mfma_f32_16x16x32_bf16 v[212:215], a[200:203], a[132:135], v[212:215]
    buffer_load_dwordx4 a[80:83], v10, s[40:43], s10 offen offset:1024 sc1
    v_mfma_f32_16x16x32_bf16 v[216:219], a[200:203], a[148:151], v[216:219]
    s_waitcnt lgkmcnt(5)
    ds_read_b64_tr_b16 a[254:255], v116 offset:4096
    v_ashrrev_i32 v56, 31, v56
    v_mfma_f32_16x16x32_bf16 v[224:227], a[204:207], a[116:119], v[224:227]
    ds_read_b64_tr_b16 a[192:193], v34 offset:16384
    v_and_b32 v57, 1, v0
    v_mfma_f32_16x16x32_bf16 v[228:231], a[204:207], a[132:135], v[228:231]
    ds_read_b64_tr_b16 a[194:195], v34 offset:20480
    v_lshlrev_b32 v57, 4, v57
    v_mfma_f32_16x16x32_bf16 v[232:235], a[204:207], a[148:151], v[232:235]
    buffer_load_dwordx4 a[96:99], v11, s[40:43], s10 offen offset:0 sc1
    v_mfma_f32_16x16x32_bf16 v[240:243], a[208:211], a[116:119], v[240:243]
    ds_read_b64_tr_b16 a[196:197], v117 offset:16384
    v_and_b32 v56, 0x3f80, v56
    v_mfma_f32_16x16x32_bf16 v[244:247], a[208:211], a[132:135], v[244:247]
    ds_read_b64_tr_b16 a[198:199], v117 offset:20480
    v_lshlrev_b32 v56, v57, v56
    v_mfma_f32_16x16x32_bf16 v[248:251], a[208:211], a[148:151], v[248:251]
    s_waitcnt vmcnt(19)
    ds_read_b64_tr_b16 a[200:201], v117 offset:0
    v_bfe_i32 v57, v0, 1, 1
    v_mfma_f32_16x16x32_bf16 v[144:147], a[212:215], a[0:3], v[144:147]
    s_waitcnt vmcnt(15)
    buffer_load_dwordx4 a[108:111], v12, s[40:43], s10 offen offset:0 sc1
    v_mfma_f32_16x16x32_bf16 v[144:147], a[216:219], a[56:59], v[144:147]
    s_waitcnt vmcnt(13)
    ds_read_b64_tr_b16 a[202:203], v117 offset:4096
    v_and_b32 v70, v56, v57
    v_mfma_f32_16x16x32_bf16 v[144:147], a[220:223], a[112:115], v[144:147]
    ds_read_b64_tr_b16 a[204:205], v35 offset:16384
    v_xor_b32 v56, v56, v70
    v_mfma_f32_16x16x32_bf16 v[148:151], a[212:215], a[16:19], v[148:151]
    ds_read_b64_tr_b16 a[206:207], v35 offset:20480
    v_accvgpr_write_b32 a174, v56
    v_mfma_f32_16x16x32_bf16 v[148:151], a[216:219], a[72:75], v[148:151]
    s_waitcnt vmcnt(12)
    buffer_load_dwordx4 a[120:123], v10, s[40:43], s11 offen offset:0 sc1
    v_mfma_f32_16x16x32_bf16 v[148:151], a[220:223], a[128:131], v[148:151]
    ds_read_b64_tr_b16 a[208:209], v31 offset:49152
    v_accvgpr_write_b32 a175, v70
    v_mfma_f32_16x16x32_bf16 v[152:155], a[212:215], a[32:35], v[152:155]
    ds_read_b64_tr_b16 a[210:211], v31 offset:53248
    v_accvgpr_write_b32 a172, 0
    v_mfma_f32_16x16x32_bf16 v[152:155], a[216:219], a[88:91], v[152:155]
    s_waitcnt vmcnt(12)
    v_accvgpr_write_b32 a173, 0
    v_accvgpr_write_b32 a176, 0
    v_mfma_f32_16x16x32_bf16 v[152:155], a[220:223], a[144:147], v[152:155]
    s_waitcnt vmcnt(11)
    buffer_load_dwordx4 a[136:139], v10, s[40:43], s11 offen offset:1024 sc1
    v_mfma_f32_16x16x32_bf16 v[156:159], a[212:215], a[48:51], v[156:159]
    s_waitcnt vmcnt(11)
    ds_read_b64_tr_b16 a[212:213], v31 offset:0
    v_accvgpr_write_b32 a177, 0
    v_mfma_f32_16x16x32_bf16 v[156:159], a[216:219], a[104:107], v[156:159]
    s_waitcnt vmcnt(10)
    ds_read_b64_tr_b16 a[214:215], v31 offset:4096
    v_mfma_f32_16x16x32_bf16 v[156:159], a[220:223], a[160:163], v[156:159]
    s_waitcnt lgkmcnt(0)
    s_and_b32 s84, s84, s85
    s_and_b32 s84, s84, s86
    s_cbranch_scc0 L_pollc_first
L_pollc_ok:
    ds_read_b64_tr_b16 a[216:217], v31 offset:32768
    v_mfma_f32_16x16x32_bf16 v[160:163], a[224:227], a[0:3], v[160:163]
    buffer_load_dwordx4 a[152:155], v11, s[40:43], s11 offen offset:0 sc1
    v_mfma_f32_16x16x32_bf16 v[160:163], a[228:231], a[56:59], v[160:163]
    ds_read_b64_tr_b16 a[218:219], v31 offset:36864
    v_mfma_f32_16x16x32_bf16 v[160:163], a[232:235], a[112:115], v[160:163]
    ds_read_b64_tr_b16 a[220:221], v39 offset:49152
    v_mfma_f32_16x16x32_bf16 v[164:167], a[224:227], a[16:19], v[164:167]
    ds_read_b64_tr_b16 a[222:223], v39 offset:53248
    v_mfma_f32_16x16x32_bf16 v[164:167], a[228:231], a[72:75], v[164:167]
    buffer_load_dwordx4 a[164:167], v12, s[40:43], s11 offen offset:0 sc1
    v_mfma_f32_16x16x32_bf16 v[164:167], a[232:235], a[128:131], v[164:167]
    v_mfma_f32_16x16x32_bf16 v[168:171], a[224:227], a[32:35], v[168:171]
    v_mfma_f32_16x16x32_bf16 v[168:171], a[228:231], a[88:91], v[168:171]
    v_mfma_f32_16x16x32_bf16 v[168:171], a[232:235], a[144:147], v[168:171]
    buffer_load_dwordx4 a[12:15], v12, s[40:43], s9 offen offset:1024 sc1
    v_mfma_f32_16x16x32_bf16 v[172:175], a[224:227], a[48:51], v[172:175]
    ds_read_b64_tr_b16 a[224:225], v39 offset:0
    v_mfma_f32_16x16x32_bf16 v[172:175], a[228:231], a[104:107], v[172:175]
    ds_read_b64_tr_b16 a[226:227], v39 offset:4096
    v_mfma_f32_16x16x32_bf16 v[172:175], a[232:235], a[160:163], v[172:175]
    ds_read_b64_tr_b16 a[228:229], v39 offset:32768
    v_mfma_f32_16x16x32_bf16 v[176:179], a[236:239], a[0:3], v[176:179]
    buffer_load_dwordx4 a[28:31], v13, s[40:43], s9 offen offset:0 sc1
    v_mfma_f32_16x16x32_bf16 v[176:179], a[240:243], a[56:59], v[176:179]
    ds_read_b64_tr_b16 a[230:231], v39 offset:36864
    v_mfma_f32_16x16x32_bf16 v[176:179], a[244:247], a[112:115], v[176:179]
    ds_read_b64_tr_b16 a[232:233], v32 offset:49152
    v_mfma_f32_16x16x32_bf16 v[180:183], a[236:239], a[16:19], v[180:183]
    ds_read_b64_tr_b16 a[234:235], v32 offset:53248
    v_mfma_f32_16x16x32_bf16 v[180:183], a[240:243], a[72:75], v[180:183]
    buffer_load_dwordx4 a[44:47], v13, s[40:43], s9 offen offset:1024 sc1
    v_mfma_f32_16x16x32_bf16 v[180:183], a[244:247], a[128:131], v[180:183]
    v_mfma_f32_16x16x32_bf16 v[184:187], a[236:239], a[32:35], v[184:187]
    v_mfma_f32_16x16x32_bf16 v[184:187], a[240:243], a[88:91], v[184:187]
    v_mfma_f32_16x16x32_bf16 v[184:187], a[244:247], a[144:147], v[184:187]
    buffer_load_dwordx4 a[68:71], v12, s[40:43], s10 offen offset:1024 sc1
    v_mfma_f32_16x16x32_bf16 v[188:191], a[236:239], a[48:51], v[188:191]
    ds_read_b64_tr_b16 a[236:237], v32 offset:0
    v_mfma_f32_16x16x32_bf16 v[188:191], a[240:243], a[104:107], v[188:191]
    ds_read_b64_tr_b16 a[238:239], v32 offset:4096
    v_mfma_f32_16x16x32_bf16 v[188:191], a[244:247], a[160:163], v[188:191]
    ds_read_b64_tr_b16 a[240:241], v32 offset:32768
    v_mfma_f32_16x16x32_bf16 v[192:195], a[248:251], a[0:3], v[192:195]
    buffer_load_dwordx4 a[84:87], v13, s[40:43], s10 offen offset:0 sc1
    v_mfma_f32_16x16x32_bf16 v[192:195], a[252:255], a[56:59], v[192:195]
    ds_read_b64_tr_b16 a[242:243], v32 offset:36864
    v_mfma_f32_16x16x32_bf16 v[192:195], a[192:195], a[112:115], v[192:195]
    ds_read_b64_tr_b16 a[244:245], v40 offset:49152
    v_mfma_f32_16x16x32_bf16 v[196:199], a[248:251], a[16:19], v[196:199]
    ds_read_b64_tr_b16 a[246:247], v40 offset:53248
    v_mfma_f32_16x16x32_bf16 v[196:199], a[252:255], a[72:75], v[196:199]
    buffer_load_dwordx4 a[100:103], v13, s[40:43], s10 offen offset:1024 sc1
    v_mfma_f32_16x16x32_bf16 v[196:199], a[192:195], a[128:131], v[196:199]
    v_mfma_f32_16x16x32_bf16 v[200:203], a[248:251], a[32:35], v[200:203]
    v_mfma_f32_16x16x32_bf16 v[200:203], a[252:255], a[88:91], v[200:203]
    v_mfma_f32_16x16x32_bf16 v[200:203], a[192:195], a[144:147], v[200:203]
    buffer_load_dwordx4 a[124:127], v12, s[40:43], s11 offen offset:1024 sc1
    v_mfma_f32_16x16x32_bf16 v[204:207], a[248:251], a[48:51], v[204:207]
    ds_read_b64_tr_b16 a[248:249], v40 offset:0
    v_mfma_f32_16x16x32_bf16 v[204:207], a[252:255], a[104:107], v[204:207]
    ds_read_b64_tr_b16 a[250:251], v40 offset:4096
    v_mfma_f32_16x16x32_bf16 v[204:207], a[192:195], a[160:163], v[204:207]
    ds_read_b64_tr_b16 a[252:253], v40 offset:32768
    v_mfma_f32_16x16x32_bf16 v[208:211], a[196:199], a[0:3], v[208:211]
    buffer_load_dwordx4 a[140:143], v13, s[40:43], s11 offen offset:0 sc1
    v_mfma_f32_16x16x32_bf16 v[208:211], a[200:203], a[56:59], v[208:211]
    ds_read_b64_tr_b16 a[254:255], v40 offset:36864
    v_mfma_f32_16x16x32_bf16 v[208:211], a[204:207], a[112:115], v[208:211]
    ds_read_b64_tr_b16 a[192:193], v33 offset:49152
    v_mfma_f32_16x16x32_bf16 v[212:215], a[196:199], a[16:19], v[212:215]
    s_mov_b64 vcc, 0x6
    ds_read_b64_tr_b16 a[194:195], v33 offset:53248
    v_cndmask_b32 v2, v6, v20, vcc
    v_mfma_f32_16x16x32_bf16 v[212:215], a[200:203], a[72:75], v[212:215]
    buffer_load_dwordx4 a[156:159], v13, s[40:43], s11 offen offset:1024 sc1
    v_mfma_f32_16x16x32_bf16 v[212:215], a[204:207], a[128:131], v[212:215]
    s_mov_b64 vcc, 0x8
    v_cndmask_b32 v3, v6, v20, vcc
    v_mfma_f32_16x16x32_bf16 v[216:219], a[196:199], a[32:35], v[216:219]
    v_mfma_f32_16x16x32_bf16 v[216:219], a[200:203], a[88:91], v[216:219]
    s_mov_b64 vcc, 0x10
    v_cndmask_b32 v4, v6, v20, vcc
    v_mfma_f32_16x16x32_bf16 v[216:219], a[204:207], a[144:147], v[216:219]
    v_mfma_f32_16x16x32_bf16 v[220:223], a[196:199], a[48:51], v[220:223]
    s_mov_b64 vcc, 0x20
    ds_read_b64_tr_b16 a[196:197], v33 offset:0
    v_cndmask_b32 v54, v6, v20, vcc
    v_mfma_f32_16x16x32_bf16 v[220:223], a[200:203], a[104:107], v[220:223]
    ds_read_b64_tr_b16 a[198:199], v33 offset:4096
    v_mfma_f32_16x16x32_bf16 v[220:223], a[204:207], a[160:163], v[220:223]
    s_waitcnt vmcnt(17)
    ds_read_b64_tr_b16 a[200:201], v33 offset:32768
    v_mfma_f32_16x16x32_bf16 v[156:159], a[208:211], a[52:55], v[156:159]
    s_waitcnt vmcnt(13)
    ds_read_b64_tr_b16 a[202:203], v33 offset:36864
    v_mfma_f32_16x16x32_bf16 v[156:159], a[212:215], a[108:111], v[156:159]
    s_waitcnt vmcnt(9) lgkmcnt(4)
    ds_read_b64_tr_b16 a[204:205], v41 offset:49152
    v_mfma_f32_16x16x32_bf16 v[156:159], a[216:219], a[164:167], v[156:159]
    ds_read_b64_tr_b16 a[206:207], v41 offset:53248
    v_mfma_f32_16x16x32_bf16 v[144:147], a[208:211], a[8:11], v[144:147]
    v_mfma_f32_16x16x32_bf16 v[144:147], a[212:215], a[64:67], v[144:147]
    v_mfma_f32_16x16x32_bf16 v[144:147], a[216:219], a[120:123], v[144:147]
    v_mfma_f32_16x16x32_bf16 v[148:151], a[208:211], a[24:27], v[148:151]
    v_mfma_f32_16x16x32_bf16 v[148:151], a[212:215], a[80:83], v[148:151]
    s_nop 1
    ds_write_b128 v21, v[156:159] offset:1024
    v_mfma_f32_16x16x32_bf16 v[148:151], a[216:219], a[136:139], v[148:151]
    v_mfma_f32_16x16x32_bf16 v[152:155], a[208:211], a[40:43], v[152:155]
    v_mfma_f32_16x16x32_bf16 v[152:155], a[212:215], a[96:99], v[152:155]
    ds_read_b64_tr_b16 a[208:209], v41 offset:0
    v_mfma_f32_16x16x32_bf16 v[152:155], a[216:219], a[152:155], v[152:155]
    s_waitcnt vmcnt(8)
    ds_read_b64_tr_b16 a[210:211], v41 offset:4096
    v_mfma_f32_16x16x32_bf16 v[144:147], a[220:223], a[12:15], v[144:147]
    s_waitcnt vmcnt(5) lgkmcnt(2)
    ds_read_b64_tr_b16 a[212:213], v41 offset:32768
    v_mfma_f32_16x16x32_bf16 v[144:147], a[224:227], a[68:71], v[144:147]
    s_barrier
    ds_read_b128 v[76:79], v1 offset:1024
    s_waitcnt vmcnt(2)
    v_mfma_f32_16x16x32_bf16 v[144:147], a[228:231], a[124:127], v[144:147]
    ds_read_b64_tr_b16 a[214:215], v41 offset:36864
    v_mfma_f32_16x16x32_bf16 v[148:151], a[220:223], a[28:31], v[148:151]
    ds_read_b64_tr_b16 a[216:217], v34 offset:49152
    v_mfma_f32_16x16x32_bf16 v[148:151], a[224:227], a[84:87], v[148:151]
    s_waitcnt vmcnt(1)
    ds_read_b64_tr_b16 a[218:219], v34 offset:53248
    v_mfma_f32_16x16x32_bf16 v[148:151], a[228:231], a[140:143], v[148:151]
    v_mfma_f32_16x16x32_bf16 v[152:155], a[220:223], a[44:47], v[152:155]
    ds_read_b64_tr_b16 a[220:221], v34 offset:0
    v_mfma_f32_16x16x32_bf16 v[152:155], a[224:227], a[100:103], v[152:155]
    s_waitcnt vmcnt(0)
    ds_read_b64_tr_b16 a[222:223], v34 offset:4096
    v_cvt_pk_bf16_f32 v46, v144, v145
    v_mfma_f32_16x16x32_bf16 v[152:155], a[228:231], a[156:159], v[152:155]
    ds_read_b64_tr_b16 a[224:225], v34 offset:32768
    v_cvt_pk_bf16_f32 v47, v146, v147
    v_mfma_f32_16x16x32_bf16 v[172:175], a[232:235], a[52:55], v[172:175]
    s_waitcnt lgkmcnt(6)
    ds_read_b64_tr_b16 a[226:227], v34 offset:36864
    v_add_f32 v156, v156, v76
    v_mfma_f32_16x16x32_bf16 v[172:175], a[236:239], a[108:111], v[172:175]
    ds_read_b64_tr_b16 a[228:229], v42 offset:49152
    v_add_f32 v157, v157, v77
    v_mfma_f32_16x16x32_bf16 v[172:175], a[240:243], a[164:167], v[172:175]
    ds_read_b64_tr_b16 a[230:231], v42 offset:53248
    v_add_f32 v158, v158, v78
    v_mfma_f32_16x16x32_bf16 v[160:163], a[232:235], a[8:11], v[160:163]
    v_add_f32 v159, v159, v79
    v_cvt_pk_bf16_f32 v52, v156, v157
    v_mfma_f32_16x16x32_bf16 v[160:163], a[236:239], a[64:67], v[160:163]
    v_cvt_pk_bf16_f32 v53, v158, v159
    v_cvt_pk_bf16_f32 v48, v148, v149
    v_mfma_f32_16x16x32_bf16 v[160:163], a[240:243], a[120:123], v[160:163]
    v_cvt_pk_bf16_f32 v49, v150, v151
    v_cvt_pk_bf16_f32 v50, v152, v153
    v_mfma_f32_16x16x32_bf16 v[164:167], a[232:235], a[24:27], v[164:167]
    buffer_store_dwordx4 v[46:49], v18, s[40:43], s92 offen offset:0 sc1
    v_mfma_f32_16x16x32_bf16 v[164:167], a[236:239], a[80:83], v[164:167]
    ds_write_b128 v21, v[172:175] offset:2048
    v_cvt_pk_bf16_f32 v51, v154, v155
    v_mfma_f32_16x16x32_bf16 v[164:167], a[240:243], a[136:139], v[164:167]
    v_permlane16_swap_b32 v50, v52
    v_mfma_f32_16x16x32_bf16 v[168:171], a[232:235], a[40:43], v[168:171]
    v_permlane16_swap_b32 v51, v53
    v_mfma_f32_16x16x32_bf16 v[168:171], a[236:239], a[96:99], v[168:171]
    buffer_store_dwordx4 v[50:53], v60, s[40:43], s92 offen offset:1024 sc1
    v_mfma_f32_16x16x32_bf16 v[168:171], a[240:243], a[152:155], v[168:171]
    ds_read_b64_tr_b16 a[232:233], v42 offset:0
    v_mfma_f32_16x16x32_bf16 v[160:163], a[244:247], a[12:15], v[160:163]
    s_waitcnt lgkmcnt(1)
    ds_read_b64_tr_b16 a[234:235], v42 offset:4096
    v_mfma_f32_16x16x32_bf16 v[160:163], a[248:251], a[68:71], v[160:163]
    s_barrier
    ds_read_b128 v[80:83], v1 offset:2048
    v_mfma_f32_16x16x32_bf16 v[160:163], a[252:255], a[124:127], v[160:163]
    ds_read_b64_tr_b16 a[236:237], v42 offset:32768
    v_mfma_f32_16x16x32_bf16 v[164:167], a[244:247], a[28:31], v[164:167]
    ds_read_b64_tr_b16 a[238:239], v42 offset:36864
    v_mfma_f32_16x16x32_bf16 v[164:167], a[248:251], a[84:87], v[164:167]
    ds_read_b64_tr_b16 a[240:241], v35 offset:49152
    v_mfma_f32_16x16x32_bf16 v[164:167], a[252:255], a[140:143], v[164:167]
    ds_read_b64_tr_b16 a[242:243], v35 offset:53248
    v_mfma_f32_16x16x32_bf16 v[168:171], a[244:247], a[44:47], v[168:171]
    ds_read_b64_tr_b16 a[244:245], v35 offset:0
    v_mfma_f32_16x16x32_bf16 v[168:171], a[248:251], a[100:103], v[168:171]
    ds_read_b64_tr_b16 a[246:247], v35 offset:4096
    v_cvt_pk_bf16_f32 v22, v160, v161
    v_mfma_f32_16x16x32_bf16 v[168:171], a[252:255], a[156:159], v[168:171]
    ds_read_b64_tr_b16 a[248:249], v35 offset:32768
    v_cvt_pk_bf16_f32 v23, v162, v163
    v_mfma_f32_16x16x32_bf16 v[188:191], a[192:195], a[52:55], v[188:191]
    s_waitcnt lgkmcnt(7)
    ds_read_b64_tr_b16 a[250:251], v35 offset:36864
    v_add_f32 v172, v172, v80
    v_mfma_f32_16x16x32_bf16 v[188:191], a[196:199], a[108:111], v[188:191]
    ds_read_b64_tr_b16 a[252:253], v43 offset:49152
    v_add_f32 v173, v173, v81
    v_mfma_f32_16x16x32_bf16 v[188:191], a[200:203], a[164:167], v[188:191]
    ds_read_b64_tr_b16 a[254:255], v43 offset:53248
    v_add_f32 v174, v174, v82
    v_mfma_f32_16x16x32_bf16 v[176:179], a[192:195], a[8:11], v[176:179]
    v_add_f32 v175, v175, v83
    v_cvt_pk_bf16_f32 v28, v172, v173
    v_mfma_f32_16x16x32_bf16 v[176:179], a[196:199], a[64:67], v[176:179]
    v_cvt_pk_bf16_f32 v29, v174, v175
    v_cvt_pk_bf16_f32 v24, v164, v165
    v_mfma_f32_16x16x32_bf16 v[176:179], a[200:203], a[120:123], v[176:179]
L_pad8:
    s_cbranch_execz L_wret
    v_cvt_pk_bf16_f32 v25, v166, v167
    v_cvt_pk_bf16_f32 v26, v168, v169
    v_mfma_f32_16x16x32_bf16 v[180:183], a[192:195], a[24:27], v[180:183]
    buffer_store_dwordx4 v[22:25], v18, s[40:43], s93 offen offset:0 sc1
    v_mfma_f32_16x16x32_bf16 v[180:183], a[196:199], a[80:83], v[180:183]
    s_mul_i32 s55, s4, 224
    ds_write_b128 v21, v[188:191] offset:3072
    v_cvt_pk_bf16_f32 v27, v170, v171
    v_mfma_f32_16x16x32_bf16 v[180:183], a[200:203], a[136:139], v[180:183]
    s_lshr_b32 s56, s3, 1
    v_permlane16_swap_b32 v26, v28
    v_mfma_f32_16x16x32_bf16 v[184:187], a[192:195], a[40:43], v[184:187]
    v_permlane16_swap_b32 v27, v29
    v_mfma_f32_16x16x32_bf16 v[184:187], a[196:199], a[96:99], v[184:187]
    buffer_store_dwordx4 v[26:29], v60, s[40:43], s93 offen offset:1024 sc1
    v_mfma_f32_16x16x32_bf16 v[184:187], a[200:203], a[152:155], v[184:187]
    s_mul_i32 s56, s56, 112
    ds_read_b64_tr_b16 a[192:193], v43 offset:0
    v_mfma_f32_16x16x32_bf16 v[176:179], a[204:207], a[12:15], v[176:179]
    s_waitcnt lgkmcnt(1)
    ds_read_b64_tr_b16 a[194:195], v43 offset:4096
    v_mfma_f32_16x16x32_bf16 v[176:179], a[208:211], a[68:71], v[176:179]
    s_barrier
    ds_read_b128 v[84:87], v1 offset:3072
    v_mfma_f32_16x16x32_bf16 v[176:179], a[212:215], a[124:127], v[176:179]
    s_add_u32 s55, s55, s56
    ds_read_b64_tr_b16 a[196:197], v43 offset:32768
    v_mfma_f32_16x16x32_bf16 v[180:183], a[204:207], a[28:31], v[180:183]
    s_lshl_b32 s55, s55, 10
    ds_read_b64_tr_b16 a[198:199], v43 offset:36864
    v_mfma_f32_16x16x32_bf16 v[180:183], a[208:211], a[84:87], v[180:183]
    s_and_b32 s56, s13, 0x300
    ds_read_b64_tr_b16 a[200:201], v118 offset:16384
    v_mfma_f32_16x16x32_bf16 v[180:183], a[212:215], a[140:143], v[180:183]
    s_add_u32 s55, s55, s56
    ds_read_b64_tr_b16 a[202:203], v118 offset:20480
    v_mfma_f32_16x16x32_bf16 v[184:187], a[204:207], a[44:47], v[184:187]
    s_lshl_b32 s56, s6, 5
    ds_read_b64_tr_b16 a[204:205], v118 offset:0
    v_mfma_f32_16x16x32_bf16 v[184:187], a[208:211], a[100:103], v[184:187]
    s_waitcnt lgkmcnt(5)
    ds_read_b64_tr_b16 a[206:207], v118 offset:4096
    v_cvt_pk_bf16_f32 v104, v176, v177
    v_mfma_f32_16x16x32_bf16 v[184:187], a[212:215], a[156:159], v[184:187]
    s_add_u32 s55, s55, s56
    ds_read_b64_tr_b16 a[208:209], v36 offset:16384
    v_cvt_pk_bf16_f32 v105, v178, v179
    v_mfma_f32_16x16x32_bf16 v[204:207], a[216:219], a[52:55], v[204:207]
    s_lshl_b32 s56, s8, 16
    ds_read_b64_tr_b16 a[210:211], v36 offset:20480
    v_add_f32 v188, v188, v84
    v_mfma_f32_16x16x32_bf16 v[204:207], a[220:223], a[108:111], v[204:207]
    s_add_u32 s56, s56, s55
    ds_read_b64_tr_b16 a[212:213], v36 offset:49152
    v_add_f32 v189, v189, v85
    v_mfma_f32_16x16x32_bf16 v[204:207], a[224:227], a[164:167], v[204:207]
    s_add_u32 s57, s55, 32768
    ds_read_b64_tr_b16 a[214:215], v36 offset:53248
    v_add_f32 v190, v190, v86
    v_mfma_f32_16x16x32_bf16 v[192:195], a[216:219], a[8:11], v[192:195]
    v_add_f32 v191, v191, v87
    v_cvt_pk_bf16_f32 v110, v188, v189
    v_mfma_f32_16x16x32_bf16 v[192:195], a[220:223], a[64:67], v[192:195]
    v_cvt_pk_bf16_f32 v111, v190, v191
    v_cvt_pk_bf16_f32 v106, v180, v181
    v_mfma_f32_16x16x32_bf16 v[192:195], a[224:227], a[120:123], v[192:195]
    v_cvt_pk_bf16_f32 v107, v182, v183
    v_cvt_pk_bf16_f32 v108, v184, v185
    v_mfma_f32_16x16x32_bf16 v[196:199], a[216:219], a[24:27], v[196:199]
    buffer_store_dwordx4 v[104:107], v18, s[40:43], s94 offen offset:0 sc1
    v_mfma_f32_16x16x32_bf16 v[196:199], a[220:223], a[80:83], v[196:199]
    ds_write_b128 v21, v[204:207] offset:16384
    v_cvt_pk_bf16_f32 v109, v186, v187
    v_mfma_f32_16x16x32_bf16 v[196:199], a[224:227], a[136:139], v[196:199]
    v_permlane16_swap_b32 v108, v110
    v_mfma_f32_16x16x32_bf16 v[200:203], a[216:219], a[40:43], v[200:203]
    v_permlane16_swap_b32 v109, v111
    v_mfma_f32_16x16x32_bf16 v[200:203], a[220:223], a[96:99], v[200:203]
    buffer_store_dwordx4 v[108:111], v60, s[40:43], s94 offen offset:1024 sc1
    v_mfma_f32_16x16x32_bf16 v[200:203], a[224:227], a[152:155], v[200:203]
    ds_read_b64_tr_b16 a[216:217], v36 offset:0
    v_mfma_f32_16x16x32_bf16 v[192:195], a[228:231], a[12:15], v[192:195]
    s_waitcnt lgkmcnt(1)
    ds_read_b64_tr_b16 a[218:219], v36 offset:4096
    v_mfma_f32_16x16x32_bf16 v[192:195], a[232:235], a[68:71], v[192:195]
    s_barrier
    ds_read_b128 v[88:91], v1 offset:16384
    v_mfma_f32_16x16x32_bf16 v[192:195], a[236:239], a[124:127], v[192:195]
    ds_read_b64_tr_b16 a[220:221], v36 offset:32768
    v_mfma_f32_16x16x32_bf16 v[196:199], a[228:231], a[28:31], v[196:199]
    ds_read_b64_tr_b16 a[222:223], v36 offset:36864
    v_mfma_f32_16x16x32_bf16 v[196:199], a[232:235], a[84:87], v[196:199]
    ds_read_b64_tr_b16 a[224:225], v44 offset:49152
    v_mfma_f32_16x16x32_bf16 v[196:199], a[236:239], a[140:143], v[196:199]
    ds_read_b64_tr_b16 a[226:227], v44 offset:53248
    v_mfma_f32_16x16x32_bf16 v[200:203], a[228:231], a[44:47], v[200:203]
    ds_read_b64_tr_b16 a[228:229], v44 offset:0
    v_mfma_f32_16x16x32_bf16 v[200:203], a[232:235], a[100:103], v[200:203]
    ds_read_b64_tr_b16 a[230:231], v44 offset:4096
    v_cvt_pk_bf16_f32 v46, v192, v193
    v_mfma_f32_16x16x32_bf16 v[200:203], a[236:239], a[156:159], v[200:203]
    ds_read_b64_tr_b16 a[232:233], v44 offset:32768
    v_cvt_pk_bf16_f32 v47, v194, v195
    v_mfma_f32_16x16x32_bf16 v[220:223], a[240:243], a[52:55], v[220:223]
    s_waitcnt lgkmcnt(7)
    ds_read_b64_tr_b16 a[234:235], v44 offset:36864
    v_add_f32 v204, v204, v88
    v_mfma_f32_16x16x32_bf16 v[220:223], a[244:247], a[108:111], v[220:223]
    ds_read_b64_tr_b16 a[236:237], v119 offset:16384
    v_add_f32 v205, v205, v89
    v_mfma_f32_16x16x32_bf16 v[220:223], a[248:251], a[164:167], v[220:223]
    ds_read_b64_tr_b16 a[238:239], v119 offset:20480
    v_add_f32 v206, v206, v90
    v_mfma_f32_16x16x32_bf16 v[208:211], a[240:243], a[8:11], v[208:211]
    v_add_f32 v207, v207, v91
    v_cvt_pk_bf16_f32 v52, v204, v205
    v_mfma_f32_16x16x32_bf16 v[208:211], a[244:247], a[64:67], v[208:211]
    v_cvt_pk_bf16_f32 v53, v206, v207
    v_cvt_pk_bf16_f32 v48, v196, v197
    v_mfma_f32_16x16x32_bf16 v[208:211], a[248:251], a[120:123], v[208:211]
    v_cvt_pk_bf16_f32 v49, v198, v199
    v_cvt_pk_bf16_f32 v50, v200, v201
    v_mfma_f32_16x16x32_bf16 v[212:215], a[240:243], a[24:27], v[212:215]
    buffer_store_dwordx4 v[46:49], v18, s[40:43], s95 offen offset:0 sc1
    v_mfma_f32_16x16x32_bf16 v[212:215], a[244:247], a[80:83], v[212:215]
    ds_write_b128 v21, v[220:223] offset:17408
    v_cvt_pk_bf16_f32 v51, v202, v203
    v_mfma_f32_16x16x32_bf16 v[212:215], a[248:251], a[136:139], v[212:215]
    v_permlane16_swap_b32 v50, v52
    v_mfma_f32_16x16x32_bf16 v[216:219], a[240:243], a[40:43], v[216:219]
    v_permlane16_swap_b32 v51, v53
    v_mfma_f32_16x16x32_bf16 v[216:219], a[244:247], a[96:99], v[216:219]
    buffer_store_dwordx4 v[50:53], v60, s[40:43], s95 offen offset:1024 sc1
    v_mfma_f32_16x16x32_bf16 v[216:219], a[248:251], a[152:155], v[216:219]
    ds_read_b64_tr_b16 a[240:241], v119 offset:0
    v_mfma_f32_16x16x32_bf16 v[208:211], a[252:255], a[12:15], v[208:211]
    s_waitcnt lgkmcnt(1)
    ds_read_b64_tr_b16 a[242:243], v119 offset:4096
    v_mfma_f32_16x16x32_bf16 v[208:211], a[192:195], a[68:71], v[208:211]
    s_barrier
    ds_read_b128 v[92:95], v1 offset:17408
    v_mfma_f32_16x16x32_bf16 v[208:211], a[196:199], a[124:127], v[208:211]
    ds_read_b64_tr_b16 a[244:245], v37 offset:16384
    v_mfma_f32_16x16x32_bf16 v[212:215], a[252:255], a[28:31], v[212:215]
    ds_read_b64_tr_b16 a[246:247], v37 offset:20480
    v_mfma_f32_16x16x32_bf16 v[212:215], a[192:195], a[84:87], v[212:215]
    s_waitcnt vmcnt(4)
    ds_read_b64_tr_b16 a[248:249], v37 offset:49152
    v_mfma_f32_16x16x32_bf16 v[212:215], a[196:199], a[140:143], v[212:215]
L_fx336:
    buffer_store_dword v7, v2, s[40:43], 0 offen sc1
    v_mfma_f32_16x16x32_bf16 v[216:219], a[252:255], a[44:47], v[216:219]
    ds_read_b64_tr_b16 a[250:251], v37 offset:53248
    v_mfma_f32_16x16x32_bf16 v[216:219], a[192:195], a[100:103], v[216:219]
    ds_read_b64_tr_b16 a[252:253], v37 offset:0
    v_cvt_pk_bf16_f32 v22, v208, v209
    v_mfma_f32_16x16x32_bf16 v[216:219], a[196:199], a[156:159], v[216:219]
    ds_read_b64_tr_b16 a[254:255], v37 offset:4096
    v_cvt_pk_bf16_f32 v23, v210, v211
    v_mfma_f32_16x16x32_bf16 v[224:227], a[200:203], a[0:3], v[224:227]
    s_waitcnt lgkmcnt(6)
    ds_read_b64_tr_b16 a[192:193], v37 offset:32768
    v_add_f32 v220, v220, v92
    v_mfma_f32_16x16x32_bf16 v[224:227], a[204:207], a[56:59], v[224:227]
    ds_read_b64_tr_b16 a[194:195], v37 offset:36864
    v_add_f32 v221, v221, v93
    v_mfma_f32_16x16x32_bf16 v[224:227], a[208:211], a[112:115], v[224:227]
    ds_read_b64_tr_b16 a[196:197], v45 offset:49152
    v_add_f32 v222, v222, v94
    v_mfma_f32_16x16x32_bf16 v[228:231], a[200:203], a[16:19], v[228:231]
    ds_read_b64_tr_b16 a[198:199], v45 offset:53248
    v_add_f32 v223, v223, v95
    v_mfma_f32_16x16x32_bf16 v[228:231], a[204:207], a[72:75], v[228:231]
    v_cvt_pk_bf16_f32 v28, v220, v221
    v_cvt_pk_bf16_f32 v29, v222, v223
    v_mfma_f32_16x16x32_bf16 v[228:231], a[208:211], a[128:131], v[228:231]
    v_cvt_pk_bf16_f32 v24, v212, v213
    v_cvt_pk_bf16_f32 v25, v214, v215
    v_mfma_f32_16x16x32_bf16 v[232:235], a[200:203], a[32:35], v[232:235]
    buffer_store_dwordx4 v[22:25], v18, s[40:43], s96 offen offset:0 sc1
    v_mfma_f32_16x16x32_bf16 v[232:235], a[204:207], a[88:91], v[232:235]
    v_cvt_pk_bf16_f32 v26, v216, v217
    v_cvt_pk_bf16_f32 v27, v218, v219
    v_mfma_f32_16x16x32_bf16 v[232:235], a[208:211], a[144:147], v[232:235]
    v_permlane16_swap_b32 v26, v28
    v_mfma_f32_16x16x32_bf16 v[236:239], a[200:203], a[48:51], v[236:239]
    v_permlane16_swap_b32 v27, v29
    v_mfma_f32_16x16x32_bf16 v[236:239], a[204:207], a[104:107], v[236:239]
    buffer_store_dwordx4 v[26:29], v60, s[40:43], s96 offen offset:1024 sc1
    v_mfma_f32_16x16x32_bf16 v[236:239], a[208:211], a[160:163], v[236:239]
    ds_read_b64_tr_b16 a[200:201], v45 offset:0
    v_mfma_f32_16x16x32_bf16 v[236:239], a[212:215], a[52:55], v[236:239]
    ds_read_b64_tr_b16 a[202:203], v45 offset:4096
    v_mfma_f32_16x16x32_bf16 v[236:239], a[216:219], a[108:111], v[236:239]
    ds_read_b64_tr_b16 a[204:205], v45 offset:32768
    v_mfma_f32_16x16x32_bf16 v[236:239], a[220:223], a[164:167], v[236:239]
    ds_read_b64_tr_b16 a[206:207], v45 offset:36864
    v_mfma_f32_16x16x32_bf16 v[224:227], a[212:215], a[8:11], v[224:227]
    ds_read_b64_tr_b16 a[208:209], v120 offset:16384
    v_mfma_f32_16x16x32_bf16 v[224:227], a[216:219], a[64:67], v[224:227]
    ds_read_b64_tr_b16 a[210:211], v120 offset:20480
    v_mfma_f32_16x16x32_bf16 v[224:227], a[220:223], a[120:123], v[224:227]
    v_mfma_f32_16x16x32_bf16 v[228:231], a[212:215], a[24:27], v[228:231]
    v_mfma_f32_16x16x32_bf16 v[228:231], a[216:219], a[80:83], v[228:231]
    ds_write_b128 v21, v[236:239] offset:18432
    v_mfma_f32_16x16x32_bf16 v[228:231], a[220:223], a[136:139], v[228:231]
    v_mfma_f32_16x16x32_bf16 v[232:235], a[212:215], a[40:43], v[232:235]
    v_mfma_f32_16x16x32_bf16 v[232:235], a[216:219], a[96:99], v[232:235]
    ds_read_b64_tr_b16 a[212:213], v120 offset:0
    v_mfma_f32_16x16x32_bf16 v[232:235], a[220:223], a[152:155], v[232:235]
    ds_read_b64_tr_b16 a[214:215], v120 offset:4096
    v_mfma_f32_16x16x32_bf16 v[224:227], a[224:227], a[12:15], v[224:227]
    s_waitcnt lgkmcnt(2)
    ds_read_b64_tr_b16 a[216:217], v38 offset:16384
    v_mfma_f32_16x16x32_bf16 v[224:227], a[228:231], a[68:71], v[224:227]
    s_barrier
    ds_read_b128 v[96:99], v1 offset:18432
    v_mfma_f32_16x16x32_bf16 v[224:227], a[232:235], a[124:127], v[224:227]
    ds_read_b64_tr_b16 a[218:219], v38 offset:20480
    v_mfma_f32_16x16x32_bf16 v[228:231], a[224:227], a[28:31], v[228:231]
    ds_read_b64_tr_b16 a[220:221], v112 offset:16384
    v_mfma_f32_16x16x32_bf16 v[228:231], a[228:231], a[84:87], v[228:231]
    s_waitcnt vmcnt(5)
    ds_read_b64_tr_b16 a[222:223], v112 offset:20480
    v_mfma_f32_16x16x32_bf16 v[228:231], a[232:235], a[140:143], v[228:231]
L_fx369:
    buffer_store_dword v7, v3, s[40:43], 0 offen sc1
    v_mfma_f32_16x16x32_bf16 v[232:235], a[224:227], a[44:47], v[232:235]
    ds_read_b64_tr_b16 a[224:225], v112 offset:0
    v_mfma_f32_16x16x32_bf16 v[232:235], a[228:231], a[100:103], v[232:235]
    ds_read_b64_tr_b16 a[226:227], v112 offset:4096
    v_cvt_pk_bf16_f32 v104, v224, v225
    v_mfma_f32_16x16x32_bf16 v[232:235], a[232:235], a[156:159], v[232:235]
    ds_read_b64_tr_b16 a[228:229], v30 offset:16384
    v_cvt_pk_bf16_f32 v105, v226, v227
    v_mfma_f32_16x16x32_bf16 v[240:243], a[236:239], a[0:3], v[240:243]
    s_waitcnt lgkmcnt(6)
    ds_read_b64_tr_b16 a[230:231], v30 offset:20480
    v_add_f32 v236, v236, v96
    v_mfma_f32_16x16x32_bf16 v[240:243], a[240:243], a[56:59], v[240:243]
    ds_read_b64_tr_b16 a[232:233], v30 offset:49152
    v_add_f32 v237, v237, v97
    v_mfma_f32_16x16x32_bf16 v[240:243], a[244:247], a[112:115], v[240:243]
    ds_read_b64_tr_b16 a[234:235], v30 offset:53248
    v_add_f32 v238, v238, v98
    v_mfma_f32_16x16x32_bf16 v[244:247], a[236:239], a[16:19], v[244:247]
    v_add_f32 v239, v239, v99
    v_cvt_pk_bf16_f32 v110, v236, v237
    v_mfma_f32_16x16x32_bf16 v[244:247], a[240:243], a[72:75], v[244:247]
    v_cvt_pk_bf16_f32 v111, v238, v239
    v_cvt_pk_bf16_f32 v106, v228, v229
    v_mfma_f32_16x16x32_bf16 v[244:247], a[244:247], a[128:131], v[244:247]
    v_cvt_pk_bf16_f32 v107, v230, v231
    v_cvt_pk_bf16_f32 v108, v232, v233
    v_mfma_f32_16x16x32_bf16 v[248:251], a[236:239], a[32:35], v[248:251]
    buffer_store_dwordx4 v[104:107], v18, s[40:43], s97 offen offset:0 sc1
    v_mfma_f32_16x16x32_bf16 v[248:251], a[240:243], a[88:91], v[248:251]
    v_cvt_pk_bf16_f32 v109, v234, v235
    v_mfma_f32_16x16x32_bf16 v[248:251], a[244:247], a[144:147], v[248:251]
    v_permlane16_swap_b32 v108, v110
    v_mfma_f32_16x16x32_bf16 v[252:255], a[236:239], a[48:51], v[252:255]
    v_permlane16_swap_b32 v109, v111
    v_mfma_f32_16x16x32_bf16 v[252:255], a[240:243], a[104:107], v[252:255]
    buffer_store_dwordx4 v[108:111], v60, s[40:43], s97 offen offset:1024 sc1
    v_mfma_f32_16x16x32_bf16 v[252:255], a[244:247], a[160:163], v[252:255]
    ds_read_b64_tr_b16 a[236:237], v30 offset:0
    v_mfma_f32_16x16x32_bf16 v[252:255], a[248:251], a[52:55], v[252:255]
    ds_read_b64_tr_b16 a[238:239], v30 offset:4096
    v_mfma_f32_16x16x32_bf16 v[252:255], a[252:255], a[108:111], v[252:255]
    ds_read_b64_tr_b16 a[240:241], v30 offset:32768
    v_mfma_f32_16x16x32_bf16 v[252:255], a[192:195], a[164:167], v[252:255]
    ds_read_b64_tr_b16 a[242:243], v30 offset:36864
    v_mfma_f32_16x16x32_bf16 v[240:243], a[248:251], a[8:11], v[240:243]
    ds_read_b64_tr_b16 a[244:245], v38 offset:49152
    v_mfma_f32_16x16x32_bf16 v[240:243], a[252:255], a[64:67], v[240:243]
    ds_read_b64_tr_b16 a[246:247], v38 offset:53248
    v_mfma_f32_16x16x32_bf16 v[240:243], a[192:195], a[120:123], v[240:243]
    v_mfma_f32_16x16x32_bf16 v[244:247], a[248:251], a[24:27], v[244:247]
    v_mfma_f32_16x16x32_bf16 v[244:247], a[252:255], a[80:83], v[244:247]
    ds_write_b128 v21, v[252:255] offset:19456
    v_mfma_f32_16x16x32_bf16 v[244:247], a[192:195], a[136:139], v[244:247]
    v_mfma_f32_16x16x32_bf16 v[248:251], a[248:251], a[40:43], v[248:251]
    v_mfma_f32_16x16x32_bf16 v[248:251], a[252:255], a[96:99], v[248:251]
    ds_read_b64_tr_b16 a[248:249], v38 offset:0
    v_mfma_f32_16x16x32_bf16 v[248:251], a[192:195], a[152:155], v[248:251]
    ds_read_b64_tr_b16 a[250:251], v38 offset:4096
    v_mfma_f32_16x16x32_bf16 v[240:243], a[196:199], a[12:15], v[240:243]
    s_waitcnt lgkmcnt(2)
    ds_read_b64_tr_b16 a[252:253], v38 offset:32768
    v_mfma_f32_16x16x32_bf16 v[240:243], a[200:203], a[68:71], v[240:243]
    s_barrier
    ds_read_b128 v[100:103], v1 offset:19456
    v_mfma_f32_16x16x32_bf16 v[240:243], a[204:207], a[124:127], v[240:243]
    ds_read_b64_tr_b16 a[254:255], v38 offset:36864
    v_mfma_f32_16x16x32_bf16 v[244:247], a[196:199], a[28:31], v[244:247]
    v_mfma_f32_16x16x32_bf16 v[244:247], a[200:203], a[84:87], v[244:247]
    s_waitcnt vmcnt(6)
    v_mfma_f32_16x16x32_bf16 v[244:247], a[204:207], a[140:143], v[244:247]
L_fx402:
    buffer_store_dword v7, v4, s[40:43], 0 offen sc1
    v_mfma_f32_16x16x32_bf16 v[248:251], a[196:199], a[44:47], v[248:251]
    v_mfma_f32_16x16x32_bf16 v[248:251], a[200:203], a[100:103], v[248:251]
    v_cvt_pk_bf16_f32 v46, v240, v241
    v_cvt_pk_bf16_f32 v47, v242, v243
    v_mfma_f32_16x16x32_bf16 v[248:251], a[204:207], a[156:159], v[248:251]
    s_waitcnt lgkmcnt(1)
    v_add_f32 v252, v252, v100
    v_add_f32 v253, v253, v101
    v_mfma_f32_16x16x32_bf16 v[128:131], a[208:211], a[4:7], v[128:131]
    v_add_f32 v254, v254, v102
    v_add_f32 v255, v255, v103
    v_mfma_f32_16x16x32_bf16 v[128:131], a[212:215], a[60:63], v[128:131]
    v_cvt_pk_bf16_f32 v52, v252, v253
    v_cvt_pk_bf16_f32 v53, v254, v255
    v_mfma_f32_16x16x32_bf16 v[128:131], a[216:219], a[116:119], v[128:131]
    v_cvt_pk_bf16_f32 v48, v244, v245
    v_cvt_pk_bf16_f32 v49, v246, v247
    v_mfma_f32_16x16x32_bf16 v[132:135], a[208:211], a[20:23], v[132:135]
    buffer_store_dwordx4 v[46:49], v18, s[40:43], s98 offen offset:0 sc1
    v_mfma_f32_16x16x32_bf16 v[132:135], a[212:215], a[76:79], v[132:135]
    v_cvt_pk_bf16_f32 v50, v248, v249
    v_cvt_pk_bf16_f32 v51, v250, v251
    v_mfma_f32_16x16x32_bf16 v[132:135], a[216:219], a[132:135], v[132:135]
    v_mfma_f32_16x16x32_bf16 v[136:139], a[208:211], a[36:39], v[136:139]
    v_permlane16_swap_b32 v50, v52
    v_mfma_f32_16x16x32_bf16 v[136:139], a[212:215], a[92:95], v[136:139]
    v_permlane16_swap_b32 v51, v53
    v_mfma_f32_16x16x32_bf16 v[136:139], a[216:219], a[148:151], v[136:139]
    buffer_store_dwordx4 v[50:53], v60, s[40:43], s98 offen offset:1024 sc1
    v_mfma_f32_16x16x32_bf16 v[128:131], a[220:223], a[0:3], v[128:131]
    v_mfma_f32_16x16x32_bf16 v[128:131], a[224:227], a[56:59], v[128:131]
    v_mfma_f32_16x16x32_bf16 v[128:131], a[228:231], a[112:115], v[128:131]
    v_mfma_f32_16x16x32_bf16 v[132:135], a[220:223], a[16:19], v[132:135]
    s_buffer_load_dword s89, s[40:43], s61 offset:128 glc
    v_mfma_f32_16x16x32_bf16 v[132:135], a[224:227], a[72:75], v[132:135]
    s_buffer_load_dword s90, s[40:43], s61 offset:256 glc
    v_mfma_f32_16x16x32_bf16 v[132:135], a[228:231], a[128:131], v[132:135]
    v_mfma_f32_16x16x32_bf16 v[136:139], a[220:223], a[32:35], v[136:139]
    v_mfma_f32_16x16x32_bf16 v[136:139], a[224:227], a[88:91], v[136:139]
    v_mfma_f32_16x16x32_bf16 v[136:139], a[228:231], a[144:147], v[136:139]
    v_mfma_f32_16x16x32_bf16 v[140:143], a[220:223], a[48:51], v[140:143]
    v_mfma_f32_16x16x32_bf16 v[140:143], a[224:227], a[104:107], v[140:143]
    v_mfma_f32_16x16x32_bf16 v[140:143], a[228:231], a[160:163], v[140:143]
    v_mfma_f32_16x16x32_bf16 v[140:143], a[232:235], a[52:55], v[140:143]
    v_mfma_f32_16x16x32_bf16 v[140:143], a[236:239], a[108:111], v[140:143]
    v_mfma_f32_16x16x32_bf16 v[140:143], a[240:243], a[164:167], v[140:143]
    v_mfma_f32_16x16x32_bf16 v[128:131], a[232:235], a[8:11], v[128:131]
    v_mfma_f32_16x16x32_bf16 v[128:131], a[236:239], a[64:67], v[128:131]
    v_mfma_f32_16x16x32_bf16 v[128:131], a[240:243], a[120:123], v[128:131]
    v_mfma_f32_16x16x32_bf16 v[132:135], a[232:235], a[24:27], v[132:135]
    v_mfma_f32_16x16x32_bf16 v[132:135], a[236:239], a[80:83], v[132:135]
    s_nop 2
    ds_write_b128 v58, v[140:143] offset:0
    v_mfma_f32_16x16x32_bf16 v[132:135], a[240:243], a[136:139], v[132:135]
    s_waitcnt vmcnt(6)
    v_mfma_f32_16x16x32_bf16 v[136:139], a[232:235], a[40:43], v[136:139]
L_fx436:
    buffer_store_dword v7, v54, s[40:43], 0 offen sc1
    v_mfma_f32_16x16x32_bf16 v[136:139], a[236:239], a[96:99], v[136:139]
    v_mfma_f32_16x16x32_bf16 v[136:139], a[240:243], a[152:155], v[136:139]
    v_mfma_f32_16x16x32_bf16 v[128:131], a[244:247], a[12:15], v[128:131]
    v_mfma_f32_16x16x32_bf16 v[128:131], a[248:251], a[68:71], v[128:131]
    s_waitcnt lgkmcnt(1)
    v_mfma_f32_16x16x32_bf16 v[128:131], a[252:255], a[124:127], v[128:131]
    v_mfma_f32_16x16x32_bf16 v[132:135], a[244:247], a[28:31], v[132:135]
    v_mfma_f32_16x16x32_bf16 v[132:135], a[248:251], a[84:87], v[132:135]
    v_mfma_f32_16x16x32_bf16 v[132:135], a[252:255], a[140:143], v[132:135]
    v_mfma_f32_16x16x32_bf16 v[136:139], a[244:247], a[44:47], v[136:139]
    v_mfma_f32_16x16x32_bf16 v[136:139], a[248:251], a[100:103], v[136:139]
    v_mfma_f32_16x16x32_bf16 v[136:139], a[252:255], a[156:159], v[136:139]
L_collect:
    s_waitcnt lgkmcnt(0)
    s_barrier
    ds_read_b128 v[72:75], v59 offset:0
    s_cmp_eq_u32 s89, 0
    s_cbranch_scc1 L_f1_pub
L_f1_ok:
    buffer_load_dwordx4 v[144:147], v18, s[40:43], s14 offen offset:0 sc1
    buffer_load_dwordx4 v[148:151], v60, s[40:43], s14 offen offset:1024 sc1
    s_cmp_eq_u32 s90, 0
    s_cbranch_scc1 L_f2_pub
L_f2_ok:
    buffer_load_dwordx4 v[160:163], v8, s[40:43], s14 offen offset:0 sc1
    buffer_load_dwordx4 v[164:167], v61, s[40:43], s14 offen offset:1024 sc1
    s_waitcnt vmcnt(8)
    s_mov_b64 exec, 0x40
    buffer_store_dword v7, v20, s[40:43], 0 offen sc1
    s_mov_b64 exec, -1
    s_buffer_load_dword s91, s[40:43], s61 offset:384 glc
    s_buffer_load_dword s92, s[40:43], s61 offset:512 glc
    s_buffer_load_dword s93, s[40:43], s61 offset:640 glc
    s_buffer_load_dword s94, s[40:43], s61 offset:768 glc
    s_buffer_load_dword s95, s[40:43], s61 offset:896 glc
    s_waitcnt vmcnt(6)
    s_mov_b64 exec, 0x80
    buffer_store_dword v7, v20, s[40:43], 0 offen sc1
    s_mov_b64 exec, -1
    s_waitcnt lgkmcnt(0)
    s_cmp_eq_u32 s91, 0
    s_cbranch_scc1 L_f3_spin
L_f3_ok:
    buffer_load_dwordx4 v[176:179], v9, s[40:43], s14 offen offset:0 sc1
    buffer_load_dwordx4 v[180:183], v62, s[40:43], s14 offen offset:1024 sc1
    s_cmp_eq_u32 s92, 0
    s_cbranch_scc1 L_f4_spin
L_f4_ok:
    buffer_load_dwordx4 v[192:195], v10, s[40:43], s14 offen offset:0 sc1
    buffer_load_dwordx4 v[196:199], v63, s[40:43], s14 offen offset:1024 sc1
    s_cmp_eq_u32 s93, 0
    s_cbranch_scc1 L_f5_spin
L_f5_ok:
    buffer_load_dwordx4 v[208:211], v11, s[40:43], s14 offen offset:0 sc1
    buffer_load_dwordx4 v[212:215], v64, s[40:43], s14 offen offset:1024 sc1
    v_add_f32 v140, v140, v72
    v_add_f32 v141, v141, v73
    v_add_f32 v142, v142, v74
    v_add_f32 v143, v143, v75
    s_nop 0
    v_permlane16_swap_b32 v136, v140
    v_permlane16_swap_b32 v137, v141
    v_permlane16_swap_b32 v138, v142
    v_permlane16_swap_b32 v139, v143
    s_mov_b32 s55, 6
    s_waitcnt lgkmcnt(0)
    s_cmp_lg_u32 s55, 6
    s_cbranch_scc1 L_try1_6
    s_cmp_eq_u32 s94, 0
    s_cbranch_scc1 L_try1_6
    buffer_load_dwordx4 v[224:227], v12, s[40:43], s14 offen offset:0 sc1
    buffer_load_dwordx4 v[228:231], v65, s[40:43], s14 offen offset:1024 sc1
    s_add_u32 s55, s55, 1
L_try1_6:
    s_cmp_lg_u32 s55, 7
    s_cbranch_scc1 L_try1_7
    s_cmp_eq_u32 s95, 0
    s_cbranch_scc1 L_try1_7
    buffer_load_dwordx4 v[240:243], v13, s[40:43], s14 offen offset:0 sc1
    buffer_load_dwordx4 v[244:247], v66, s[40:43], s14 offen offset:1024 sc1
    s_add_u32 s55, s55, 1
L_try1_7:
    s_waitcnt vmcnt(11)
    v_mfma_f32_16x16x32_bf16 v[128:131], a[174:177], v[144:147], v[128:131]
    v_mfma_f32_16x16x32_bf16 v[132:135], a[172:175], v[144:147], v[132:135]
    s_waitcnt vmcnt(10)
    v_mfma_f32_16x16x32_bf16 v[136:139], a[174:177], v[148:151], v[136:139]
    v_mfma_f32_16x16x32_bf16 v[140:143], a[172:175], v[148:151], v[140:143]
    s_cmp_gt_u32 s55, 7
    s_cbranch_scc1 L_nopoll2
    s_buffer_load_dword s94, s[40:43], s61 offset:768 glc
    s_buffer_load_dword s95, s[40:43], s61 offset:896 glc
L_nopoll2:
    s_waitcnt vmcnt(9)
    v_mfma_f32_16x16x32_bf16 v[128:131], a[174:177], v[160:163], v[128:131]
    v_mfma_f32_16x16x32_bf16 v[132:135], a[172:175], v[160:163], v[132:135]
    s_waitcnt vmcnt(8)
    v_mfma_f32_16x16x32_bf16 v[136:139], a[174:177], v[164:167], v[136:139]
    v_mfma_f32_16x16x32_bf16 v[140:143], a[172:175], v[164:167], v[140:143]
    s_waitcnt lgkmcnt(0)
    s_cmp_lg_u32 s55, 6
    s_cbranch_scc1 L_try2_6
    s_cmp_eq_u32 s94, 0
    s_cbranch_scc1 L_try2_6
    buffer_load_dwordx4 v[224:227], v12, s[40:43], s14 offen offset:0 sc1
    buffer_load_dwordx4 v[228:231], v65, s[40:43], s14 offen offset:1024 sc1
    s_add_u32 s55, s55, 1
L_try2_6:
    s_cmp_lg_u32 s55, 7
    s_cbranch_scc1 L_try2_7
    s_cmp_eq_u32 s95, 0
    s_cbranch_scc1 L_try2_7
    buffer_load_dwordx4 v[240:243], v13, s[40:43], s14 offen offset:0 sc1
    buffer_load_dwordx4 v[244:247], v66, s[40:43], s14 offen offset:1024 sc1
    s_add_u32 s55, s55, 1
L_try2_7:
    s_waitcnt vmcnt(5)
    v_mfma_f32_16x16x32_bf16 v[128:131], a[174:177], v[176:179], v[128:131]
    v_mfma_f32_16x16x32_bf16 v[132:135], a[172:175], v[176:179], v[132:135]
    s_waitcnt vmcnt(4)
    v_mfma_f32_16x16x32_bf16 v[136:139], a[174:177], v[180:183], v[136:139]
    v_mfma_f32_16x16x32_bf16 v[140:143], a[172:175], v[180:183], v[140:143]
    s_waitcnt vmcnt(3)
    v_mfma_f32_16x16x32_bf16 v[128:131], a[174:177], v[192:195], v[128:131]
    v_mfma_f32_16x16x32_bf16 v[132:135], a[172:175], v[192:195], v[132:135]
    s_waitcnt vmcnt(2)
    v_mfma_f32_16x16x32_bf16 v[136:139], a[174:177], v[196:199], v[136:139]
    v_mfma_f32_16x16x32_bf16 v[140:143], a[172:175], v[196:199], v[140:143]
    s_waitcnt vmcnt(1)
    v_mfma_f32_16x16x32_bf16 v[128:131], a[174:177], v[208:211], v[128:131]
    v_mfma_f32_16x16x32_bf16 v[132:135], a[172:175], v[208:211], v[132:135]
    s_waitcnt vmcnt(0)
    v_mfma_f32_16x16x32_bf16 v[136:139], a[174:177], v[212:215], v[136:139]
    v_mfma_f32_16x16x32_bf16 v[140:143], a[172:175], v[212:215], v[140:143]
    s_cmp_gt_u32 s55, 6
    s_cbranch_scc1 L_have6
    s_cmp_eq_u32 s94, 0
    s_cbranch_scc1 L_f6_spin
L_f6_ok:
    buffer_load_dwordx4 v[224:227], v12, s[40:43], s14 offen offset:0 sc1
    buffer_load_dwordx4 v[228:231], v65, s[40:43], s14 offen offset:1024 sc1
L_have6:
    s_cmp_gt_u32 s55, 7
    s_cbranch_scc1 L_have7
    s_cmp_eq_u32 s95, 0
    s_cbranch_scc1 L_f7_spin
L_f7_ok:
    buffer_load_dwordx4 v[240:243], v13, s[40:43], s14 offen offset:0 sc1
    buffer_load_dwordx4 v[244:247], v66, s[40:43], s14 offen offset:1024 sc1
L_have7:
    s_waitcnt vmcnt(2)
    v_mfma_f32_16x16x32_bf16 v[128:131], a[174:177], v[224:227], v[128:131]
    v_mfma_f32_16x16x32_bf16 v[132:135], a[172:175], v[224:227], v[132:135]
    v_mfma_f32_16x16x32_bf16 v[136:139], a[174:177], v[228:231], v[136:139]
    v_mfma_f32_16x16x32_bf16 v[140:143], a[172:175], v[228:231], v[140:143]
    s_waitcnt vmcnt(0)
    v_mfma_f32_16x16x32_bf16 v[128:131], a[174:177], v[240:243], v[128:131]
    v_mfma_f32_16x16x32_bf16 v[132:135], a[172:175], v[240:243], v[132:135]
    v_mfma_f32_16x16x32_bf16 v[136:139], a[174:177], v[244:247], v[136:139]
    v_mfma_f32_16x16x32_bf16 v[140:143], a[172:175], v[244:247], v[140:143]
    s_nop 4
    v_cvt_pk_bf16_f32 v46, v128, v129
    v_cvt_pk_bf16_f32 v47, v130, v131
    v_cvt_pk_bf16_f32 v48, v132, v133
    v_cvt_pk_bf16_f32 v49, v134, v135
    v_cvt_pk_bf16_f32 v50, v136, v137
    v_cvt_pk_bf16_f32 v51, v138, v139
    v_cvt_pk_bf16_f32 v52, v140, v141
    v_cvt_pk_bf16_f32 v53, v142, v143
    buffer_store_dwordx4 v[50:53], v69, s[44:47], s57 offen
    v_permlane16_swap_b32 v46, v48
    v_permlane16_swap_b32 v47, v49
    buffer_store_dwordx4 v[46:49], v68, s[44:47], s56 offen
L_end:
    s_endpgm
L_hello_spin:
    s_add_u32 s63, s63, 1
    s_cmp_ge_u32 s63, 0x20000
    s_cbranch_scc1 L_hello_ok
    s_sleep 4
    buffer_load_dword v54, v55, s[48:51], s58 offen sc1
    s_waitcnt vmcnt(0)
    v_subrev_u32 v5, 0x01010101, v54
    v_not_b32 v3, v54
    v_and_b32 v5, v5, v3
    v_and_b32 v5, 0x80808080, v5
    v_cmp_ne_u32 vcc, 0, v5
    s_cbranch_vccnz L_hello_spin
    s_branch L_hello_ok
L_poll_first:
    s_buffer_load_dword s84, s[40:43], s88 offset:0x1c000 glc
    s_buffer_load_dword s85, s[40:43], s89 offset:0x1c000 glc
    s_buffer_load_dword s86, s[40:43], s90 offset:0x1c000 glc
    s_waitcnt vmcnt(0)
    buffer_store_dword v7, v19, s[40:43], s61 offen offset:1152 sc1
    s_waitcnt lgkmcnt(0)
    s_and_b32 s84, s84, s85
    s_and_b32 s84, s84, s86
    s_cbranch_scc1 L_poll_ok
L_poll_spin:
    s_add_u32 s63, s63, 1
    s_cmp_ge_u32 s63, 0x20000
    s_cbranch_scc1 L_poll_ok
    s_buffer_load_dword s84, s[40:43], s88 offset:0x1c000 glc
    s_buffer_load_dword s85, s[40:43], s89 offset:0x1c000 glc
    s_buffer_load_dword s86, s[40:43], s90 offset:0x1c000 glc
    s_waitcnt lgkmcnt(0)
    s_and_b32 s84, s84, s85
    s_and_b32 s84, s84, s86
    s_cbranch_scc0 L_poll_spin
    s_branch L_poll_ok
L_pollb_first:
    s_buffer_load_dword s84, s[40:43], s88 offset:0x1c400 glc
    s_buffer_load_dword s85, s[40:43], s89 offset:0x1c400 glc
    s_buffer_load_dword s86, s[40:43], s90 offset:0x1c400 glc
    s_waitcnt lgkmcnt(0)
    s_and_b32 s84, s84, s85
    s_and_b32 s84, s84, s86
    s_cbranch_scc1 L_pollb_ok
L_pollb_spin:
    s_add_u32 s63, s63, 1
    s_cmp_ge_u32 s63, 0x20000
    s_cbranch_scc1 L_pollb_ok
    s_buffer_load_dword s84, s[40:43], s88 offset:0x1c400 glc
    s_buffer_load_dword s85, s[40:43], s89 offset:0x1c400 glc
    s_buffer_load_dword s86, s[40:43], s90 offset:0x1c400 glc
    s_waitcnt lgkmcnt(0)
    s_and_b32 s84, s84, s85
    s_and_b32 s84, s84, s86
    s_cbranch_scc0 L_pollb_spin
    s_branch L_pollb_ok
L_pollc_first:
    s_buffer_load_dword s84, s[40:43], s88 offset:0x1c480 glc
    s_buffer_load_dword s85, s[40:43], s89 offset:0x1c480 glc
    s_buffer_load_dword s86, s[40:43], s90 offset:0x1c480 glc
    s_waitcnt lgkmcnt(0)
    s_and_b32 s84, s84, s85
    s_and_b32 s84, s84, s86
    s_cbranch_scc1 L_pollc_ok
L_pollc_spin:
    s_add_u32 s63, s63, 1
    s_cmp_ge_u32 s63, 0x20000
    s_cbranch_scc1 L_pollc_ok
    s_buffer_load_dword s84, s[40:43], s88 offset:0x1c480 glc
    s_buffer_load_dword s85, s[40:43], s89 offset:0x1c480 glc
    s_buffer_load_dword s86, s[40:43], s90 offset:0x1c480 glc
    s_waitcnt lgkmcnt(0)
    s_and_b32 s84, s84, s85
    s_and_b32 s84, s84, s86
    s_cbranch_scc0 L_pollc_spin
    s_branch L_pollc_ok
L_f1_pub:
    s_waitcnt vmcnt(4)
    s_mov_b64 exec, 0x40
    buffer_store_dword v7, v20, s[40:43], 0 offen sc1
    s_mov_b64 exec, -1
    s_waitcnt vmcnt(2)
    s_mov_b64 exec, 0x80
    buffer_store_dword v7, v20, s[40:43], 0 offen sc1
    s_mov_b64 exec, -1
L_f1_spin:
    s_add_u32 s63, s63, 1
    s_cmp_ge_u32 s63, 0x20000
    s_cbranch_scc1 L_f1_ok
    s_buffer_load_dword s89, s[40:43], s61 offset:128 glc
    s_buffer_load_dword s90, s[40:43], s61 offset:256 glc
    s_waitcnt lgkmcnt(0)
    s_cmp_eq_u32 s89, 0
    s_cbranch_scc1 L_f1_spin
    s_branch L_f1_ok
L_f2_pub:
    s_waitcnt vmcnt(6)
    s_mov_b64 exec, 0x40
    buffer_store_dword v7, v20, s[40:43], 0 offen sc1
    s_mov_b64 exec, -1
    s_waitcnt vmcnt(4)
    s_mov_b64 exec, 0x80
    buffer_store_dword v7, v20, s[40:43], 0 offen sc1
    s_mov_b64 exec, -1
L_f2_spin:
    s_add_u32 s63, s63, 1
    s_cmp_ge_u32 s63, 0x20000
    s_cbranch_scc1 L_f2_ok
    s_buffer_load_dword s90, s[40:43], s61 offset:256 glc
    s_waitcnt lgkmcnt(0)
    s_cmp_eq_u32 s90, 0
    s_cbranch_scc1 L_f2_spin
    s_branch L_f2_ok
L_f3_spin:
    s_add_u32 s63, s63, 1
    s_cmp_ge_u32 s63, 0x20000
    s_cbranch_scc1 L_f3_ok
    s_buffer_load_dword s91, s[40:43], s61 offset:384 glc
    s_buffer_load_dword s92, s[40:43], s61 offset:512 glc
    s_buffer_load_dword s93, s[40:43], s61 offset:640 glc
    s_buffer_load_dword s94, s[40:43], s61 offset:768 glc
    s_buffer_load_dword s95, s[40:43], s61 offset:896 glc
    s_waitcnt lgkmcnt(0)
    s_cmp_eq_u32 s91, 0
    s_cbranch_scc1 L_f3_spin
    s_branch L_f3_ok
L_f4_spin:
    s_add_u32 s63, s63, 1
    s_cmp_ge_u32 s63, 0x20000
    s_cbranch_scc1 L_f4_ok
    s_buffer_load_dword s92, s[40:43], s61 offset:512 glc
    s_buffer_load_dword s93, s[40:43], s61 offset:640 glc
    s_buffer_load_dword s94, s[40:43], s61 offset:768 glc
    s_buffer_load_dword s95, s[40:43], s61 offset:896 glc
    s_waitcnt lgkmcnt(0)
    s_cmp_eq_u32 s92, 0
    s_cbranch_scc1 L_f4_spin
    s_branch L_f4_ok
L_f5_spin:
    s_add_u32 s63, s63, 1
    s_cmp_ge_u32 s63, 0x20000
    s_cbranch_scc1 L_f5_ok
    s_buffer_load_dword s93, s[40:43], s61 offset:640 glc
    s_buffer_load_dword s94, s[40:43], s61 offset:768 glc
    s_buffer_load_dword s95, s[40:43], s61 offset:896 glc
    s_waitcnt lgkmcnt(0)
    s_cmp_eq_u32 s93, 0
    s_cbranch_scc1 L_f5_spin
    s_branch L_f5_ok
L_f6_spin:
    s_add_u32 s63, s63, 1
    s_cmp_ge_u32 s63, 0x20000
    s_cbranch_scc1 L_f6_ok
    s_buffer_load_dword s94, s[40:43], s61 offset:768 glc
    s_buffer_load_dword s95, s[40:43], s61 offset:896 glc
    s_waitcnt lgkmcnt(0)
    s_cmp_eq_u32 s94, 0
    s_cbranch_scc1 L_f6_spin
    s_branch L_f6_ok
L_f7_spin:
    s_add_u32 s63, s63, 1
    s_cmp_ge_u32 s63, 0x20000
    s_cbranch_scc1 L_f7_ok
    s_buffer_load_dword s95, s[40:43], s61 offset:896 glc
    s_waitcnt lgkmcnt(0)
    s_cmp_eq_u32 s95, 0
    s_cbranch_scc1 L_f7_spin
    s_branch L_f7_ok
L_fallback:
    s_waitcnt vmcnt(0) lgkmcnt(0)
    s_barrier
    s_mov_b32 s60, 0x7f800000
    s_mov_b32 s62, 0
    v_mov_b32 v112, 0xff800000
    v_mov_b32 v116, 0xff800000
    v_mov_b32 v120, 0xff800000
    v_mov_b32 v124, 0xff800000
L_fb_loop:
    s_add_u32 m0, s15, 0x24000
    s_add_u32 s54, s12, s62
    buffer_load_dwordx4 v8, s[28:31], s54 offen offset:0 lds
    buffer_load_dwordx4 v9, s[28:31], s54 offen offset:1024 lds
    buffer_load_dwordx4 v10, s[28:31], s54 offen offset:2048 lds
    buffer_load_dwordx4 v11, s[28:31], s54 offen offset:3072 lds
    s_waitcnt vmcnt(0)
    s_barrier
    ds_read_b128 a[96:99], v22 offset:49152
    ds_read_b128 a[100:103], v23 offset:49152
    ds_read_b128 a[104:107], v24 offset:49152
    ds_read_b128 a[108:111], v25 offset:49152
    s_waitcnt lgkmcnt(0)
    v_mfma_f32_16x16x32_bf16 v[88:91], a[96:99], a[0:3], 0
    v_mfma_f32_16x16x32_bf16 v[88:91], a[100:103], a[4:7], v[88:91]
    v_mfma_f32_16x16x32_bf16 v[88:91], a[104:107], a[8:11], v[88:91]
    v_mfma_f32_16x16x32_bf16 v[88:91], a[108:111], a[12:15], v[88:91]
    v_mfma_f32_16x16x32_bf16 v[92:95], a[96:99], a[16:19], 0
    v_mfma_f32_16x16x32_bf16 v[92:95], a[100:103], a[20:23], v[92:95]
    v_mfma_f32_16x16x32_bf16 v[92:95], a[104:107], a[24:27], v[92:95]
    v_mfma_f32_16x16x32_bf16 v[92:95], a[108:111], a[28:31], v[92:95]
    v_mfma_f32_16x16x32_bf16 v[96:99], a[96:99], a[32:35], 0
    v_mfma_f32_16x16x32_bf16 v[96:99], a[100:103], a[36:39], v[96:99]
    v_mfma_f32_16x16x32_bf16 v[96:99], a[104:107], a[40:43], v[96:99]
    v_mfma_f32_16x16x32_bf16 v[96:99], a[108:111], a[44:47], v[96:99]
    v_mfma_f32_16x16x32_bf16 v[100:103], a[96:99], a[48:51], 0
    v_mfma_f32_16x16x32_bf16 v[100:103], a[100:103], a[52:55], v[100:103]
    v_mfma_f32_16x16x32_bf16 v[100:103], a[104:107], a[56:59], v[100:103]
    v_mfma_f32_16x16x32_bf16 v[100:103], a[108:111], a[60:63], v[100:103]
    s_nop 7
    v_max3_f32 v112, v112, v88, v89
    v_max3_f32 v112, v112, v90, v91
    v_max3_f32 v116, v116, v92, v93
    v_max3_f32 v116, v116, v94, v95
    v_max3_f32 v120, v120, v96, v97
    v_max3_f32 v120, v120, v98, v99
    v_max3_f32 v124, v124, v100, v101
    v_max3_f32 v124, v124, v102, v103
    s_nop 1
    ds_read_b128 a[96:99], v22 offset:53248
    ds_read_b128 a[100:103], v23 offset:53248
    ds_read_b128 a[104:107], v24 offset:53248
    ds_read_b128 a[108:111], v25 offset:53248
    s_waitcnt lgkmcnt(0)
    v_mfma_f32_16x16x32_bf16 v[88:91], a[96:99], a[0:3], 0
    v_mfma_f32_16x16x32_bf16 v[88:91], a[100:103], a[4:7], v[88:91]
    v_mfma_f32_16x16x32_bf16 v[88:91], a[104:107], a[8:11], v[88:91]
    v_mfma_f32_16x16x32_bf16 v[88:91], a[108:111], a[12:15], v[88:91]
    v_mfma_f32_16x16x32_bf16 v[92:95], a[96:99], a[16:19], 0
    v_mfma_f32_16x16x32_bf16 v[92:95], a[100:103], a[20:23], v[92:95]
    v_mfma_f32_16x16x32_bf16 v[92:95], a[104:107], a[24:27], v[92:95]
    v_mfma_f32_16x16x32_bf16 v[92:95], a[108:111], a[28:31], v[92:95]
    v_mfma_f32_16x16x32_bf16 v[96:99], a[96:99], a[32:35], 0
    v_mfma_f32_16x16x32_bf16 v[96:99], a[100:103], a[36:39], v[96:99]
    v_mfma_f32_16x16x32_bf16 v[96:99], a[104:107], a[40:43], v[96:99]
    v_mfma_f32_16x16x32_bf16 v[96:99], a[108:111], a[44:47], v[96:99]
    v_mfma_f32_16x16x32_bf16 v[100:103], a[96:99], a[48:51], 0
    v_mfma_f32_16x16x32_bf16 v[100:103], a[100:103], a[52:55], v[100:103]
    v_mfma_f32_16x16x32_bf16 v[100:103], a[104:107], a[56:59], v[100:103]
    v_mfma_f32_16x16x32_bf16 v[100:103], a[108:111], a[60:63], v[100:103]
    s_nop 7
    v_max3_f32 v112, v112, v88, v89
    v_max3_f32 v112, v112, v90, v91
    v_max3_f32 v116, v116, v92, v93
    v_max3_f32 v116, v116, v94, v95
    v_max3_f32 v120, v120, v96, v97
    v_max3_f32 v120, v120, v98, v99
    v_max3_f32 v124, v124, v100, v101
    v_max3_f32 v124, v124, v102, v103
    s_nop 1
    ds_read_b128 a[96:99], v26 offset:49152
    ds_read_b128 a[100:103], v27 offset:49152
    ds_read_b128 a[104:107], v28 offset:49152
    ds_read_b128 a[108:111], v29 offset:49152
    s_waitcnt lgkmcnt(0)
    v_mfma_f32_16x16x32_bf16 v[88:91], a[96:99], a[0:3], 0
    v_mfma_f32_16x16x32_bf16 v[88:91], a[100:103], a[4:7], v[88:91]
    v_mfma_f32_16x16x32_bf16 v[88:91], a[104:107], a[8:11], v[88:91]
    v_mfma_f32_16x16x32_bf16 v[88:91], a[108:111], a[12:15], v[88:91]
    v_mfma_f32_16x16x32_bf16 v[92:95], a[96:99], a[16:19], 0
    v_mfma_f32_16x16x32_bf16 v[92:95], a[100:103], a[20:23], v[92:95]
    v_mfma_f32_16x16x32_bf16 v[92:95], a[104:107], a[24:27], v[92:95]
    v_mfma_f32_16x16x32_bf16 v[92:95], a[108:111], a[28:31], v[92:95]
    v_mfma_f32_16x16x32_bf16 v[96:99], a[96:99], a[32:35], 0
    v_mfma_f32_16x16x32_bf16 v[96:99], a[100:103], a[36:39], v[96:99]
    v_mfma_f32_16x16x32_bf16 v[96:99], a[104:107], a[40:43], v[96:99]
    v_mfma_f32_16x16x32_bf16 v[96:99], a[108:111], a[44:47], v[96:99]
    v_mfma_f32_16x16x32_bf16 v[100:103], a[96:99], a[48:51], 0
    v_mfma_f32_16x16x32_bf16 v[100:103], a[100:103], a[52:55], v[100:103]
    v_mfma_f32_16x16x32_bf16 v[100:103], a[104:107], a[56:59], v[100:103]
    v_mfma_f32_16x16x32_bf16 v[100:103], a[108:111], a[60:63], v[100:103]
    s_nop 7
    v_max3_f32 v112, v112, v88, v89
    v_max3_f32 v112, v112, v90, v91
    v_max3_f32 v116, v116, v92, v93
    v_max3_f32 v116, v116, v94, v95
    v_max3_f32 v120, v120, v96, v97
    v_max3_f32 v120, v120, v98, v99
    v_max3_f32 v124, v124, v100, v101
    v_max3_f32 v124, v124, v102, v103
    s_nop 1
    ds_read_b128 a[96:99], v26 offset:53248
    ds_read_b128 a[100:103], v27 offset:53248
    ds_read_b128 a[104:107], v28 offset:53248
    ds_read_b128 a[108:111], v29 offset:53248
    s_waitcnt lgkmcnt(0)
    v_mfma_f32_16x16x32_bf16 v[88:91], a[96:99], a[0:3], 0
    v_mfma_f32_16x16x32_bf16 v[88:91], a[100:103], a[4:7], v[88:91]
    v_mfma_f32_16x16x32_bf16 v[88:91], a[104:107], a[8:11], v[88:91]
    v_mfma_f32_16x16x32_bf16 v[88:91], a[108:111], a[12:15], v[88:91]
    v_mfma_f32_16x16x32_bf16 v[92:95], a[96:99], a[16:19], 0
    v_mfma_f32_16x16x32_bf16 v[92:95], a[100:103], a[20:23], v[92:95]
    v_mfma_f32_16x16x32_bf16 v[92:95], a[104:107], a[24:27], v[92:95]
    v_mfma_f32_16x16x32_bf16 v[92:95], a[108:111], a[28:31], v[92:95]
    v_mfma_f32_16x16x32_bf16 v[96:99], a[96:99], a[32:35], 0
    v_mfma_f32_16x16x32_bf16 v[96:99], a[100:103], a[36:39], v[96:99]
    v_mfma_f32_16x16x32_bf16 v[96:99], a[104:107], a[40:43], v[96:99]
    v_mfma_f32_16x16x32_bf16 v[96:99], a[108:111], a[44:47], v[96:99]
    v_mfma_f32_16x16x32_bf16 v[100:103], a[96:99], a[48:51], 0
    v_mfma_f32_16x16x32_bf16 v[100:103], a[100:103], a[52:55], v[100:103]
    v_mfma_f32_16x16x32_bf16 v[100:103], a[104:107], a[56:59], v[100:103]
    v_mfma_f32_16x16x32_bf16 v[100:103], a[108:111], a[60:63], v[100:103]
    s_nop 7
    v_max3_f32 v112, v112, v88, v89
    v_max3_f32 v112, v112, v90, v91
    v_max3_f32 v116, v116, v92, v93
    v_max3_f32 v116, v116, v94, v95
    v_max3_f32 v120, v120, v96, v97
    v_max3_f32 v120, v120, v98, v99
    v_max3_f32 v124, v124, v100, v101
    v_max3_f32 v124, v124, v102, v103
    s_nop 1
    s_barrier
    s_add_u32 s62, s62, 0x4000
    s_cmp_lt_u32 s62, 0x20000
    s_cbranch_scc1 L_fb_loop
    v_mov_b32 v88, v112
    v_mov_b32 v89, v116
    v_mov_b32 v90, v120
    v_mov_b32 v91, v124
    v_mov_b32 v46, v88
    v_mov_b32 v47, v89
    v_mov_b32 v48, v90
    v_mov_b32 v49, v91
    v_permlane16_swap_b32 v88, v46
    v_permlane16_swap_b32 v89, v47
    v_permlane16_swap_b32 v90, v48
    v_permlane16_swap_b32 v91, v49
    v_max_f32 v88, v88, v46
    v_max_f32 v89, v89, v47
    v_max_f32 v90, v90, v48
    v_max_f32 v91, v91, v49
    v_mov_b32 v46, v88
    v_mov_b32 v47, v89
    v_mov_b32 v48, v90
    v_mov_b32 v49, v91
    v_permlane32_swap_b32 v88, v46
    v_permlane32_swap_b32 v89, v47
    v_permlane32_swap_b32 v90, v48
    v_permlane32_swap_b32 v91, v49
    v_max_f32 v88, v88, v46
    v_max_f32 v89, v89, v47
    v_max_f32 v90, v90, v48
    v_max_f32 v91, v91, v49
    v_sub_f32 v112, 0, v88
    v_sub_f32 v113, 0, v88
    v_sub_f32 v114, 0, v88
    v_sub_f32 v115, 0, v88
    v_sub_f32 v116, 0, v89
    v_sub_f32 v117, 0, v89
    v_sub_f32 v118, 0, v89
    v_sub_f32 v119, 0, v89
    v_sub_f32 v120, 0, v90
    v_sub_f32 v121, 0, v90
    v_sub_f32 v122, 0, v90
    v_sub_f32 v123, 0, v90
    v_sub_f32 v124, 0, v91
    v_sub_f32 v125, 0, v91
    v_sub_f32 v126, 0, v91
    v_sub_f32 v127, 0, v91
    s_lshl_b32 s101, s99, 8
    s_sub_u32 s101, 0x100000, s101
    s_mov_b32 s53, 0x40000000
    s_branch L_restart
L_codeend:
.section .rodata,"a"
.p2align 6
.amdhsa_kernel standalone__gqa_block_cached__near_ridge_kernel
  .amdhsa_next_free_vgpr 512
  .amdhsa_next_free_sgpr 102
  .amdhsa_accum_offset 256
  .amdhsa_group_segment_fixed_size 0
  .amdhsa_kernarg_size 64
  .amdhsa_user_sgpr_count 2
  .amdhsa_user_sgpr_kernarg_segment_ptr 1
  .amdhsa_system_sgpr_workgroup_id_x 1
  .amdhsa_float_denorm_mode_32 3
.end_amdhsa_kernel
```
